```python
import torch

def _softmax(x, axis=-1):
    return torch.softmax(x, dim=axis)
def _gelu(x):
    return torch.nn.functional.gelu(x, approximate="tanh")
def _silu(x):
    return torch.nn.functional.silu(x)
def _sigmoid(x):
    return torch.sigmoid(x)
def _layernorm(x, axis=-1, eps=1e-5):
    m = x.mean(dim=axis, keepdim=True)
    v = x.var(dim=axis, keepdim=True, unbiased=False)
    return (x - m) / torch.sqrt(v + eps)
def _scatter_add(tgt, idx, src, axis=0):
    return tgt.clone().index_add_(axis, idx, src)
def _segment_sum(src, seg, n):
    out = torch.zeros((n,) + src.shape[1:], dtype=src.dtype)
    return out.index_add_(0, seg, src)
def _pad(x, pw):
    flat = tuple(v for pair in reversed(pw) for v in pair)
    return torch.nn.functional.pad(x, flat)

kernel_name = 'sequential_preLN__mha_block__mixer_s_mlp__prompt'

def setup_inputs():

    _w = (lambda a: (lambda t: t.to(torch.bfloat16) if t.is_floating_point() else t)(torch.as_tensor(a)))
    def _A_setup():
        B, S, D, H = 1, 2048, 512, 32
        return {
            "x": _w((lambda *s: torch.randn(*s, dtype=torch.bfloat16) * 0.05)(B, S, D)),
            "wqkv": _w((lambda *s: torch.randn(*s, dtype=torch.bfloat16) * 0.05)(D, 3 * D)),
            "wo": _w((lambda *s: torch.randn(*s, dtype=torch.bfloat16) * 0.05)(D, D)),
        }
    _A_in = _A_setup()

    def _B_setup():
        B, S, D, F = 1, 2048, 512, 1792
        return {
            "x":  _w((lambda *s: torch.randn(*s, dtype=torch.bfloat16) * 0.05)(B, S, D)),
            "w1": _w((lambda *s: torch.randn(*s, dtype=torch.bfloat16) * 3.2)(D, D) * (D ** -0.5)),
            "w2": _w((lambda *s: torch.randn(*s, dtype=torch.bfloat16) * 3.2)(D, D) * (D ** -0.5)),
            "w3": _w((lambda *s: torch.randn(*s, dtype=torch.bfloat16) * 3.2)(D, F) * (D ** -0.5)),
            "w4": _w((lambda *s: torch.randn(*s, dtype=torch.bfloat16) * 3.2)(F, D) * (F ** -0.5)),
        }
    _B_in = _B_setup()

    return {
        "A_x": _A_in["x"],
        "A_wqkv": _A_in["wqkv"],
        "A_wo": _A_in["wo"],
        "B_x": _B_in["x"],
        "B_w1": _B_in["w1"],
        "B_w2": _B_in["w2"],
        "B_w3": _B_in["w3"],
        "B_w4": _B_in["w4"],
    }

def reference(A_x, A_wqkv, A_wo, B_x, B_w1, B_w2, B_w3, B_w4):
    def _A_ref(x, wqkv, wo):
        B, S, D = x.shape
        H = 32
        Dh = D // H
        qkv = (lambda x, *d: x.permute(*d))((x @ wqkv).reshape(B, S, 3, H, Dh), 2, 0, 3, 1, 4)
        q, k, v = qkv[0], qkv[1], qkv[2]
        scores = torch.einsum("bhqd,bhkd->bhqk", q, k) * (Dh ** -0.5)
        p = _softmax(scores, axis=-1)
        o = torch.einsum("bhqk,bhkd->bhqd", p, v)
        return (lambda x, *d: x.permute(*d))(o, 0, 2, 1, 3).reshape(B, S, D) @ wo

    def _B_ref(x, w1, w2, w3, w4):
        B, S, D = x.shape
        h = _gelu(_layernorm(x, axis=-1) @ w1)
        c = D // 4
        g0 = _pad(h[:, :, 0*c:1*c], ((0, 0), (1, 0), (0, 0)))[:, :S, :]
        g1 = _pad(h[:, :, 1*c:2*c], ((0, 0), (0, 1), (0, 0)))[:, 1:, :]
        g2 = _pad(h[:, :, 2*c:3*c], ((0, 0), (2, 0), (0, 0)))[:, :S, :]
        g3 = _pad(h[:, :, 3*c:   ], ((0, 0), (0, 2), (0, 0)))[:, 2:, :]
        hs = torch.concatenate([g0, g1, g2, g3], axis=-1) @ w2
        x1 = x + hs
        h2 = _gelu(_layernorm(x1, axis=-1) @ w3) @ w4
        return x1 + h2

    x = A_x
    h = x + _A_ref(_layernorm(x, axis=-1), A_wqkv, A_wo)
    h2 = h + _B_ref(_layernorm(h, axis=-1), B_w1, B_w2, B_w3, B_w4)
    return h2
```

```asm
; @launch grid=(256,1,1) block=(512,1,1) lds=163840
.amdgcn_target "amdgcn-amd-amdhsa--gfx950"
.text
.globl sequential_preLN__mha_block__mixer_s_mlp__prompt_kernel
.p2align 8
.type sequential_preLN__mha_block__mixer_s_mlp__prompt_kernel,@function
sequential_preLN__mha_block__mixer_s_mlp__prompt_kernel:
    s_cmp_ge_u32 s2, 256
    s_cbranch_scc1 L_k2_end
    s_load_dwordx4 s[4:7], s[0:1], 0
    s_load_dwordx2 s[10:11], s[0:1], 80
    s_load_dwordx2 s[60:61], s[0:1], 16
    s_load_dwordx2 s[62:63], s[0:1], 32
    s_load_dwordx2 s[64:65], s[0:1], 40
    s_load_dwordx2 s[66:67], s[0:1], 48
    s_load_dwordx2 s[68:69], s[0:1], 56
    v_lshrrev_b32 v2, 6, v0
    v_and_b32 v1, 63, v0
    v_readfirstlane_b32 s3, v2
    v_lshlrev_b32 v2, 4, v1
    v_lshlrev_b32 v114, 4, v0
    s_mov_b32 s37, 0x3f803f80
    s_getpc_b64 s[30:31]
L_pca:
    s_add_u32 s30, s30, sequential_preLN__mha_block__mixer_s_mlp__prompt_kernel-L_pca
    s_addc_u32 s31, s31, -1
    s_lshr_b32 s32, s2, 3
    s_lshl_b32 s32, s32, 3
    s_add_u32 s32, s32, s3
    s_mul_i32 s32, s32, 256
    v_and_b32 v126, 1, v1
    v_lshl_add_u32 v126, v126, 7, s32
    v_min_u32 v126, L_code_end-sequential_preLN__mha_block__mixer_s_mlp__prompt_kernel-4, v126
    v_mov_b32 v127, s31
    v_add_co_u32 v126, vcc, s30, v126
    s_nop 1
    v_addc_co_u32 v127, vcc, 0, v127, vcc
    global_load_dword v125, v[126:127], off
    s_lshr_b32 s24, s2, 3
    s_and_b32 s25, s2, 7
    s_xor_b32 s46, s24, s25
    s_and_b32 s46, s46, 7
    s_and_b32 s26, s3, 1
    v_lshrrev_b32 v7, 3, v1
    s_cmp_lt_u32 s3, 6
    s_cbranch_scc1 L_q_cons
    v_bfe_u32 v9, v1, 4, 1
    v_lshlrev_b32 v9, 2, v9
    v_and_b32 v6, 7, v1
    v_xor_b32 v6, v6, v9
    v_lshlrev_b32 v6, 4, v6
    v_mul_u32_u24 v9, 3072, v7
    v_add_u32 v6, v6, v9
    v_lshrrev_b32 v9, 4, v1
    v_and_b32 v10, 7, v1
    v_xor_b32 v10, v10, v9
    v_lshlrev_b32 v10, 4, v10
    v_lshl_add_u32 v8, v7, 10, v10
    v_xor_b32 v9, 64, v8
    v_add_u32 v9, 0x2000, v9
    s_mul_i32 s27, s26, 98304
    s_lshl_b32 s30, s25, 7
    s_add_u32 s27, s27, s30
    s_mul_i32 s28, s26, 12288
    s_add_u32 s28, s28, 65536
    s_lshl_b32 s40, s24, 16
    s_lshl_b32 s41, s26, 15
    s_add_u32 s40, s40, s41
    s_lshl_b32 s47, s46, 7
    s_add_u32 s40, s40, s47
    s_lshl_b32 s41, s26, 12
    s_waitcnt lgkmcnt(0)
    s_mov_b32 s12, s4
    s_and_b32 s13, s5, 0xffff
    s_mov_b32 s14, 0x200000
    s_mov_b32 s15, 0x20000
    s_mov_b32 s48, s6
    s_and_b32 s49, s7, 0xffff
    s_mov_b32 s50, 0x180000
    s_mov_b32 s51, 0x20000
    s_xor_b32 s47, s40, 0
    s_add_u32 m0, s41, 0
    s_nop 0
    buffer_load_dwordx4 v8, s[12:15], s47 offen lds
    s_add_u32 m0, s41, 1024
    s_nop 0
    buffer_load_dwordx4 v9, s[12:15], s47 offen lds
    s_add_u32 s47, s47, 0x4000
    s_add_u32 m0, s41, 2048
    s_nop 0
    buffer_load_dwordx4 v8, s[12:15], s47 offen lds
    s_add_u32 m0, s41, 3072
    s_nop 0
    buffer_load_dwordx4 v9, s[12:15], s47 offen lds
    s_xor_b32 s29, s46, 0
    s_mul_i32 s29, s29, 196608
    s_add_u32 s29, s29, s27
    s_add_u32 m0, s28, 0
    s_nop 0
    buffer_load_dwordx4 v6, s[48:51], s29 offen offset:0 lds
    buffer_load_dwordx4 v6, s[48:51], s29 offen offset:1024 lds
    buffer_load_dwordx4 v6, s[48:51], s29 offen offset:2048 lds
    s_add_u32 s29, s29, 24576
    s_add_u32 m0, s28, 3072
    s_nop 0
    buffer_load_dwordx4 v6, s[48:51], s29 offen offset:0 lds
    buffer_load_dwordx4 v6, s[48:51], s29 offen offset:1024 lds
    buffer_load_dwordx4 v6, s[48:51], s29 offen offset:2048 lds
    s_add_u32 s29, s29, 24576
    s_add_u32 m0, s28, 6144
    s_nop 0
    buffer_load_dwordx4 v6, s[48:51], s29 offen offset:0 lds
    buffer_load_dwordx4 v6, s[48:51], s29 offen offset:1024 lds
    buffer_load_dwordx4 v6, s[48:51], s29 offen offset:2048 lds
    s_add_u32 s29, s29, 24576
    s_add_u32 m0, s28, 9216
    s_nop 0
    buffer_load_dwordx4 v6, s[48:51], s29 offen offset:0 lds
    buffer_load_dwordx4 v6, s[48:51], s29 offen offset:1024 lds
    buffer_load_dwordx4 v6, s[48:51], s29 offen offset:2048 lds
    s_xor_b32 s47, s40, 128
    s_add_u32 m0, s41, 8192
    s_nop 0
    buffer_load_dwordx4 v8, s[12:15], s47 offen lds
    s_add_u32 m0, s41, 9216
    s_nop 0
    buffer_load_dwordx4 v9, s[12:15], s47 offen lds
    s_add_u32 s47, s47, 0x4000
    s_add_u32 m0, s41, 10240
    s_nop 0
    buffer_load_dwordx4 v8, s[12:15], s47 offen lds
    s_add_u32 m0, s41, 11264
    s_nop 0
    buffer_load_dwordx4 v9, s[12:15], s47 offen lds
    s_xor_b32 s29, s46, 1
    s_mul_i32 s29, s29, 196608
    s_add_u32 s29, s29, s27
    s_add_u32 m0, s28, 24576
    s_nop 0
    buffer_load_dwordx4 v6, s[48:51], s29 offen offset:0 lds
    buffer_load_dwordx4 v6, s[48:51], s29 offen offset:1024 lds
    buffer_load_dwordx4 v6, s[48:51], s29 offen offset:2048 lds
    s_add_u32 s29, s29, 24576
    s_add_u32 m0, s28, 27648
    s_nop 0
    buffer_load_dwordx4 v6, s[48:51], s29 offen offset:0 lds
    buffer_load_dwordx4 v6, s[48:51], s29 offen offset:1024 lds
    buffer_load_dwordx4 v6, s[48:51], s29 offen offset:2048 lds
    s_add_u32 s29, s29, 24576
    s_add_u32 m0, s28, 30720
    s_nop 0
    buffer_load_dwordx4 v6, s[48:51], s29 offen offset:0 lds
    buffer_load_dwordx4 v6, s[48:51], s29 offen offset:1024 lds
    buffer_load_dwordx4 v6, s[48:51], s29 offen offset:2048 lds
    s_add_u32 s29, s29, 24576
    s_add_u32 m0, s28, 33792
    s_nop 0
    buffer_load_dwordx4 v6, s[48:51], s29 offen offset:0 lds
    buffer_load_dwordx4 v6, s[48:51], s29 offen offset:1024 lds
    buffer_load_dwordx4 v6, s[48:51], s29 offen offset:2048 lds
    s_mov_b32 s16, s10
    s_and_b32 s17, s11, 0xffff
    s_mov_b32 s18, 0x10000000
    s_mov_b32 s19, 0x20000
    v_mov_b32 v3, 0x1b05000
    buffer_load_dword v3, v3, s[16:19], 0 offen sc1
    s_waitcnt vmcnt(17)
    s_barrier
    s_xor_b32 s47, s40, 256
    s_add_u32 m0, s41, 16384
    s_nop 0
    buffer_load_dwordx4 v8, s[12:15], s47 offen lds
    s_add_u32 m0, s41, 17408
    s_nop 0
    buffer_load_dwordx4 v9, s[12:15], s47 offen lds
    s_add_u32 s47, s47, 0x4000
    s_add_u32 m0, s41, 18432
    s_nop 0
    buffer_load_dwordx4 v8, s[12:15], s47 offen lds
    s_add_u32 m0, s41, 19456
    s_nop 0
    buffer_load_dwordx4 v9, s[12:15], s47 offen lds
    s_xor_b32 s29, s46, 2
    s_mul_i32 s29, s29, 196608
    s_add_u32 s29, s29, s27
    s_add_u32 m0, s28, 49152
    s_nop 0
    buffer_load_dwordx4 v6, s[48:51], s29 offen offset:0 lds
    buffer_load_dwordx4 v6, s[48:51], s29 offen offset:1024 lds
    buffer_load_dwordx4 v6, s[48:51], s29 offen offset:2048 lds
    s_add_u32 s29, s29, 24576
    s_add_u32 m0, s28, 52224
    s_nop 0
    buffer_load_dwordx4 v6, s[48:51], s29 offen offset:0 lds
    buffer_load_dwordx4 v6, s[48:51], s29 offen offset:1024 lds
    buffer_load_dwordx4 v6, s[48:51], s29 offen offset:2048 lds
    s_add_u32 s29, s29, 24576
    s_add_u32 m0, s28, 55296
    s_nop 0
    buffer_load_dwordx4 v6, s[48:51], s29 offen offset:0 lds
    buffer_load_dwordx4 v6, s[48:51], s29 offen offset:1024 lds
    buffer_load_dwordx4 v6, s[48:51], s29 offen offset:2048 lds
    s_add_u32 s29, s29, 24576
    s_add_u32 m0, s28, 58368
    s_nop 0
    buffer_load_dwordx4 v6, s[48:51], s29 offen offset:0 lds
    buffer_load_dwordx4 v6, s[48:51], s29 offen offset:1024 lds
    buffer_load_dwordx4 v6, s[48:51], s29 offen offset:2048 lds
    s_waitcnt vmcnt(17)
    s_barrier
    s_xor_b32 s47, s40, 384
    s_add_u32 m0, s41, 24576
    s_nop 0
    buffer_load_dwordx4 v8, s[12:15], s47 offen lds
    s_add_u32 m0, s41, 25600
    s_nop 0
    buffer_load_dwordx4 v9, s[12:15], s47 offen lds
    s_add_u32 s47, s47, 0x4000
    s_add_u32 m0, s41, 26624
    s_nop 0
    buffer_load_dwordx4 v8, s[12:15], s47 offen lds
    s_add_u32 m0, s41, 27648
    s_nop 0
    buffer_load_dwordx4 v9, s[12:15], s47 offen lds
    s_xor_b32 s29, s46, 3
    s_mul_i32 s29, s29, 196608
    s_add_u32 s29, s29, s27
    s_add_u32 m0, s28, 73728
    s_nop 0
    buffer_load_dwordx4 v6, s[48:51], s29 offen offset:0 lds
    buffer_load_dwordx4 v6, s[48:51], s29 offen offset:1024 lds
    buffer_load_dwordx4 v6, s[48:51], s29 offen offset:2048 lds
    s_add_u32 s29, s29, 24576
    s_add_u32 m0, s28, 76800
    s_nop 0
    buffer_load_dwordx4 v6, s[48:51], s29 offen offset:0 lds
    buffer_load_dwordx4 v6, s[48:51], s29 offen offset:1024 lds
    buffer_load_dwordx4 v6, s[48:51], s29 offen offset:2048 lds
    s_add_u32 s29, s29, 24576
    s_add_u32 m0, s28, 79872
    s_nop 0
    buffer_load_dwordx4 v6, s[48:51], s29 offen offset:0 lds
    buffer_load_dwordx4 v6, s[48:51], s29 offen offset:1024 lds
    buffer_load_dwordx4 v6, s[48:51], s29 offen offset:2048 lds
    s_add_u32 s29, s29, 24576
    s_add_u32 m0, s28, 82944
    s_nop 0
    buffer_load_dwordx4 v6, s[48:51], s29 offen offset:0 lds
    buffer_load_dwordx4 v6, s[48:51], s29 offen offset:1024 lds
    buffer_load_dwordx4 v6, s[48:51], s29 offen offset:2048 lds
    s_waitcnt vmcnt(16)
    s_barrier
    s_xor_b32 s47, s40, 512
    s_add_u32 m0, s41, 32768
    s_nop 0
    buffer_load_dwordx4 v8, s[12:15], s47 offen lds
    s_add_u32 m0, s41, 33792
    s_nop 0
    buffer_load_dwordx4 v9, s[12:15], s47 offen lds
    s_add_u32 s47, s47, 0x4000
    s_add_u32 m0, s41, 34816
    s_nop 0
    buffer_load_dwordx4 v8, s[12:15], s47 offen lds
    s_add_u32 m0, s41, 35840
    s_nop 0
    buffer_load_dwordx4 v9, s[12:15], s47 offen lds
    s_xor_b32 s29, s46, 4
    s_mul_i32 s29, s29, 196608
    s_add_u32 s29, s29, s27
    s_add_u32 m0, s28, 0
    s_nop 0
    buffer_load_dwordx4 v6, s[48:51], s29 offen offset:0 lds
    buffer_load_dwordx4 v6, s[48:51], s29 offen offset:1024 lds
    buffer_load_dwordx4 v6, s[48:51], s29 offen offset:2048 lds
    s_add_u32 s29, s29, 24576
    s_add_u32 m0, s28, 3072
    s_nop 0
    buffer_load_dwordx4 v6, s[48:51], s29 offen offset:0 lds
    buffer_load_dwordx4 v6, s[48:51], s29 offen offset:1024 lds
    buffer_load_dwordx4 v6, s[48:51], s29 offen offset:2048 lds
    s_add_u32 s29, s29, 24576
    s_add_u32 m0, s28, 6144
    s_nop 0
    buffer_load_dwordx4 v6, s[48:51], s29 offen offset:0 lds
    buffer_load_dwordx4 v6, s[48:51], s29 offen offset:1024 lds
    buffer_load_dwordx4 v6, s[48:51], s29 offen offset:2048 lds
    s_add_u32 s29, s29, 24576
    s_add_u32 m0, s28, 9216
    s_nop 0
    buffer_load_dwordx4 v6, s[48:51], s29 offen offset:0 lds
    buffer_load_dwordx4 v6, s[48:51], s29 offen offset:1024 lds
    buffer_load_dwordx4 v6, s[48:51], s29 offen offset:2048 lds
    s_waitcnt vmcnt(16)
    s_barrier
    s_xor_b32 s47, s40, 640
    s_add_u32 m0, s41, 40960
    s_nop 0
    buffer_load_dwordx4 v8, s[12:15], s47 offen lds
    s_add_u32 m0, s41, 41984
    s_nop 0
    buffer_load_dwordx4 v9, s[12:15], s47 offen lds
    s_add_u32 s47, s47, 0x4000
    s_add_u32 m0, s41, 43008
    s_nop 0
    buffer_load_dwordx4 v8, s[12:15], s47 offen lds
    s_add_u32 m0, s41, 44032
    s_nop 0
    buffer_load_dwordx4 v9, s[12:15], s47 offen lds
    s_xor_b32 s29, s46, 5
    s_mul_i32 s29, s29, 196608
    s_add_u32 s29, s29, s27
    s_add_u32 m0, s28, 24576
    s_nop 0
    buffer_load_dwordx4 v6, s[48:51], s29 offen offset:0 lds
    buffer_load_dwordx4 v6, s[48:51], s29 offen offset:1024 lds
    buffer_load_dwordx4 v6, s[48:51], s29 offen offset:2048 lds
    s_add_u32 s29, s29, 24576
    s_add_u32 m0, s28, 27648
    s_nop 0
    buffer_load_dwordx4 v6, s[48:51], s29 offen offset:0 lds
    buffer_load_dwordx4 v6, s[48:51], s29 offen offset:1024 lds
    buffer_load_dwordx4 v6, s[48:51], s29 offen offset:2048 lds
    s_add_u32 s29, s29, 24576
    s_add_u32 m0, s28, 30720
    s_nop 0
    buffer_load_dwordx4 v6, s[48:51], s29 offen offset:0 lds
    buffer_load_dwordx4 v6, s[48:51], s29 offen offset:1024 lds
    buffer_load_dwordx4 v6, s[48:51], s29 offen offset:2048 lds
    s_add_u32 s29, s29, 24576
    s_add_u32 m0, s28, 33792
    s_nop 0
    buffer_load_dwordx4 v6, s[48:51], s29 offen offset:0 lds
    buffer_load_dwordx4 v6, s[48:51], s29 offen offset:1024 lds
    buffer_load_dwordx4 v6, s[48:51], s29 offen offset:2048 lds
    s_waitcnt vmcnt(16)
    s_barrier
    s_xor_b32 s47, s40, 768
    s_add_u32 m0, s41, 49152
    s_nop 0
    buffer_load_dwordx4 v8, s[12:15], s47 offen lds
    s_add_u32 m0, s41, 50176
    s_nop 0
    buffer_load_dwordx4 v9, s[12:15], s47 offen lds
    s_add_u32 s47, s47, 0x4000
    s_add_u32 m0, s41, 51200
    s_nop 0
    buffer_load_dwordx4 v8, s[12:15], s47 offen lds
    s_add_u32 m0, s41, 52224
    s_nop 0
    buffer_load_dwordx4 v9, s[12:15], s47 offen lds
    s_xor_b32 s29, s46, 6
    s_mul_i32 s29, s29, 196608
    s_add_u32 s29, s29, s27
    s_add_u32 m0, s28, 49152
    s_nop 0
    buffer_load_dwordx4 v6, s[48:51], s29 offen offset:0 lds
    buffer_load_dwordx4 v6, s[48:51], s29 offen offset:1024 lds
    buffer_load_dwordx4 v6, s[48:51], s29 offen offset:2048 lds
    s_add_u32 s29, s29, 24576
    s_add_u32 m0, s28, 52224
    s_nop 0
    buffer_load_dwordx4 v6, s[48:51], s29 offen offset:0 lds
    buffer_load_dwordx4 v6, s[48:51], s29 offen offset:1024 lds
    buffer_load_dwordx4 v6, s[48:51], s29 offen offset:2048 lds
    s_add_u32 s29, s29, 24576
    s_add_u32 m0, s28, 55296
    s_nop 0
    buffer_load_dwordx4 v6, s[48:51], s29 offen offset:0 lds
    buffer_load_dwordx4 v6, s[48:51], s29 offen offset:1024 lds
    buffer_load_dwordx4 v6, s[48:51], s29 offen offset:2048 lds
    s_add_u32 s29, s29, 24576
    s_add_u32 m0, s28, 58368
    s_nop 0
    buffer_load_dwordx4 v6, s[48:51], s29 offen offset:0 lds
    buffer_load_dwordx4 v6, s[48:51], s29 offen offset:1024 lds
    buffer_load_dwordx4 v6, s[48:51], s29 offen offset:2048 lds
    s_waitcnt vmcnt(16)
    s_barrier
    s_xor_b32 s47, s40, 896
    s_add_u32 m0, s41, 57344
    s_nop 0
    buffer_load_dwordx4 v8, s[12:15], s47 offen lds
    s_add_u32 m0, s41, 58368
    s_nop 0
    buffer_load_dwordx4 v9, s[12:15], s47 offen lds
    s_add_u32 s47, s47, 0x4000
    s_add_u32 m0, s41, 59392
    s_nop 0
    buffer_load_dwordx4 v8, s[12:15], s47 offen lds
    s_add_u32 m0, s41, 60416
    s_nop 0
    buffer_load_dwordx4 v9, s[12:15], s47 offen lds
    s_xor_b32 s29, s46, 7
    s_mul_i32 s29, s29, 196608
    s_add_u32 s29, s29, s27
    s_add_u32 m0, s28, 73728
    s_nop 0
    buffer_load_dwordx4 v6, s[48:51], s29 offen offset:0 lds
    buffer_load_dwordx4 v6, s[48:51], s29 offen offset:1024 lds
    buffer_load_dwordx4 v6, s[48:51], s29 offen offset:2048 lds
    s_add_u32 s29, s29, 24576
    s_add_u32 m0, s28, 76800
    s_nop 0
    buffer_load_dwordx4 v6, s[48:51], s29 offen offset:0 lds
    buffer_load_dwordx4 v6, s[48:51], s29 offen offset:1024 lds
    buffer_load_dwordx4 v6, s[48:51], s29 offen offset:2048 lds
    s_add_u32 s29, s29, 24576
    s_add_u32 m0, s28, 79872
    s_nop 0
    buffer_load_dwordx4 v6, s[48:51], s29 offen offset:0 lds
    buffer_load_dwordx4 v6, s[48:51], s29 offen offset:1024 lds
    buffer_load_dwordx4 v6, s[48:51], s29 offen offset:2048 lds
    s_add_u32 s29, s29, 24576
    s_add_u32 m0, s28, 82944
    s_nop 0
    buffer_load_dwordx4 v6, s[48:51], s29 offen offset:0 lds
    buffer_load_dwordx4 v6, s[48:51], s29 offen offset:1024 lds
    buffer_load_dwordx4 v6, s[48:51], s29 offen offset:2048 lds
    s_waitcnt vmcnt(16)
    s_barrier
    s_and_b32 s52, s3, 3
    s_and_b32 s30, s2, 3
    s_lshr_b32 s31, s2, 2
    s_lshl_b32 s32, s31, 15
    s_lshl_b32 s30, s30, 8
    s_add_u32 s32, s32, s30
    s_mul_hi_u32 s31, s2, 0x12492493
    s_mul_i32 s30, s31, 14
    s_sub_u32 s30, s2, s30
    s_mul_i32 s33, s31, 114688
    s_lshl_b32 s30, s30, 8
    s_add_u32 s33, s33, s30
    s_lshr_b32 s30, s2, 4
    s_and_b32 s31, s2, 15
    s_lshl_b32 s54, s30, 15
    s_lshl_b32 s31, s31, 6
    s_add_u32 s54, s54, s31
    s_and_b32 s30, s2, 3
    s_lshl_b32 s30, s30, 2
    s_add_u32 s30, s30, s52
    s_mul_i32 s53, s30, 115712
    s_lshr_b32 s31, s2, 2
    s_mul_hi_u32 s57, s31, 0x12492493
    s_and_b32 s57, s57, 1
    s_lshl_b32 s57, s57, 5
    s_lshl_b32 s31, s31, 11
    s_add_u32 s53, s53, s31
    s_add_u32 s53, s53, 0x1900000
    s_mul_hi_u32 s31, s2, 0x12492493
    s_mul_i32 s30, s31, 14
    s_sub_u32 s30, s2, s30
    s_lshl_b32 s30, s30, 2
    s_add_u32 s30, s30, s52
    s_mul_i32 s30, s30, 33792
    s_lshl_b32 s31, s31, 11
    s_add_u32 s30, s30, s31
    s_add_u32 s30, s30, 0x1700000
    s_cmp_ge_u32 s3, 4
    s_cselect_b32 s32, s33, s32
    s_cselect_b32 s53, s30, s53
    s_cselect_b32 s57, 0, s57
    s_cselect_b32 s20, s66, s68
    s_cselect_b32 s21, s67, s69
    s_movk_i32 s55, 1024
    s_cselect_b32 s55, 3584, s55
    s_lshl_b32 s30, s52, 6
    s_add_u32 s32, s32, s30
    s_cmp_lt_u32 s2, 224
    s_cselect_b32 s32, s32, 0x7ff00000
    s_cselect_b32 s68, s53, 0x7ff00000
    s_and_b32 s21, s21, 0xffff
    s_mov_b32 s22, 0x1c0000
    s_mov_b32 s23, 0x20000
    v_lshrrev_b32 v246, 2, v1
    v_and_b32 v247, 48, v2
    v_mad_u32_u24 v244, v246, s55, v247
    v_add_u32 v244, s32, v244
    s_lshl_b32 s55, s55, 4
    v_add_u32 v245, s55, v244
    v_lshl_add_u32 v246, v246, 10, v247
    s_lshr_b32 s30, s2, 4
    s_and_b32 s31, s2, 15
    s_and_b32 s32, s30, 1
    s_lshl_b32 s32, s32, 12
    s_lshr_b32 s33, s30, 1
    s_mul_i32 s33, s33, 9216
    s_add_u32 s32, s32, s33
    s_lshr_b32 s33, s31, 1
    s_mul_i32 s33, s33, 74752
    s_add_u32 s32, s32, s33
    s_and_b32 s33, s31, 1
    s_lshl_b32 s33, s33, 11
    s_add_u32 s32, s32, s33
    s_mul_i32 s33, s3, 655360
    s_add_u32 s32, s32, s33
    s_add_u32 s32, s32, 0x1500000
    s_cmp_eq_u32 s3, 1
    s_cselect_b32 s30, s62, s60
    s_cselect_b32 s31, s63, s61
    s_cmp_eq_u32 s3, 2
    s_cselect_b32 s64, s64, s30
    s_cselect_b32 s65, s65, s31
    s_cmp_lt_u32 s3, 3
    s_cselect_b32 s54, s54, 0x7ff00000
    s_cselect_b32 s69, s32, 0x7ff00000
    s_and_b32 s65, s65, 0xffff
    s_mov_b32 s66, 0x80000
    s_mov_b32 s67, 0x20000
    s_mov_b32 s63, s57
    v_add_u32 v246, s54, v246
    v_add_u32 v247, 0x4000, v246
    s_waitcnt vmcnt(0)
    s_barrier
    v_readfirstlane_b32 s56, v3
    s_mul_i32 s56, s56, 0x9e3779b1
    s_add_u32 s56, s56, 0x7f4a7c15
    s_barrier
    v_mov_b32 v113, 0
    ds_read_b32 v112, v113 offset:16896
    s_waitcnt lgkmcnt(0)
    v_readfirstlane_b32 s34, v112
    s_mov_b32 s35, s34
    s_waitcnt vmcnt(0) lgkmcnt(0)
    s_branch L_q_join
L_q_cons:
    s_lshr_b32 s40, s3, 1
    s_cmp_lt_u32 s3, 4
    s_cselect_b32 s40, s40, s26
    v_and_b32 v8, 31, v1
    v_lshrrev_b32 v9, 5, v1
    v_bfe_u32 v10, v1, 1, 3
    v_xor_b32 v10, v10, v9
    v_lshlrev_b32 v10, 4, v10
    v_lshl_add_u32 v10, v8, 7, v10
    s_lshl_b32 s30, s40, 12
    v_add_u32 v16, s30, v10
    v_xor_b32 v17, 32, v16
    v_xor_b32 v18, 64, v16
    v_xor_b32 v19, 96, v16
    v_lshrrev_b32 v24, 5, v1
    v_mul_u32_u24 v24, 3072, v24
    v_bfe_u32 v8, v1, 2, 2
    v_lshl_add_u32 v24, v8, 7, v24
    v_bfe_u32 v8, v1, 3, 1
    v_lshl_add_u32 v24, v8, 6, v24
    v_bfe_u32 v8, v1, 4, 1
    v_lshl_add_u32 v24, v8, 5, v24
    v_and_b32 v8, 1, v1
    v_lshl_add_u32 v24, v8, 4, v24
    v_bfe_u32 v8, v1, 1, 1
    v_lshl_add_u32 v24, v8, 3, v24
    s_lshl_b32 s30, s26, 6
    v_xor_b32 v24, s30, v24
    v_add_u32 v24, 65536, v24
    v_add_u32 v25, 49152, v24
    s_waitcnt lgkmcnt(0)
    s_mov_b32 s12, s4
    s_and_b32 s13, s5, 0xffff
    s_mov_b32 s14, 0x200000
    s_mov_b32 s15, 0x20000
    s_mov_b32 s16, s10
    s_and_b32 s17, s11, 0xffff
    s_mov_b32 s18, 0x10000000
    s_mov_b32 s19, 0x20000
    v_mov_b32 v3, 0x1b05000
    buffer_load_dword v3, v3, s[16:19], 0 offen sc1
    s_and_b32 s52, s3, 3
    s_and_b32 s30, s2, 3
    s_lshr_b32 s31, s2, 2
    s_lshl_b32 s32, s31, 15
    s_lshl_b32 s30, s30, 8
    s_add_u32 s32, s32, s30
    s_mul_hi_u32 s31, s2, 0x12492493
    s_mul_i32 s30, s31, 14
    s_sub_u32 s30, s2, s30
    s_mul_i32 s33, s31, 114688
    s_lshl_b32 s30, s30, 8
    s_add_u32 s33, s33, s30
    s_lshr_b32 s30, s2, 4
    s_and_b32 s31, s2, 15
    s_lshl_b32 s54, s30, 15
    s_lshl_b32 s31, s31, 6
    s_add_u32 s54, s54, s31
    s_and_b32 s30, s2, 3
    s_lshl_b32 s30, s30, 2
    s_add_u32 s30, s30, s52
    s_mul_i32 s53, s30, 115712
    s_lshr_b32 s31, s2, 2
    s_mul_hi_u32 s57, s31, 0x12492493
    s_and_b32 s57, s57, 1
    s_lshl_b32 s57, s57, 5
    s_lshl_b32 s31, s31, 11
    s_add_u32 s53, s53, s31
    s_add_u32 s53, s53, 0x1900000
    s_mul_hi_u32 s31, s2, 0x12492493
    s_mul_i32 s30, s31, 14
    s_sub_u32 s30, s2, s30
    s_lshl_b32 s30, s30, 2
    s_add_u32 s30, s30, s52
    s_mul_i32 s30, s30, 33792
    s_lshl_b32 s31, s31, 11
    s_add_u32 s30, s30, s31
    s_add_u32 s30, s30, 0x1700000
    s_cmp_ge_u32 s3, 4
    s_cselect_b32 s32, s33, s32
    s_cselect_b32 s53, s30, s53
    s_cselect_b32 s57, 0, s57
    s_cselect_b32 s20, s66, s68
    s_cselect_b32 s21, s67, s69
    s_movk_i32 s55, 1024
    s_cselect_b32 s55, 3584, s55
    s_lshl_b32 s30, s52, 6
    s_add_u32 s32, s32, s30
    s_cmp_lt_u32 s2, 224
    s_cselect_b32 s32, s32, 0x7ff00000
    s_cselect_b32 s68, s53, 0x7ff00000
    s_and_b32 s21, s21, 0xffff
    s_mov_b32 s22, 0x1c0000
    s_mov_b32 s23, 0x20000
    v_lshrrev_b32 v246, 2, v1
    v_and_b32 v247, 48, v2
    v_mad_u32_u24 v244, v246, s55, v247
    v_add_u32 v244, s32, v244
    s_lshl_b32 s55, s55, 4
    v_add_u32 v245, s55, v244
    v_lshl_add_u32 v246, v246, 10, v247
    s_lshr_b32 s30, s2, 4
    s_and_b32 s31, s2, 15
    s_and_b32 s32, s30, 1
    s_lshl_b32 s32, s32, 12
    s_lshr_b32 s33, s30, 1
    s_mul_i32 s33, s33, 9216
    s_add_u32 s32, s32, s33
    s_lshr_b32 s33, s31, 1
    s_mul_i32 s33, s33, 74752
    s_add_u32 s32, s32, s33
    s_and_b32 s33, s31, 1
    s_lshl_b32 s33, s33, 11
    s_add_u32 s32, s32, s33
    s_mul_i32 s33, s3, 655360
    s_add_u32 s32, s32, s33
    s_add_u32 s32, s32, 0x1500000
    s_cmp_eq_u32 s3, 1
    s_cselect_b32 s30, s62, s60
    s_cselect_b32 s31, s63, s61
    s_cmp_eq_u32 s3, 2
    s_cselect_b32 s64, s64, s30
    s_cselect_b32 s65, s65, s31
    s_cmp_lt_u32 s3, 3
    s_cselect_b32 s54, s54, 0x7ff00000
    s_cselect_b32 s69, s32, 0x7ff00000
    s_and_b32 s65, s65, 0xffff
    s_mov_b32 s66, 0x80000
    s_mov_b32 s67, 0x20000
    s_mov_b32 s63, s57
    v_add_u32 v246, s54, v246
    v_add_u32 v247, 0x4000, v246
    s_cmp_lt_u32 s3, 4
    s_cbranch_scc1 L_q_comp
    s_lshl_b32 s42, s25, 5
    s_add_u32 s42, s42, s24
    s_lshl_b32 s44, s42, 6
    s_add_u32 s44, s44, 0x1b01000
    s_cmp_eq_u32 s3, 4
    s_cselect_b32 s44, s44, 0x7ff00000
    s_getreg_b32 s45, hwreg(HW_REG_XCC_ID)
    s_and_b32 s45, s45, 15
    s_waitcnt vmcnt(0)
    v_readfirstlane_b32 s56, v3
    s_mul_i32 s56, s56, 0x9e3779b1
    s_add_u32 s56, s56, 0x7f4a7c15
    s_xor_b32 s45, s45, s56
    v_mov_b32 v12, 0
    v_mov_b32 v13, s45
    s_mov_b64 exec, 1
    buffer_store_dword v13, v12, s[16:19], s44 offen sc1
    s_mov_b64 exec, -1
    s_lshl_b32 s30, s25, 9
    s_add_u32 s30, s30, 0x1b06000
    s_cmp_eq_u32 s26, 0
    s_cselect_b32 s30, s30, 0x1b00000
    buffer_load_dwordx4 v[52:55], v2, s[16:19], s30 offen sc1
    v_mov_b32 v32, 0
    v_mov_b32 v33, 0
    v_mov_b32 v34, 0
    v_mov_b32 v35, 0
    s_setprio 2
    s_barrier
    ds_read_b128 v[80:83], v16 offset:0
    ds_read_b128 v[96:99], v17 offset:0
    ds_read_b128 v[212:215], v18 offset:0
    s_waitcnt lgkmcnt(2)
    v_lshlrev_b32 v40, 16, v80
    v_and_b32 v41, 0xffff0000, v80
    v_lshlrev_b32 v42, 16, v81
    v_and_b32 v43, 0xffff0000, v81
    v_lshlrev_b32 v44, 16, v82
    v_and_b32 v45, 0xffff0000, v82
    v_lshlrev_b32 v46, 16, v83
    v_and_b32 v47, 0xffff0000, v83
    v_add_f32 v32, v32, v40
    v_fmac_f32 v34, v40, v40
    v_add_f32 v33, v33, v41
    v_fmac_f32 v35, v41, v41
    v_add_f32 v32, v32, v42
    v_fmac_f32 v34, v42, v42
    v_add_f32 v33, v33, v43
    v_fmac_f32 v35, v43, v43
    v_add_f32 v32, v32, v44
    v_fmac_f32 v34, v44, v44
    v_add_f32 v33, v33, v45
    v_fmac_f32 v35, v45, v45
    v_add_f32 v32, v32, v46
    v_fmac_f32 v34, v46, v46
    v_add_f32 v33, v33, v47
    v_fmac_f32 v35, v47, v47
    ds_read_b128 v[80:83], v19 offset:0
    s_waitcnt lgkmcnt(2)
    v_lshlrev_b32 v40, 16, v96
    v_and_b32 v41, 0xffff0000, v96
    v_lshlrev_b32 v42, 16, v97
    v_and_b32 v43, 0xffff0000, v97
    v_lshlrev_b32 v44, 16, v98
    v_and_b32 v45, 0xffff0000, v98
    v_lshlrev_b32 v46, 16, v99
    v_and_b32 v47, 0xffff0000, v99
    v_add_f32 v32, v32, v40
    v_fmac_f32 v34, v40, v40
    v_add_f32 v33, v33, v41
    v_fmac_f32 v35, v41, v41
    v_add_f32 v32, v32, v42
    v_fmac_f32 v34, v42, v42
    v_add_f32 v33, v33, v43
    v_fmac_f32 v35, v43, v43
    v_add_f32 v32, v32, v44
    v_fmac_f32 v34, v44, v44
    v_add_f32 v33, v33, v45
    v_fmac_f32 v35, v45, v45
    v_add_f32 v32, v32, v46
    v_fmac_f32 v34, v46, v46
    v_add_f32 v33, v33, v47
    v_fmac_f32 v35, v47, v47
    s_barrier
    ds_read_b128 v[96:99], v16 offset:8192
    s_waitcnt lgkmcnt(2)
    v_lshlrev_b32 v40, 16, v212
    v_and_b32 v41, 0xffff0000, v212
    v_lshlrev_b32 v42, 16, v213
    v_and_b32 v43, 0xffff0000, v213
    v_lshlrev_b32 v44, 16, v214
    v_and_b32 v45, 0xffff0000, v214
    v_lshlrev_b32 v46, 16, v215
    v_and_b32 v47, 0xffff0000, v215
    v_add_f32 v32, v32, v40
    v_fmac_f32 v34, v40, v40
    v_add_f32 v33, v33, v41
    v_fmac_f32 v35, v41, v41
    v_add_f32 v32, v32, v42
    v_fmac_f32 v34, v42, v42
    v_add_f32 v33, v33, v43
    v_fmac_f32 v35, v43, v43
    v_add_f32 v32, v32, v44
    v_fmac_f32 v34, v44, v44
    v_add_f32 v33, v33, v45
    v_fmac_f32 v35, v45, v45
    v_add_f32 v32, v32, v46
    v_fmac_f32 v34, v46, v46
    v_add_f32 v33, v33, v47
    v_fmac_f32 v35, v47, v47
    ds_read_b128 v[212:215], v17 offset:8192
    s_waitcnt lgkmcnt(2)
    v_lshlrev_b32 v40, 16, v80
    v_and_b32 v41, 0xffff0000, v80
    v_lshlrev_b32 v42, 16, v81
    v_and_b32 v43, 0xffff0000, v81
    v_lshlrev_b32 v44, 16, v82
    v_and_b32 v45, 0xffff0000, v82
    v_lshlrev_b32 v46, 16, v83
    v_and_b32 v47, 0xffff0000, v83
    v_add_f32 v32, v32, v40
    v_fmac_f32 v34, v40, v40
    v_add_f32 v33, v33, v41
    v_fmac_f32 v35, v41, v41
    v_add_f32 v32, v32, v42
    v_fmac_f32 v34, v42, v42
    v_add_f32 v33, v33, v43
    v_fmac_f32 v35, v43, v43
    v_add_f32 v32, v32, v44
    v_fmac_f32 v34, v44, v44
    v_add_f32 v33, v33, v45
    v_fmac_f32 v35, v45, v45
    v_add_f32 v32, v32, v46
    v_fmac_f32 v34, v46, v46
    v_add_f32 v33, v33, v47
    v_fmac_f32 v35, v47, v47
    ds_read_b128 v[80:83], v18 offset:8192
    s_waitcnt lgkmcnt(2)
    v_lshlrev_b32 v40, 16, v96
    v_and_b32 v41, 0xffff0000, v96
    v_lshlrev_b32 v42, 16, v97
    v_and_b32 v43, 0xffff0000, v97
    v_lshlrev_b32 v44, 16, v98
    v_and_b32 v45, 0xffff0000, v98
    v_lshlrev_b32 v46, 16, v99
    v_and_b32 v47, 0xffff0000, v99
    v_add_f32 v32, v32, v40
    v_fmac_f32 v34, v40, v40
    v_add_f32 v33, v33, v41
    v_fmac_f32 v35, v41, v41
    v_add_f32 v32, v32, v42
    v_fmac_f32 v34, v42, v42
    v_add_f32 v33, v33, v43
    v_fmac_f32 v35, v43, v43
    v_add_f32 v32, v32, v44
    v_fmac_f32 v34, v44, v44
    v_add_f32 v33, v33, v45
    v_fmac_f32 v35, v45, v45
    v_add_f32 v32, v32, v46
    v_fmac_f32 v34, v46, v46
    v_add_f32 v33, v33, v47
    v_fmac_f32 v35, v47, v47
    ds_read_b128 v[96:99], v19 offset:8192
    s_waitcnt lgkmcnt(2)
    v_lshlrev_b32 v40, 16, v212
    v_and_b32 v41, 0xffff0000, v212
    v_lshlrev_b32 v42, 16, v213
    v_and_b32 v43, 0xffff0000, v213
    v_lshlrev_b32 v44, 16, v214
    v_and_b32 v45, 0xffff0000, v214
    v_lshlrev_b32 v46, 16, v215
    v_and_b32 v47, 0xffff0000, v215
    v_add_f32 v32, v32, v40
    v_fmac_f32 v34, v40, v40
    v_add_f32 v33, v33, v41
    v_fmac_f32 v35, v41, v41
    v_add_f32 v32, v32, v42
    v_fmac_f32 v34, v42, v42
    v_add_f32 v33, v33, v43
    v_fmac_f32 v35, v43, v43
    v_add_f32 v32, v32, v44
    v_fmac_f32 v34, v44, v44
    v_add_f32 v33, v33, v45
    v_fmac_f32 v35, v45, v45
    v_add_f32 v32, v32, v46
    v_fmac_f32 v34, v46, v46
    v_add_f32 v33, v33, v47
    v_fmac_f32 v35, v47, v47
    s_barrier
    ds_read_b128 v[212:215], v16 offset:16384
    s_waitcnt lgkmcnt(2)
    v_lshlrev_b32 v40, 16, v80
    v_and_b32 v41, 0xffff0000, v80
    v_lshlrev_b32 v42, 16, v81
    v_and_b32 v43, 0xffff0000, v81
    v_lshlrev_b32 v44, 16, v82
    v_and_b32 v45, 0xffff0000, v82
    v_lshlrev_b32 v46, 16, v83
    v_and_b32 v47, 0xffff0000, v83
    v_add_f32 v32, v32, v40
    v_fmac_f32 v34, v40, v40
    v_add_f32 v33, v33, v41
    v_fmac_f32 v35, v41, v41
    v_add_f32 v32, v32, v42
    v_fmac_f32 v34, v42, v42
    v_add_f32 v33, v33, v43
    v_fmac_f32 v35, v43, v43
    v_add_f32 v32, v32, v44
    v_fmac_f32 v34, v44, v44
    v_add_f32 v33, v33, v45
    v_fmac_f32 v35, v45, v45
    v_add_f32 v32, v32, v46
    v_fmac_f32 v34, v46, v46
    v_add_f32 v33, v33, v47
    v_fmac_f32 v35, v47, v47
    ds_read_b128 v[80:83], v17 offset:16384
    s_waitcnt lgkmcnt(2)
    v_lshlrev_b32 v40, 16, v96
    v_and_b32 v41, 0xffff0000, v96
    v_lshlrev_b32 v42, 16, v97
    v_and_b32 v43, 0xffff0000, v97
    v_lshlrev_b32 v44, 16, v98
    v_and_b32 v45, 0xffff0000, v98
    v_lshlrev_b32 v46, 16, v99
    v_and_b32 v47, 0xffff0000, v99
    v_add_f32 v32, v32, v40
    v_fmac_f32 v34, v40, v40
    v_add_f32 v33, v33, v41
    v_fmac_f32 v35, v41, v41
    v_add_f32 v32, v32, v42
    v_fmac_f32 v34, v42, v42
    v_add_f32 v33, v33, v43
    v_fmac_f32 v35, v43, v43
    v_add_f32 v32, v32, v44
    v_fmac_f32 v34, v44, v44
    v_add_f32 v33, v33, v45
    v_fmac_f32 v35, v45, v45
    v_add_f32 v32, v32, v46
    v_fmac_f32 v34, v46, v46
    v_add_f32 v33, v33, v47
    v_fmac_f32 v35, v47, v47
    ds_read_b128 v[96:99], v18 offset:16384
    s_waitcnt lgkmcnt(2)
    v_lshlrev_b32 v40, 16, v212
    v_and_b32 v41, 0xffff0000, v212
    v_lshlrev_b32 v42, 16, v213
    v_and_b32 v43, 0xffff0000, v213
    v_lshlrev_b32 v44, 16, v214
    v_and_b32 v45, 0xffff0000, v214
    v_lshlrev_b32 v46, 16, v215
    v_and_b32 v47, 0xffff0000, v215
    v_add_f32 v32, v32, v40
    v_fmac_f32 v34, v40, v40
    v_add_f32 v33, v33, v41
    v_fmac_f32 v35, v41, v41
    v_add_f32 v32, v32, v42
    v_fmac_f32 v34, v42, v42
    v_add_f32 v33, v33, v43
    v_fmac_f32 v35, v43, v43
    v_add_f32 v32, v32, v44
    v_fmac_f32 v34, v44, v44
    v_add_f32 v33, v33, v45
    v_fmac_f32 v35, v45, v45
    v_add_f32 v32, v32, v46
    v_fmac_f32 v34, v46, v46
    v_add_f32 v33, v33, v47
    v_fmac_f32 v35, v47, v47
    ds_read_b128 v[212:215], v19 offset:16384
    s_waitcnt lgkmcnt(2)
    v_lshlrev_b32 v40, 16, v80
    v_and_b32 v41, 0xffff0000, v80
    v_lshlrev_b32 v42, 16, v81
    v_and_b32 v43, 0xffff0000, v81
    v_lshlrev_b32 v44, 16, v82
    v_and_b32 v45, 0xffff0000, v82
    v_lshlrev_b32 v46, 16, v83
    v_and_b32 v47, 0xffff0000, v83
    v_add_f32 v32, v32, v40
    v_fmac_f32 v34, v40, v40
    v_add_f32 v33, v33, v41
    v_fmac_f32 v35, v41, v41
    v_add_f32 v32, v32, v42
    v_fmac_f32 v34, v42, v42
    v_add_f32 v33, v33, v43
    v_fmac_f32 v35, v43, v43
    v_add_f32 v32, v32, v44
    v_fmac_f32 v34, v44, v44
    v_add_f32 v33, v33, v45
    v_fmac_f32 v35, v45, v45
    v_add_f32 v32, v32, v46
    v_fmac_f32 v34, v46, v46
    v_add_f32 v33, v33, v47
    v_fmac_f32 v35, v47, v47
    s_barrier
    ds_read_b128 v[80:83], v16 offset:24576
    s_waitcnt lgkmcnt(2)
    v_lshlrev_b32 v40, 16, v96
    v_and_b32 v41, 0xffff0000, v96
    v_lshlrev_b32 v42, 16, v97
    v_and_b32 v43, 0xffff0000, v97
    v_lshlrev_b32 v44, 16, v98
    v_and_b32 v45, 0xffff0000, v98
    v_lshlrev_b32 v46, 16, v99
    v_and_b32 v47, 0xffff0000, v99
    v_add_f32 v32, v32, v40
    v_fmac_f32 v34, v40, v40
    v_add_f32 v33, v33, v41
    v_fmac_f32 v35, v41, v41
    v_add_f32 v32, v32, v42
    v_fmac_f32 v34, v42, v42
    v_add_f32 v33, v33, v43
    v_fmac_f32 v35, v43, v43
    v_add_f32 v32, v32, v44
    v_fmac_f32 v34, v44, v44
    v_add_f32 v33, v33, v45
    v_fmac_f32 v35, v45, v45
    v_add_f32 v32, v32, v46
    v_fmac_f32 v34, v46, v46
    v_add_f32 v33, v33, v47
    v_fmac_f32 v35, v47, v47
    ds_read_b128 v[96:99], v17 offset:24576
    s_waitcnt lgkmcnt(2)
    v_lshlrev_b32 v40, 16, v212
    v_and_b32 v41, 0xffff0000, v212
    v_lshlrev_b32 v42, 16, v213
    v_and_b32 v43, 0xffff0000, v213
    v_lshlrev_b32 v44, 16, v214
    v_and_b32 v45, 0xffff0000, v214
    v_lshlrev_b32 v46, 16, v215
    v_and_b32 v47, 0xffff0000, v215
    v_add_f32 v32, v32, v40
    v_fmac_f32 v34, v40, v40
    v_add_f32 v33, v33, v41
    v_fmac_f32 v35, v41, v41
    v_add_f32 v32, v32, v42
    v_fmac_f32 v34, v42, v42
    v_add_f32 v33, v33, v43
    v_fmac_f32 v35, v43, v43
    v_add_f32 v32, v32, v44
    v_fmac_f32 v34, v44, v44
    v_add_f32 v33, v33, v45
    v_fmac_f32 v35, v45, v45
    v_add_f32 v32, v32, v46
    v_fmac_f32 v34, v46, v46
    v_add_f32 v33, v33, v47
    v_fmac_f32 v35, v47, v47
    ds_read_b128 v[212:215], v18 offset:24576
    s_waitcnt lgkmcnt(2)
    v_lshlrev_b32 v40, 16, v80
    v_and_b32 v41, 0xffff0000, v80
    v_lshlrev_b32 v42, 16, v81
    v_and_b32 v43, 0xffff0000, v81
    v_lshlrev_b32 v44, 16, v82
    v_and_b32 v45, 0xffff0000, v82
    v_lshlrev_b32 v46, 16, v83
    v_and_b32 v47, 0xffff0000, v83
    v_add_f32 v32, v32, v40
    v_fmac_f32 v34, v40, v40
    v_add_f32 v33, v33, v41
    v_fmac_f32 v35, v41, v41
    v_add_f32 v32, v32, v42
    v_fmac_f32 v34, v42, v42
    v_add_f32 v33, v33, v43
    v_fmac_f32 v35, v43, v43
    v_add_f32 v32, v32, v44
    v_fmac_f32 v34, v44, v44
    v_add_f32 v33, v33, v45
    v_fmac_f32 v35, v45, v45
    v_add_f32 v32, v32, v46
    v_fmac_f32 v34, v46, v46
    v_add_f32 v33, v33, v47
    v_fmac_f32 v35, v47, v47
    ds_read_b128 v[80:83], v19 offset:24576
    s_waitcnt lgkmcnt(2)
    v_lshlrev_b32 v40, 16, v96
    v_and_b32 v41, 0xffff0000, v96
    v_lshlrev_b32 v42, 16, v97
    v_and_b32 v43, 0xffff0000, v97
    v_lshlrev_b32 v44, 16, v98
    v_and_b32 v45, 0xffff0000, v98
    v_lshlrev_b32 v46, 16, v99
    v_and_b32 v47, 0xffff0000, v99
    v_add_f32 v32, v32, v40
    v_fmac_f32 v34, v40, v40
    v_add_f32 v33, v33, v41
    v_fmac_f32 v35, v41, v41
    v_add_f32 v32, v32, v42
    v_fmac_f32 v34, v42, v42
    v_add_f32 v33, v33, v43
    v_fmac_f32 v35, v43, v43
    v_add_f32 v32, v32, v44
    v_fmac_f32 v34, v44, v44
    v_add_f32 v33, v33, v45
    v_fmac_f32 v35, v45, v45
    v_add_f32 v32, v32, v46
    v_fmac_f32 v34, v46, v46
    v_add_f32 v33, v33, v47
    v_fmac_f32 v35, v47, v47
    s_barrier
    ds_read_b128 v[96:99], v16 offset:32768
    s_waitcnt lgkmcnt(2)
    v_lshlrev_b32 v40, 16, v212
    v_and_b32 v41, 0xffff0000, v212
    v_lshlrev_b32 v42, 16, v213
    v_and_b32 v43, 0xffff0000, v213
    v_lshlrev_b32 v44, 16, v214
    v_and_b32 v45, 0xffff0000, v214
    v_lshlrev_b32 v46, 16, v215
    v_and_b32 v47, 0xffff0000, v215
    v_add_f32 v32, v32, v40
    v_fmac_f32 v34, v40, v40
    v_add_f32 v33, v33, v41
    v_fmac_f32 v35, v41, v41
    v_add_f32 v32, v32, v42
    v_fmac_f32 v34, v42, v42
    v_add_f32 v33, v33, v43
    v_fmac_f32 v35, v43, v43
    v_add_f32 v32, v32, v44
    v_fmac_f32 v34, v44, v44
    v_add_f32 v33, v33, v45
    v_fmac_f32 v35, v45, v45
    v_add_f32 v32, v32, v46
    v_fmac_f32 v34, v46, v46
    v_add_f32 v33, v33, v47
    v_fmac_f32 v35, v47, v47
    v_min_u32 v113, 31, v1
    v_lshlrev_b32 v113, 6, v113
    s_and_b32 s30, s2, 7
    s_lshl_b32 s30, s30, 11
    s_add_u32 s30, s30, 0x1b01000
    s_cmp_eq_u32 s3, 4
    s_cselect_b32 s30, s30, 0x7ff00000
    buffer_load_dword v112, v113, s[16:19], s30 offen sc1
    ds_read_b128 v[212:215], v17 offset:32768
    s_waitcnt lgkmcnt(2)
    v_lshlrev_b32 v40, 16, v80
    v_and_b32 v41, 0xffff0000, v80
    v_lshlrev_b32 v42, 16, v81
    v_and_b32 v43, 0xffff0000, v81
    v_lshlrev_b32 v44, 16, v82
    v_and_b32 v45, 0xffff0000, v82
    v_lshlrev_b32 v46, 16, v83
    v_and_b32 v47, 0xffff0000, v83
    v_add_f32 v32, v32, v40
    v_fmac_f32 v34, v40, v40
    v_add_f32 v33, v33, v41
    v_fmac_f32 v35, v41, v41
    v_add_f32 v32, v32, v42
    v_fmac_f32 v34, v42, v42
    v_add_f32 v33, v33, v43
    v_fmac_f32 v35, v43, v43
    v_add_f32 v32, v32, v44
    v_fmac_f32 v34, v44, v44
    v_add_f32 v33, v33, v45
    v_fmac_f32 v35, v45, v45
    v_add_f32 v32, v32, v46
    v_fmac_f32 v34, v46, v46
    v_add_f32 v33, v33, v47
    v_fmac_f32 v35, v47, v47
    ds_read_b128 v[80:83], v18 offset:32768
    s_waitcnt lgkmcnt(2)
    v_lshlrev_b32 v40, 16, v96
    v_and_b32 v41, 0xffff0000, v96
    v_lshlrev_b32 v42, 16, v97
    v_and_b32 v43, 0xffff0000, v97
    v_lshlrev_b32 v44, 16, v98
    v_and_b32 v45, 0xffff0000, v98
    v_lshlrev_b32 v46, 16, v99
    v_and_b32 v47, 0xffff0000, v99
    v_add_f32 v32, v32, v40
    v_fmac_f32 v34, v40, v40
    v_add_f32 v33, v33, v41
    v_fmac_f32 v35, v41, v41
    v_add_f32 v32, v32, v42
    v_fmac_f32 v34, v42, v42
    v_add_f32 v33, v33, v43
    v_fmac_f32 v35, v43, v43
    v_add_f32 v32, v32, v44
    v_fmac_f32 v34, v44, v44
    v_add_f32 v33, v33, v45
    v_fmac_f32 v35, v45, v45
    v_add_f32 v32, v32, v46
    v_fmac_f32 v34, v46, v46
    v_add_f32 v33, v33, v47
    v_fmac_f32 v35, v47, v47
    ds_read_b128 v[96:99], v19 offset:32768
    s_waitcnt lgkmcnt(2)
    v_lshlrev_b32 v40, 16, v212
    v_and_b32 v41, 0xffff0000, v212
    v_lshlrev_b32 v42, 16, v213
    v_and_b32 v43, 0xffff0000, v213
    v_lshlrev_b32 v44, 16, v214
    v_and_b32 v45, 0xffff0000, v214
    v_lshlrev_b32 v46, 16, v215
    v_and_b32 v47, 0xffff0000, v215
    v_add_f32 v32, v32, v40
    v_fmac_f32 v34, v40, v40
    v_add_f32 v33, v33, v41
    v_fmac_f32 v35, v41, v41
    v_add_f32 v32, v32, v42
    v_fmac_f32 v34, v42, v42
    v_add_f32 v33, v33, v43
    v_fmac_f32 v35, v43, v43
    v_add_f32 v32, v32, v44
    v_fmac_f32 v34, v44, v44
    v_add_f32 v33, v33, v45
    v_fmac_f32 v35, v45, v45
    v_add_f32 v32, v32, v46
    v_fmac_f32 v34, v46, v46
    v_add_f32 v33, v33, v47
    v_fmac_f32 v35, v47, v47
    s_barrier
    ds_read_b128 v[212:215], v16 offset:40960
    s_waitcnt lgkmcnt(2)
    v_lshlrev_b32 v40, 16, v80
    v_and_b32 v41, 0xffff0000, v80
    v_lshlrev_b32 v42, 16, v81
    v_and_b32 v43, 0xffff0000, v81
    v_lshlrev_b32 v44, 16, v82
    v_and_b32 v45, 0xffff0000, v82
    v_lshlrev_b32 v46, 16, v83
    v_and_b32 v47, 0xffff0000, v83
    v_add_f32 v32, v32, v40
    v_fmac_f32 v34, v40, v40
    v_add_f32 v33, v33, v41
    v_fmac_f32 v35, v41, v41
    v_add_f32 v32, v32, v42
    v_fmac_f32 v34, v42, v42
    v_add_f32 v33, v33, v43
    v_fmac_f32 v35, v43, v43
    v_add_f32 v32, v32, v44
    v_fmac_f32 v34, v44, v44
    v_add_f32 v33, v33, v45
    v_fmac_f32 v35, v45, v45
    v_add_f32 v32, v32, v46
    v_fmac_f32 v34, v46, v46
    v_add_f32 v33, v33, v47
    v_fmac_f32 v35, v47, v47
    ds_read_b128 v[80:83], v17 offset:40960
    s_waitcnt lgkmcnt(2)
    v_lshlrev_b32 v40, 16, v96
    v_and_b32 v41, 0xffff0000, v96
    v_lshlrev_b32 v42, 16, v97
    v_and_b32 v43, 0xffff0000, v97
    v_lshlrev_b32 v44, 16, v98
    v_and_b32 v45, 0xffff0000, v98
    v_lshlrev_b32 v46, 16, v99
    v_and_b32 v47, 0xffff0000, v99
    v_add_f32 v32, v32, v40
    v_fmac_f32 v34, v40, v40
    v_add_f32 v33, v33, v41
    v_fmac_f32 v35, v41, v41
    v_add_f32 v32, v32, v42
    v_fmac_f32 v34, v42, v42
    v_add_f32 v33, v33, v43
    v_fmac_f32 v35, v43, v43
    v_add_f32 v32, v32, v44
    v_fmac_f32 v34, v44, v44
    v_add_f32 v33, v33, v45
    v_fmac_f32 v35, v45, v45
    v_add_f32 v32, v32, v46
    v_fmac_f32 v34, v46, v46
    v_add_f32 v33, v33, v47
    v_fmac_f32 v35, v47, v47
    ds_read_b128 v[96:99], v18 offset:40960
    s_waitcnt lgkmcnt(2)
    v_lshlrev_b32 v40, 16, v212
    v_and_b32 v41, 0xffff0000, v212
    v_lshlrev_b32 v42, 16, v213
    v_and_b32 v43, 0xffff0000, v213
    v_lshlrev_b32 v44, 16, v214
    v_and_b32 v45, 0xffff0000, v214
    v_lshlrev_b32 v46, 16, v215
    v_and_b32 v47, 0xffff0000, v215
    v_add_f32 v32, v32, v40
    v_fmac_f32 v34, v40, v40
    v_add_f32 v33, v33, v41
    v_fmac_f32 v35, v41, v41
    v_add_f32 v32, v32, v42
    v_fmac_f32 v34, v42, v42
    v_add_f32 v33, v33, v43
    v_fmac_f32 v35, v43, v43
    v_add_f32 v32, v32, v44
    v_fmac_f32 v34, v44, v44
    v_add_f32 v33, v33, v45
    v_fmac_f32 v35, v45, v45
    v_add_f32 v32, v32, v46
    v_fmac_f32 v34, v46, v46
    v_add_f32 v33, v33, v47
    v_fmac_f32 v35, v47, v47
    ds_read_b128 v[212:215], v19 offset:40960
    s_waitcnt lgkmcnt(2)
    v_lshlrev_b32 v40, 16, v80
    v_and_b32 v41, 0xffff0000, v80
    v_lshlrev_b32 v42, 16, v81
    v_and_b32 v43, 0xffff0000, v81
    v_lshlrev_b32 v44, 16, v82
    v_and_b32 v45, 0xffff0000, v82
    v_lshlrev_b32 v46, 16, v83
    v_and_b32 v47, 0xffff0000, v83
    v_add_f32 v32, v32, v40
    v_fmac_f32 v34, v40, v40
    v_add_f32 v33, v33, v41
    v_fmac_f32 v35, v41, v41
    v_add_f32 v32, v32, v42
    v_fmac_f32 v34, v42, v42
    v_add_f32 v33, v33, v43
    v_fmac_f32 v35, v43, v43
    v_add_f32 v32, v32, v44
    v_fmac_f32 v34, v44, v44
    v_add_f32 v33, v33, v45
    v_fmac_f32 v35, v45, v45
    v_add_f32 v32, v32, v46
    v_fmac_f32 v34, v46, v46
    v_add_f32 v33, v33, v47
    v_fmac_f32 v35, v47, v47
    s_barrier
    ds_read_b128 v[80:83], v16 offset:49152
    s_waitcnt lgkmcnt(2)
    v_lshlrev_b32 v40, 16, v96
    v_and_b32 v41, 0xffff0000, v96
    v_lshlrev_b32 v42, 16, v97
    v_and_b32 v43, 0xffff0000, v97
    v_lshlrev_b32 v44, 16, v98
    v_and_b32 v45, 0xffff0000, v98
    v_lshlrev_b32 v46, 16, v99
    v_and_b32 v47, 0xffff0000, v99
    v_add_f32 v32, v32, v40
    v_fmac_f32 v34, v40, v40
    v_add_f32 v33, v33, v41
    v_fmac_f32 v35, v41, v41
    v_add_f32 v32, v32, v42
    v_fmac_f32 v34, v42, v42
    v_add_f32 v33, v33, v43
    v_fmac_f32 v35, v43, v43
    v_add_f32 v32, v32, v44
    v_fmac_f32 v34, v44, v44
    v_add_f32 v33, v33, v45
    v_fmac_f32 v35, v45, v45
    v_add_f32 v32, v32, v46
    v_fmac_f32 v34, v46, v46
    v_add_f32 v33, v33, v47
    v_fmac_f32 v35, v47, v47
    ds_read_b128 v[96:99], v17 offset:49152
    s_waitcnt lgkmcnt(2)
    v_lshlrev_b32 v40, 16, v212
    v_and_b32 v41, 0xffff0000, v212
    v_lshlrev_b32 v42, 16, v213
    v_and_b32 v43, 0xffff0000, v213
    v_lshlrev_b32 v44, 16, v214
    v_and_b32 v45, 0xffff0000, v214
    v_lshlrev_b32 v46, 16, v215
    v_and_b32 v47, 0xffff0000, v215
    v_add_f32 v32, v32, v40
    v_fmac_f32 v34, v40, v40
    v_add_f32 v33, v33, v41
    v_fmac_f32 v35, v41, v41
    v_add_f32 v32, v32, v42
    v_fmac_f32 v34, v42, v42
    v_add_f32 v33, v33, v43
    v_fmac_f32 v35, v43, v43
    v_add_f32 v32, v32, v44
    v_fmac_f32 v34, v44, v44
    v_add_f32 v33, v33, v45
    v_fmac_f32 v35, v45, v45
    v_add_f32 v32, v32, v46
    v_fmac_f32 v34, v46, v46
    v_add_f32 v33, v33, v47
    v_fmac_f32 v35, v47, v47
    ds_read_b128 v[212:215], v18 offset:49152
    s_waitcnt lgkmcnt(2)
    v_lshlrev_b32 v40, 16, v80
    v_and_b32 v41, 0xffff0000, v80
    v_lshlrev_b32 v42, 16, v81
    v_and_b32 v43, 0xffff0000, v81
    v_lshlrev_b32 v44, 16, v82
    v_and_b32 v45, 0xffff0000, v82
    v_lshlrev_b32 v46, 16, v83
    v_and_b32 v47, 0xffff0000, v83
    v_add_f32 v32, v32, v40
    v_fmac_f32 v34, v40, v40
    v_add_f32 v33, v33, v41
    v_fmac_f32 v35, v41, v41
    v_add_f32 v32, v32, v42
    v_fmac_f32 v34, v42, v42
    v_add_f32 v33, v33, v43
    v_fmac_f32 v35, v43, v43
    v_add_f32 v32, v32, v44
    v_fmac_f32 v34, v44, v44
    v_add_f32 v33, v33, v45
    v_fmac_f32 v35, v45, v45
    v_add_f32 v32, v32, v46
    v_fmac_f32 v34, v46, v46
    v_add_f32 v33, v33, v47
    v_fmac_f32 v35, v47, v47
    ds_read_b128 v[80:83], v19 offset:49152
    s_waitcnt lgkmcnt(2)
    v_lshlrev_b32 v40, 16, v96
    v_and_b32 v41, 0xffff0000, v96
    v_lshlrev_b32 v42, 16, v97
    v_and_b32 v43, 0xffff0000, v97
    v_lshlrev_b32 v44, 16, v98
    v_and_b32 v45, 0xffff0000, v98
    v_lshlrev_b32 v46, 16, v99
    v_and_b32 v47, 0xffff0000, v99
    v_add_f32 v32, v32, v40
    v_fmac_f32 v34, v40, v40
    v_add_f32 v33, v33, v41
    v_fmac_f32 v35, v41, v41
    v_add_f32 v32, v32, v42
    v_fmac_f32 v34, v42, v42
    v_add_f32 v33, v33, v43
    v_fmac_f32 v35, v43, v43
    v_add_f32 v32, v32, v44
    v_fmac_f32 v34, v44, v44
    v_add_f32 v33, v33, v45
    v_fmac_f32 v35, v45, v45
    v_add_f32 v32, v32, v46
    v_fmac_f32 v34, v46, v46
    v_add_f32 v33, v33, v47
    v_fmac_f32 v35, v47, v47
    s_barrier
    ds_read_b128 v[96:99], v16 offset:57344
    s_waitcnt lgkmcnt(2)
    v_lshlrev_b32 v40, 16, v212
    v_and_b32 v41, 0xffff0000, v212
    v_lshlrev_b32 v42, 16, v213
    v_and_b32 v43, 0xffff0000, v213
    v_lshlrev_b32 v44, 16, v214
    v_and_b32 v45, 0xffff0000, v214
    v_lshlrev_b32 v46, 16, v215
    v_and_b32 v47, 0xffff0000, v215
    v_add_f32 v32, v32, v40
    v_fmac_f32 v34, v40, v40
    v_add_f32 v33, v33, v41
    v_fmac_f32 v35, v41, v41
    v_add_f32 v32, v32, v42
    v_fmac_f32 v34, v42, v42
    v_add_f32 v33, v33, v43
    v_fmac_f32 v35, v43, v43
    v_add_f32 v32, v32, v44
    v_fmac_f32 v34, v44, v44
    v_add_f32 v33, v33, v45
    v_fmac_f32 v35, v45, v45
    v_add_f32 v32, v32, v46
    v_fmac_f32 v34, v46, v46
    v_add_f32 v33, v33, v47
    v_fmac_f32 v35, v47, v47
    ds_read_b128 v[212:215], v17 offset:57344
    s_waitcnt lgkmcnt(2)
    v_lshlrev_b32 v40, 16, v80
    v_and_b32 v41, 0xffff0000, v80
    v_lshlrev_b32 v42, 16, v81
    v_and_b32 v43, 0xffff0000, v81
    v_lshlrev_b32 v44, 16, v82
    v_and_b32 v45, 0xffff0000, v82
    v_lshlrev_b32 v46, 16, v83
    v_and_b32 v47, 0xffff0000, v83
    v_add_f32 v32, v32, v40
    v_fmac_f32 v34, v40, v40
    v_add_f32 v33, v33, v41
    v_fmac_f32 v35, v41, v41
    v_add_f32 v32, v32, v42
    v_fmac_f32 v34, v42, v42
    v_add_f32 v33, v33, v43
    v_fmac_f32 v35, v43, v43
    v_add_f32 v32, v32, v44
    v_fmac_f32 v34, v44, v44
    v_add_f32 v33, v33, v45
    v_fmac_f32 v35, v45, v45
    v_add_f32 v32, v32, v46
    v_fmac_f32 v34, v46, v46
    v_add_f32 v33, v33, v47
    v_fmac_f32 v35, v47, v47
    ds_read_b128 v[80:83], v18 offset:57344
    s_waitcnt lgkmcnt(2)
    v_lshlrev_b32 v40, 16, v96
    v_and_b32 v41, 0xffff0000, v96
    v_lshlrev_b32 v42, 16, v97
    v_and_b32 v43, 0xffff0000, v97
    v_lshlrev_b32 v44, 16, v98
    v_and_b32 v45, 0xffff0000, v98
    v_lshlrev_b32 v46, 16, v99
    v_and_b32 v47, 0xffff0000, v99
    v_add_f32 v32, v32, v40
    v_fmac_f32 v34, v40, v40
    v_add_f32 v33, v33, v41
    v_fmac_f32 v35, v41, v41
    v_add_f32 v32, v32, v42
    v_fmac_f32 v34, v42, v42
    v_add_f32 v33, v33, v43
    v_fmac_f32 v35, v43, v43
    v_add_f32 v32, v32, v44
    v_fmac_f32 v34, v44, v44
    v_add_f32 v33, v33, v45
    v_fmac_f32 v35, v45, v45
    v_add_f32 v32, v32, v46
    v_fmac_f32 v34, v46, v46
    v_add_f32 v33, v33, v47
    v_fmac_f32 v35, v47, v47
    ds_read_b128 v[96:99], v19 offset:57344
    s_waitcnt lgkmcnt(2)
    v_lshlrev_b32 v40, 16, v212
    v_and_b32 v41, 0xffff0000, v212
    v_lshlrev_b32 v42, 16, v213
    v_and_b32 v43, 0xffff0000, v213
    v_lshlrev_b32 v44, 16, v214
    v_and_b32 v45, 0xffff0000, v214
    v_lshlrev_b32 v46, 16, v215
    v_and_b32 v47, 0xffff0000, v215
    v_add_f32 v32, v32, v40
    v_fmac_f32 v34, v40, v40
    v_add_f32 v33, v33, v41
    v_fmac_f32 v35, v41, v41
    v_add_f32 v32, v32, v42
    v_fmac_f32 v34, v42, v42
    v_add_f32 v33, v33, v43
    v_fmac_f32 v35, v43, v43
    v_add_f32 v32, v32, v44
    v_fmac_f32 v34, v44, v44
    v_add_f32 v33, v33, v45
    v_fmac_f32 v35, v45, v45
    v_add_f32 v32, v32, v46
    v_fmac_f32 v34, v46, v46
    v_add_f32 v33, v33, v47
    v_fmac_f32 v35, v47, v47
    s_waitcnt lgkmcnt(1)
    v_lshlrev_b32 v40, 16, v80
    v_and_b32 v41, 0xffff0000, v80
    v_lshlrev_b32 v42, 16, v81
    v_and_b32 v43, 0xffff0000, v81
    v_lshlrev_b32 v44, 16, v82
    v_and_b32 v45, 0xffff0000, v82
    v_lshlrev_b32 v46, 16, v83
    v_and_b32 v47, 0xffff0000, v83
    v_add_f32 v32, v32, v40
    v_fmac_f32 v34, v40, v40
    v_add_f32 v33, v33, v41
    v_fmac_f32 v35, v41, v41
    v_add_f32 v32, v32, v42
    v_fmac_f32 v34, v42, v42
    v_add_f32 v33, v33, v43
    v_fmac_f32 v35, v43, v43
    v_add_f32 v32, v32, v44
    v_fmac_f32 v34, v44, v44
    v_add_f32 v33, v33, v45
    v_fmac_f32 v35, v45, v45
    v_add_f32 v32, v32, v46
    v_fmac_f32 v34, v46, v46
    v_add_f32 v33, v33, v47
    v_fmac_f32 v35, v47, v47
    s_waitcnt lgkmcnt(0)
    v_lshlrev_b32 v40, 16, v96
    v_and_b32 v41, 0xffff0000, v96
    v_lshlrev_b32 v42, 16, v97
    v_and_b32 v43, 0xffff0000, v97
    v_lshlrev_b32 v44, 16, v98
    v_and_b32 v45, 0xffff0000, v98
    v_lshlrev_b32 v46, 16, v99
    v_and_b32 v47, 0xffff0000, v99
    v_add_f32 v32, v32, v40
    v_fmac_f32 v34, v40, v40
    v_add_f32 v33, v33, v41
    v_fmac_f32 v35, v41, v41
    v_add_f32 v32, v32, v42
    v_fmac_f32 v34, v42, v42
    v_add_f32 v33, v33, v43
    v_fmac_f32 v35, v43, v43
    v_add_f32 v32, v32, v44
    v_fmac_f32 v34, v44, v44
    v_add_f32 v33, v33, v45
    v_fmac_f32 v35, v45, v45
    v_add_f32 v32, v32, v46
    v_fmac_f32 v34, v46, v46
    v_add_f32 v33, v33, v47
    v_fmac_f32 v35, v47, v47
    v_add_f32 v32, v32, v33
    v_add_f32 v33, v34, v35
    v_mov_b32 v40, v32
    v_mov_b32 v41, v33
    s_nop 0
    v_permlane32_swap_b32 v32, v40
    v_permlane32_swap_b32 v33, v41
    v_add_f32 v32, v32, v40
    v_add_f32 v33, v33, v41
    v_and_b32 v8, 31, v1
    s_lshl_b32 s30, s26, 7
    v_lshl_add_u32 v8, v8, 2, s30
    v_mul_f32 v32, 0x3b000000, v32
    v_mul_f32 v33, 0x3b000000, v33
    v_fma_f32 v33, -v32, v32, v33
    v_max_f32 v33, 0, v33
    v_add_f32 v33, 0x3727c5ac, v33
    v_rsq_f32 v33, v33
    s_nop 0
    v_mul_f32 v32, -v32, v33
    ds_write_b32 v8, v33 offset:16384
    ds_write_b32 v8, v32 offset:16640
    s_getreg_b32 s31, hwreg(HW_REG_XCC_ID)
    s_and_b32 s31, s31, 15
    s_xor_b32 s31, s31, s56
    s_waitcnt vmcnt(0)
    v_cmp_ne_u32 vcc, s31, v112
    s_cmp_eq_u64 vcc, 0
    s_cselect_b32 s34, 1, 0
    s_mov_b32 s35, s34
    v_mov_b32 v112, s34
    ds_write_b32 v8, v112 offset:16896
    s_waitcnt lgkmcnt(0)
    s_barrier
    s_setprio 0
    v_mov_b32 v113, 0
    ds_read_b32 v112, v113 offset:16896
    s_waitcnt lgkmcnt(0)
    v_readfirstlane_b32 s34, v112
    s_mov_b32 s35, s34
    s_waitcnt vmcnt(0) lgkmcnt(0)
    s_branch L_q_join
L_q_comp:
    s_lshl_b32 s42, s24, 1
    s_add_u32 s42, s42, s40
    s_lshl_b32 s45, s25, 1
    s_add_u32 s45, s45, s26
    s_lshl_b32 s45, s45, 6
    s_add_u32 s45, s45, s42
    s_lshl_b32 s45, s45, 2
    s_add_u32 s45, s45, 0x1b06000
    s_lshl_b32 s43, s25, 2
    s_lshl_b32 s44, s26, 1
    s_add_u32 s43, s43, s44
    s_lshl_b32 s43, s43, 16
    s_lshl_b32 s42, s42, 10
    s_add_u32 s42, s42, s43
    s_add_u32 s43, s42, 0x200000
    s_add_u32 s44, s42, 0x400000
    v_add_u32 v26, 0x10000, v2
    v_and_b32 v27, 15, v1
    v_lshlrev_b32 v27, 4, v27
    v_lshrrev_b32 v8, 5, v1
    v_lshl_add_u32 v27, v8, 8, v27
    v_bfe_u32 v9, v1, 4, 1
    v_lshl_add_u32 v27, v9, 16, v27
    v_and_b32 v9, 31, v1
    s_lshl_b32 s30, s40, 7
    s_lshl_b32 s31, s3, 10
    v_and_b32 v10, 15, v1
    v_bfe_u32 v11, v1, 4, 1
    v_cmp_eq_u32 vcc, v10, v11
    v_mov_b32 v116, s37
    s_nop 0
    v_cndmask_b32 v116, 0, v116, vcc
    v_mov_b32 v117, v116
    v_mov_b32 v118, v116
    v_mov_b32 v119, v116
    v_min_u32 v10, 2, v10
    v_lshrrev_b32 v11, 4, v1
    v_lshlrev_b32 v11, 4, v11
    v_lshl_add_u32 v11, v10, 6, v11
    v_add_u32 v11, s31, v11
    v_lshl_add_u32 v28, v9, 2, s30
    v_lshl_add_u32 v29, v9, 2, s31
    v_lshl_add_u32 v30, v8, 4, s30
    v_lshl_add_u32 v31, v8, 4, s31
    s_barrier
    ds_read_b128 v[80:83], v16 offset:0
    ds_read_b64_tr_b16 v[84:85], v24 offset:0
    ds_read_b64_tr_b16 v[86:87], v24 offset:512
    ds_read_b64_tr_b16 v[88:89], v24 offset:1024
    ds_read_b64_tr_b16 v[90:91], v24 offset:1536
    ds_read_b64_tr_b16 v[92:93], v24 offset:2048
    ds_read_b64_tr_b16 v[94:95], v24 offset:2560
    ds_read_b128 v[96:99], v17 offset:0
    ds_read_b64_tr_b16 v[100:101], v24 offset:6144
    ds_read_b64_tr_b16 v[102:103], v24 offset:6656
    ds_read_b64_tr_b16 v[104:105], v24 offset:7168
    ds_read_b64_tr_b16 v[106:107], v24 offset:7680
    ds_read_b64_tr_b16 v[108:109], v24 offset:8192
    ds_read_b64_tr_b16 v[110:111], v24 offset:8704
    s_waitcnt lgkmcnt(7)
    v_mfma_f32_32x32x16_bf16 v[32:47], v[84:87], v[80:83], 0
    ds_read_b128 v[212:215], v18 offset:0
    ds_read_b64_tr_b16 v[216:217], v24 offset:12288
    v_mfma_f32_16x16x32_bf16 v[200:203], v[84:87], v[116:119], 0
    ds_read_b64_tr_b16 v[218:219], v24 offset:12800
    v_mfma_f32_32x32x16_bf16 v[48:63], v[88:91], v[80:83], 0
    ds_read_b64_tr_b16 v[220:221], v24 offset:13312
    ds_read_b64_tr_b16 v[222:223], v24 offset:13824
    v_mfma_f32_16x16x32_bf16 v[204:207], v[88:91], v[116:119], 0
    ds_read_b64_tr_b16 v[224:225], v24 offset:14336
    v_mfma_f32_32x32x16_bf16 v[64:79], v[80:83], v[92:95], 0
    ds_read_b64_tr_b16 v[226:227], v24 offset:14848
    v_mfma_f32_16x16x32_bf16 v[208:211], v[92:95], v[116:119], 0
    s_waitcnt lgkmcnt(7)
    v_mfma_f32_32x32x16_bf16 v[32:47], v[100:103], v[96:99], v[32:47]
    ds_read_b128 v[80:83], v19 offset:0
    ds_read_b64_tr_b16 v[84:85], v24 offset:18432
    v_mfma_f32_16x16x32_bf16 v[200:203], v[100:103], v[116:119], v[200:203]
    ds_read_b64_tr_b16 v[86:87], v24 offset:18944
    v_mfma_f32_32x32x16_bf16 v[48:63], v[104:107], v[96:99], v[48:63]
    ds_read_b64_tr_b16 v[88:89], v24 offset:19456
    ds_read_b64_tr_b16 v[90:91], v24 offset:19968
    v_mfma_f32_16x16x32_bf16 v[204:207], v[104:107], v[116:119], v[204:207]
    ds_read_b64_tr_b16 v[92:93], v24 offset:20480
    v_mfma_f32_32x32x16_bf16 v[64:79], v[96:99], v[108:111], v[64:79]
    ds_read_b64_tr_b16 v[94:95], v24 offset:20992
    v_mfma_f32_16x16x32_bf16 v[208:211], v[108:111], v[116:119], v[208:211]
    s_waitcnt lgkmcnt(7)
    v_mfma_f32_32x32x16_bf16 v[32:47], v[216:219], v[212:215], v[32:47]
    s_barrier
    ds_read_b128 v[96:99], v16 offset:8192
    ds_read_b64_tr_b16 v[100:101], v24 offset:24576
    v_mfma_f32_16x16x32_bf16 v[200:203], v[216:219], v[116:119], v[200:203]
    ds_read_b64_tr_b16 v[102:103], v24 offset:25088
    v_mfma_f32_32x32x16_bf16 v[48:63], v[220:223], v[212:215], v[48:63]
    ds_read_b64_tr_b16 v[104:105], v24 offset:25600
    ds_read_b64_tr_b16 v[106:107], v24 offset:26112
    v_mfma_f32_16x16x32_bf16 v[204:207], v[220:223], v[116:119], v[204:207]
    ds_read_b64_tr_b16 v[108:109], v24 offset:26624
    v_mfma_f32_32x32x16_bf16 v[64:79], v[212:215], v[224:227], v[64:79]
    ds_read_b64_tr_b16 v[110:111], v24 offset:27136
    v_mfma_f32_16x16x32_bf16 v[208:211], v[224:227], v[116:119], v[208:211]
    s_waitcnt lgkmcnt(7)
    v_mfma_f32_32x32x16_bf16 v[32:47], v[84:87], v[80:83], v[32:47]
    ds_read_b128 v[212:215], v17 offset:8192
    ds_read_b64_tr_b16 v[216:217], v24 offset:30720
    v_mfma_f32_16x16x32_bf16 v[200:203], v[84:87], v[116:119], v[200:203]
    ds_read_b64_tr_b16 v[218:219], v24 offset:31232
    v_mfma_f32_32x32x16_bf16 v[48:63], v[88:91], v[80:83], v[48:63]
    ds_read_b64_tr_b16 v[220:221], v24 offset:31744
    ds_read_b64_tr_b16 v[222:223], v24 offset:32256
    v_mfma_f32_16x16x32_bf16 v[204:207], v[88:91], v[116:119], v[204:207]
    ds_read_b64_tr_b16 v[224:225], v24 offset:32768
    v_mfma_f32_32x32x16_bf16 v[64:79], v[80:83], v[92:95], v[64:79]
    ds_read_b64_tr_b16 v[226:227], v24 offset:33280
    v_mfma_f32_16x16x32_bf16 v[208:211], v[92:95], v[116:119], v[208:211]
    s_waitcnt lgkmcnt(7)
    v_mfma_f32_32x32x16_bf16 v[32:47], v[100:103], v[96:99], v[32:47]
    ds_read_b128 v[80:83], v18 offset:8192
    ds_read_b64_tr_b16 v[84:85], v24 offset:36864
    v_mfma_f32_16x16x32_bf16 v[200:203], v[100:103], v[116:119], v[200:203]
    ds_read_b64_tr_b16 v[86:87], v24 offset:37376
    v_mfma_f32_32x32x16_bf16 v[48:63], v[104:107], v[96:99], v[48:63]
    ds_read_b64_tr_b16 v[88:89], v24 offset:37888
    ds_read_b64_tr_b16 v[90:91], v24 offset:38400
    v_mfma_f32_16x16x32_bf16 v[204:207], v[104:107], v[116:119], v[204:207]
    ds_read_b64_tr_b16 v[92:93], v24 offset:38912
    v_mfma_f32_32x32x16_bf16 v[64:79], v[96:99], v[108:111], v[64:79]
    ds_read_b64_tr_b16 v[94:95], v24 offset:39424
    v_mfma_f32_16x16x32_bf16 v[208:211], v[108:111], v[116:119], v[208:211]
    s_waitcnt lgkmcnt(7)
    v_mfma_f32_32x32x16_bf16 v[32:47], v[216:219], v[212:215], v[32:47]
    ds_read_b128 v[96:99], v19 offset:8192
    ds_read_b64_tr_b16 v[100:101], v24 offset:43008
    v_mfma_f32_16x16x32_bf16 v[200:203], v[216:219], v[116:119], v[200:203]
    ds_read_b64_tr_b16 v[102:103], v24 offset:43520
    v_mfma_f32_32x32x16_bf16 v[48:63], v[220:223], v[212:215], v[48:63]
    ds_read_b64_tr_b16 v[104:105], v24 offset:44032
    ds_read_b64_tr_b16 v[106:107], v24 offset:44544
    v_mfma_f32_16x16x32_bf16 v[204:207], v[220:223], v[116:119], v[204:207]
    ds_read_b64_tr_b16 v[108:109], v24 offset:45056
    v_mfma_f32_32x32x16_bf16 v[64:79], v[212:215], v[224:227], v[64:79]
    ds_read_b64_tr_b16 v[110:111], v24 offset:45568
    v_mfma_f32_16x16x32_bf16 v[208:211], v[224:227], v[116:119], v[208:211]
    s_waitcnt lgkmcnt(7)
    v_mfma_f32_32x32x16_bf16 v[32:47], v[84:87], v[80:83], v[32:47]
    s_barrier
    ds_read_b128 v[212:215], v16 offset:16384
    ds_read_b64_tr_b16 v[216:217], v25 offset:0
    v_mfma_f32_16x16x32_bf16 v[200:203], v[84:87], v[116:119], v[200:203]
    ds_read_b64_tr_b16 v[218:219], v25 offset:512
    v_mfma_f32_32x32x16_bf16 v[48:63], v[88:91], v[80:83], v[48:63]
    ds_read_b64_tr_b16 v[220:221], v25 offset:1024
    ds_read_b64_tr_b16 v[222:223], v25 offset:1536
    v_mfma_f32_16x16x32_bf16 v[204:207], v[88:91], v[116:119], v[204:207]
    ds_read_b64_tr_b16 v[224:225], v25 offset:2048
    v_mfma_f32_32x32x16_bf16 v[64:79], v[80:83], v[92:95], v[64:79]
    ds_read_b64_tr_b16 v[226:227], v25 offset:2560
    v_mfma_f32_16x16x32_bf16 v[208:211], v[92:95], v[116:119], v[208:211]
    s_waitcnt lgkmcnt(7)
    v_mfma_f32_32x32x16_bf16 v[32:47], v[100:103], v[96:99], v[32:47]
    ds_read_b128 v[80:83], v17 offset:16384
    ds_read_b64_tr_b16 v[84:85], v25 offset:6144
    v_mfma_f32_16x16x32_bf16 v[200:203], v[100:103], v[116:119], v[200:203]
    ds_read_b64_tr_b16 v[86:87], v25 offset:6656
    v_mfma_f32_32x32x16_bf16 v[48:63], v[104:107], v[96:99], v[48:63]
    ds_read_b64_tr_b16 v[88:89], v25 offset:7168
    ds_read_b64_tr_b16 v[90:91], v25 offset:7680
    v_mfma_f32_16x16x32_bf16 v[204:207], v[104:107], v[116:119], v[204:207]
    ds_read_b64_tr_b16 v[92:93], v25 offset:8192
    v_mfma_f32_32x32x16_bf16 v[64:79], v[96:99], v[108:111], v[64:79]
    ds_read_b64_tr_b16 v[94:95], v25 offset:8704
    v_mfma_f32_16x16x32_bf16 v[208:211], v[108:111], v[116:119], v[208:211]
    s_waitcnt lgkmcnt(7)
    v_mfma_f32_32x32x16_bf16 v[32:47], v[216:219], v[212:215], v[32:47]
    ds_read_b128 v[96:99], v18 offset:16384
    ds_read_b64_tr_b16 v[100:101], v25 offset:12288
    v_mfma_f32_16x16x32_bf16 v[200:203], v[216:219], v[116:119], v[200:203]
    ds_read_b64_tr_b16 v[102:103], v25 offset:12800
    v_mfma_f32_32x32x16_bf16 v[48:63], v[220:223], v[212:215], v[48:63]
    ds_read_b64_tr_b16 v[104:105], v25 offset:13312
    ds_read_b64_tr_b16 v[106:107], v25 offset:13824
    v_mfma_f32_16x16x32_bf16 v[204:207], v[220:223], v[116:119], v[204:207]
    ds_read_b64_tr_b16 v[108:109], v25 offset:14336
    v_mfma_f32_32x32x16_bf16 v[64:79], v[212:215], v[224:227], v[64:79]
    ds_read_b64_tr_b16 v[110:111], v25 offset:14848
    v_mfma_f32_16x16x32_bf16 v[208:211], v[224:227], v[116:119], v[208:211]
    s_waitcnt lgkmcnt(7)
    v_mfma_f32_32x32x16_bf16 v[32:47], v[84:87], v[80:83], v[32:47]
    ds_read_b128 v[212:215], v19 offset:16384
    ds_read_b64_tr_b16 v[216:217], v25 offset:18432
    v_mfma_f32_16x16x32_bf16 v[200:203], v[84:87], v[116:119], v[200:203]
    ds_read_b64_tr_b16 v[218:219], v25 offset:18944
    v_mfma_f32_32x32x16_bf16 v[48:63], v[88:91], v[80:83], v[48:63]
    ds_read_b64_tr_b16 v[220:221], v25 offset:19456
    ds_read_b64_tr_b16 v[222:223], v25 offset:19968
    v_mfma_f32_16x16x32_bf16 v[204:207], v[88:91], v[116:119], v[204:207]
    ds_read_b64_tr_b16 v[224:225], v25 offset:20480
    v_mfma_f32_32x32x16_bf16 v[64:79], v[80:83], v[92:95], v[64:79]
    ds_read_b64_tr_b16 v[226:227], v25 offset:20992
    v_mfma_f32_16x16x32_bf16 v[208:211], v[92:95], v[116:119], v[208:211]
    s_waitcnt lgkmcnt(7)
    v_mfma_f32_32x32x16_bf16 v[32:47], v[100:103], v[96:99], v[32:47]
    s_barrier
    ds_read_b128 v[80:83], v16 offset:24576
    ds_read_b64_tr_b16 v[84:85], v25 offset:24576
    v_mfma_f32_16x16x32_bf16 v[200:203], v[100:103], v[116:119], v[200:203]
    ds_read_b64_tr_b16 v[86:87], v25 offset:25088
    v_mfma_f32_32x32x16_bf16 v[48:63], v[104:107], v[96:99], v[48:63]
    ds_read_b64_tr_b16 v[88:89], v25 offset:25600
    ds_read_b64_tr_b16 v[90:91], v25 offset:26112
    v_mfma_f32_16x16x32_bf16 v[204:207], v[104:107], v[116:119], v[204:207]
    ds_read_b64_tr_b16 v[92:93], v25 offset:26624
    v_mfma_f32_32x32x16_bf16 v[64:79], v[96:99], v[108:111], v[64:79]
    ds_read_b64_tr_b16 v[94:95], v25 offset:27136
    v_mfma_f32_16x16x32_bf16 v[208:211], v[108:111], v[116:119], v[208:211]
    s_waitcnt lgkmcnt(7)
    v_mfma_f32_32x32x16_bf16 v[32:47], v[216:219], v[212:215], v[32:47]
    ds_read_b128 v[96:99], v17 offset:24576
    ds_read_b64_tr_b16 v[100:101], v25 offset:30720
    v_mfma_f32_16x16x32_bf16 v[200:203], v[216:219], v[116:119], v[200:203]
    ds_read_b64_tr_b16 v[102:103], v25 offset:31232
    v_mfma_f32_32x32x16_bf16 v[48:63], v[220:223], v[212:215], v[48:63]
    ds_read_b64_tr_b16 v[104:105], v25 offset:31744
    ds_read_b64_tr_b16 v[106:107], v25 offset:32256
    v_mfma_f32_16x16x32_bf16 v[204:207], v[220:223], v[116:119], v[204:207]
    ds_read_b64_tr_b16 v[108:109], v25 offset:32768
    v_mfma_f32_32x32x16_bf16 v[64:79], v[212:215], v[224:227], v[64:79]
    ds_read_b64_tr_b16 v[110:111], v25 offset:33280
    v_mfma_f32_16x16x32_bf16 v[208:211], v[224:227], v[116:119], v[208:211]
    s_waitcnt lgkmcnt(7)
    v_mfma_f32_32x32x16_bf16 v[32:47], v[84:87], v[80:83], v[32:47]
    ds_read_b128 v[212:215], v18 offset:24576
    ds_read_b64_tr_b16 v[216:217], v25 offset:36864
    v_mfma_f32_16x16x32_bf16 v[200:203], v[84:87], v[116:119], v[200:203]
    ds_read_b64_tr_b16 v[218:219], v25 offset:37376
    v_mfma_f32_32x32x16_bf16 v[48:63], v[88:91], v[80:83], v[48:63]
    ds_read_b64_tr_b16 v[220:221], v25 offset:37888
    ds_read_b64_tr_b16 v[222:223], v25 offset:38400
    v_mfma_f32_16x16x32_bf16 v[204:207], v[88:91], v[116:119], v[204:207]
    ds_read_b64_tr_b16 v[224:225], v25 offset:38912
    v_mfma_f32_32x32x16_bf16 v[64:79], v[80:83], v[92:95], v[64:79]
    ds_read_b64_tr_b16 v[226:227], v25 offset:39424
    v_mfma_f32_16x16x32_bf16 v[208:211], v[92:95], v[116:119], v[208:211]
    s_waitcnt lgkmcnt(7)
    v_mfma_f32_32x32x16_bf16 v[32:47], v[100:103], v[96:99], v[32:47]
    ds_read_b128 v[80:83], v19 offset:24576
    ds_read_b64_tr_b16 v[84:85], v25 offset:43008
    v_mfma_f32_16x16x32_bf16 v[200:203], v[100:103], v[116:119], v[200:203]
    ds_read_b64_tr_b16 v[86:87], v25 offset:43520
    v_mfma_f32_32x32x16_bf16 v[48:63], v[104:107], v[96:99], v[48:63]
    ds_read_b64_tr_b16 v[88:89], v25 offset:44032
    ds_read_b64_tr_b16 v[90:91], v25 offset:44544
    v_mfma_f32_16x16x32_bf16 v[204:207], v[104:107], v[116:119], v[204:207]
    ds_read_b64_tr_b16 v[92:93], v25 offset:45056
    v_mfma_f32_32x32x16_bf16 v[64:79], v[96:99], v[108:111], v[64:79]
    ds_read_b64_tr_b16 v[94:95], v25 offset:45568
    v_mfma_f32_16x16x32_bf16 v[208:211], v[108:111], v[116:119], v[208:211]
    s_waitcnt lgkmcnt(7)
    v_mfma_f32_32x32x16_bf16 v[32:47], v[216:219], v[212:215], v[32:47]
    s_barrier
    ds_read_b128 v[96:99], v16 offset:32768
    ds_read_b64_tr_b16 v[100:101], v24 offset:0
    v_mfma_f32_16x16x32_bf16 v[200:203], v[216:219], v[116:119], v[200:203]
    ds_read_b64_tr_b16 v[102:103], v24 offset:512
    v_mfma_f32_32x32x16_bf16 v[48:63], v[220:223], v[212:215], v[48:63]
    ds_read_b64_tr_b16 v[104:105], v24 offset:1024
    ds_read_b64_tr_b16 v[106:107], v24 offset:1536
    v_mfma_f32_16x16x32_bf16 v[204:207], v[220:223], v[116:119], v[204:207]
    ds_read_b64_tr_b16 v[108:109], v24 offset:2048
    v_mfma_f32_32x32x16_bf16 v[64:79], v[212:215], v[224:227], v[64:79]
    ds_read_b64_tr_b16 v[110:111], v24 offset:2560
    v_mfma_f32_16x16x32_bf16 v[208:211], v[224:227], v[116:119], v[208:211]
    s_waitcnt lgkmcnt(7)
    v_mfma_f32_32x32x16_bf16 v[32:47], v[84:87], v[80:83], v[32:47]
    ds_read_b128 v[212:215], v17 offset:32768
    ds_read_b64_tr_b16 v[216:217], v24 offset:6144
    v_mfma_f32_16x16x32_bf16 v[200:203], v[84:87], v[116:119], v[200:203]
    ds_read_b64_tr_b16 v[218:219], v24 offset:6656
    v_mfma_f32_32x32x16_bf16 v[48:63], v[88:91], v[80:83], v[48:63]
    ds_read_b64_tr_b16 v[220:221], v24 offset:7168
    ds_read_b64_tr_b16 v[222:223], v24 offset:7680
    v_mfma_f32_16x16x32_bf16 v[204:207], v[88:91], v[116:119], v[204:207]
    ds_read_b64_tr_b16 v[224:225], v24 offset:8192
    v_mfma_f32_32x32x16_bf16 v[64:79], v[80:83], v[92:95], v[64:79]
    ds_read_b64_tr_b16 v[226:227], v24 offset:8704
    v_mfma_f32_16x16x32_bf16 v[208:211], v[92:95], v[116:119], v[208:211]
    s_waitcnt lgkmcnt(7)
    v_mfma_f32_32x32x16_bf16 v[32:47], v[100:103], v[96:99], v[32:47]
    ds_read_b128 v[80:83], v18 offset:32768
    ds_read_b64_tr_b16 v[84:85], v24 offset:12288
    v_mfma_f32_16x16x32_bf16 v[200:203], v[100:103], v[116:119], v[200:203]
    ds_read_b64_tr_b16 v[86:87], v24 offset:12800
    v_mfma_f32_32x32x16_bf16 v[48:63], v[104:107], v[96:99], v[48:63]
    ds_read_b64_tr_b16 v[88:89], v24 offset:13312
    ds_read_b64_tr_b16 v[90:91], v24 offset:13824
    v_mfma_f32_16x16x32_bf16 v[204:207], v[104:107], v[116:119], v[204:207]
    ds_read_b64_tr_b16 v[92:93], v24 offset:14336
    v_mfma_f32_32x32x16_bf16 v[64:79], v[96:99], v[108:111], v[64:79]
    ds_read_b64_tr_b16 v[94:95], v24 offset:14848
    v_mfma_f32_16x16x32_bf16 v[208:211], v[108:111], v[116:119], v[208:211]
    s_waitcnt lgkmcnt(7)
    v_mfma_f32_32x32x16_bf16 v[32:47], v[216:219], v[212:215], v[32:47]
    ds_read_b128 v[96:99], v19 offset:32768
    ds_read_b64_tr_b16 v[100:101], v24 offset:18432
    v_mfma_f32_16x16x32_bf16 v[200:203], v[216:219], v[116:119], v[200:203]
    ds_read_b64_tr_b16 v[102:103], v24 offset:18944
    v_mfma_f32_32x32x16_bf16 v[48:63], v[220:223], v[212:215], v[48:63]
    ds_read_b64_tr_b16 v[104:105], v24 offset:19456
    ds_read_b64_tr_b16 v[106:107], v24 offset:19968
    v_mfma_f32_16x16x32_bf16 v[204:207], v[220:223], v[116:119], v[204:207]
    ds_read_b64_tr_b16 v[108:109], v24 offset:20480
    v_mfma_f32_32x32x16_bf16 v[64:79], v[212:215], v[224:227], v[64:79]
    ds_read_b64_tr_b16 v[110:111], v24 offset:20992
    v_mfma_f32_16x16x32_bf16 v[208:211], v[224:227], v[116:119], v[208:211]
    s_waitcnt lgkmcnt(7)
    v_mfma_f32_32x32x16_bf16 v[32:47], v[84:87], v[80:83], v[32:47]
    s_barrier
    ds_read_b128 v[212:215], v16 offset:40960
    ds_read_b64_tr_b16 v[216:217], v24 offset:24576
    v_mfma_f32_16x16x32_bf16 v[200:203], v[84:87], v[116:119], v[200:203]
    ds_read_b64_tr_b16 v[218:219], v24 offset:25088
    v_mfma_f32_32x32x16_bf16 v[48:63], v[88:91], v[80:83], v[48:63]
    ds_read_b64_tr_b16 v[220:221], v24 offset:25600
    ds_read_b64_tr_b16 v[222:223], v24 offset:26112
    v_mfma_f32_16x16x32_bf16 v[204:207], v[88:91], v[116:119], v[204:207]
    ds_read_b64_tr_b16 v[224:225], v24 offset:26624
    v_mfma_f32_32x32x16_bf16 v[64:79], v[80:83], v[92:95], v[64:79]
    ds_read_b64_tr_b16 v[226:227], v24 offset:27136
    v_mfma_f32_16x16x32_bf16 v[208:211], v[92:95], v[116:119], v[208:211]
    s_waitcnt lgkmcnt(7)
    v_mfma_f32_32x32x16_bf16 v[32:47], v[100:103], v[96:99], v[32:47]
    ds_read_b128 v[80:83], v17 offset:40960
    ds_read_b64_tr_b16 v[84:85], v24 offset:30720
    v_mfma_f32_16x16x32_bf16 v[200:203], v[100:103], v[116:119], v[200:203]
    ds_read_b64_tr_b16 v[86:87], v24 offset:31232
    v_mfma_f32_32x32x16_bf16 v[48:63], v[104:107], v[96:99], v[48:63]
    ds_read_b64_tr_b16 v[88:89], v24 offset:31744
    ds_read_b64_tr_b16 v[90:91], v24 offset:32256
    v_mfma_f32_16x16x32_bf16 v[204:207], v[104:107], v[116:119], v[204:207]
    ds_read_b64_tr_b16 v[92:93], v24 offset:32768
    v_mfma_f32_32x32x16_bf16 v[64:79], v[96:99], v[108:111], v[64:79]
    ds_read_b64_tr_b16 v[94:95], v24 offset:33280
    v_mfma_f32_16x16x32_bf16 v[208:211], v[108:111], v[116:119], v[208:211]
    s_waitcnt lgkmcnt(7)
    v_mfma_f32_32x32x16_bf16 v[32:47], v[216:219], v[212:215], v[32:47]
    ds_read_b128 v[96:99], v18 offset:40960
    ds_read_b64_tr_b16 v[100:101], v24 offset:36864
    v_mfma_f32_16x16x32_bf16 v[200:203], v[216:219], v[116:119], v[200:203]
    ds_read_b64_tr_b16 v[102:103], v24 offset:37376
    v_mfma_f32_32x32x16_bf16 v[48:63], v[220:223], v[212:215], v[48:63]
    ds_read_b64_tr_b16 v[104:105], v24 offset:37888
    ds_read_b64_tr_b16 v[106:107], v24 offset:38400
    v_mfma_f32_16x16x32_bf16 v[204:207], v[220:223], v[116:119], v[204:207]
    ds_read_b64_tr_b16 v[108:109], v24 offset:38912
    v_mfma_f32_32x32x16_bf16 v[64:79], v[212:215], v[224:227], v[64:79]
    ds_read_b64_tr_b16 v[110:111], v24 offset:39424
    v_mfma_f32_16x16x32_bf16 v[208:211], v[224:227], v[116:119], v[208:211]
    s_waitcnt lgkmcnt(7)
    v_mfma_f32_32x32x16_bf16 v[32:47], v[84:87], v[80:83], v[32:47]
    ds_read_b128 v[212:215], v19 offset:40960
    ds_read_b64_tr_b16 v[216:217], v24 offset:43008
    v_mfma_f32_16x16x32_bf16 v[200:203], v[84:87], v[116:119], v[200:203]
    ds_read_b64_tr_b16 v[218:219], v24 offset:43520
    v_mfma_f32_32x32x16_bf16 v[48:63], v[88:91], v[80:83], v[48:63]
    ds_read_b64_tr_b16 v[220:221], v24 offset:44032
    ds_read_b64_tr_b16 v[222:223], v24 offset:44544
    v_mfma_f32_16x16x32_bf16 v[204:207], v[88:91], v[116:119], v[204:207]
    ds_read_b64_tr_b16 v[224:225], v24 offset:45056
    v_mfma_f32_32x32x16_bf16 v[64:79], v[80:83], v[92:95], v[64:79]
    ds_read_b64_tr_b16 v[226:227], v24 offset:45568
    v_mfma_f32_16x16x32_bf16 v[208:211], v[92:95], v[116:119], v[208:211]
    s_waitcnt lgkmcnt(7)
    v_mfma_f32_32x32x16_bf16 v[32:47], v[100:103], v[96:99], v[32:47]
    s_barrier
    ds_read_b128 v[80:83], v16 offset:49152
    ds_read_b64_tr_b16 v[84:85], v25 offset:0
    v_mfma_f32_16x16x32_bf16 v[200:203], v[100:103], v[116:119], v[200:203]
    ds_read_b64_tr_b16 v[86:87], v25 offset:512
    v_mfma_f32_32x32x16_bf16 v[48:63], v[104:107], v[96:99], v[48:63]
    ds_read_b64_tr_b16 v[88:89], v25 offset:1024
    ds_read_b64_tr_b16 v[90:91], v25 offset:1536
    v_mfma_f32_16x16x32_bf16 v[204:207], v[104:107], v[116:119], v[204:207]
    ds_read_b64_tr_b16 v[92:93], v25 offset:2048
    v_mfma_f32_32x32x16_bf16 v[64:79], v[96:99], v[108:111], v[64:79]
    ds_read_b64_tr_b16 v[94:95], v25 offset:2560
    v_mfma_f32_16x16x32_bf16 v[208:211], v[108:111], v[116:119], v[208:211]
    s_waitcnt lgkmcnt(7)
    v_mfma_f32_32x32x16_bf16 v[32:47], v[216:219], v[212:215], v[32:47]
    ds_read_b128 v[96:99], v17 offset:49152
    ds_read_b64_tr_b16 v[100:101], v25 offset:6144
    v_mfma_f32_16x16x32_bf16 v[200:203], v[216:219], v[116:119], v[200:203]
    ds_read_b64_tr_b16 v[102:103], v25 offset:6656
    v_mfma_f32_32x32x16_bf16 v[48:63], v[220:223], v[212:215], v[48:63]
    ds_read_b64_tr_b16 v[104:105], v25 offset:7168
    ds_read_b64_tr_b16 v[106:107], v25 offset:7680
    v_mfma_f32_16x16x32_bf16 v[204:207], v[220:223], v[116:119], v[204:207]
    ds_read_b64_tr_b16 v[108:109], v25 offset:8192
    v_mfma_f32_32x32x16_bf16 v[64:79], v[212:215], v[224:227], v[64:79]
    ds_read_b64_tr_b16 v[110:111], v25 offset:8704
    v_mfma_f32_16x16x32_bf16 v[208:211], v[224:227], v[116:119], v[208:211]
    buffer_load_dwordx4 v[252:255], v2, s[16:19], s42 offen sc1
    buffer_load_dwordx4 v[252:255], v26, s[16:19], s42 offen sc1
    s_waitcnt lgkmcnt(7)
    v_mfma_f32_32x32x16_bf16 v[32:47], v[84:87], v[80:83], v[32:47]
    ds_read_b128 v[212:215], v18 offset:49152
    ds_read_b64_tr_b16 v[216:217], v25 offset:12288
    v_mfma_f32_16x16x32_bf16 v[200:203], v[84:87], v[116:119], v[200:203]
    ds_read_b64_tr_b16 v[218:219], v25 offset:12800
    v_mfma_f32_32x32x16_bf16 v[48:63], v[88:91], v[80:83], v[48:63]
    ds_read_b64_tr_b16 v[220:221], v25 offset:13312
    ds_read_b64_tr_b16 v[222:223], v25 offset:13824
    v_mfma_f32_16x16x32_bf16 v[204:207], v[88:91], v[116:119], v[204:207]
    ds_read_b64_tr_b16 v[224:225], v25 offset:14336
    v_mfma_f32_32x32x16_bf16 v[64:79], v[80:83], v[92:95], v[64:79]
    ds_read_b64_tr_b16 v[226:227], v25 offset:14848
    v_mfma_f32_16x16x32_bf16 v[208:211], v[92:95], v[116:119], v[208:211]
    s_cmp_lt_u32 s24, 32
    s_cselect_b32 s32, s43, 0x7ff00000
    s_cselect_b32 s33, s44, 0x7ff00000
    buffer_load_dwordx4 v[252:255], v2, s[16:19], s32 offen sc1
    buffer_load_dwordx4 v[252:255], v26, s[16:19], s32 offen sc1
    buffer_load_dwordx4 v[252:255], v27, s[16:19], s33 offen sc1
    buffer_load_dwordx4 v[252:255], v27, s[16:19], s33 offen offset:512 sc1
    s_waitcnt lgkmcnt(7)
    v_mfma_f32_32x32x16_bf16 v[32:47], v[100:103], v[96:99], v[32:47]
    ds_read_b128 v[80:83], v19 offset:49152
    ds_read_b64_tr_b16 v[84:85], v25 offset:18432
    v_mfma_f32_16x16x32_bf16 v[200:203], v[100:103], v[116:119], v[200:203]
    ds_read_b64_tr_b16 v[86:87], v25 offset:18944
    v_mfma_f32_32x32x16_bf16 v[48:63], v[104:107], v[96:99], v[48:63]
    ds_read_b64_tr_b16 v[88:89], v25 offset:19456
    ds_read_b64_tr_b16 v[90:91], v25 offset:19968
    v_mfma_f32_16x16x32_bf16 v[204:207], v[104:107], v[116:119], v[204:207]
    ds_read_b64_tr_b16 v[92:93], v25 offset:20480
    v_mfma_f32_32x32x16_bf16 v[64:79], v[96:99], v[108:111], v[64:79]
    ds_read_b64_tr_b16 v[94:95], v25 offset:20992
    v_mfma_f32_16x16x32_bf16 v[208:211], v[108:111], v[116:119], v[208:211]
    s_waitcnt lgkmcnt(7)
    v_mfma_f32_32x32x16_bf16 v[32:47], v[216:219], v[212:215], v[32:47]
    s_barrier
    ds_read_b128 v[96:99], v16 offset:57344
    ds_read_b64_tr_b16 v[100:101], v25 offset:24576
    v_mfma_f32_16x16x32_bf16 v[200:203], v[216:219], v[116:119], v[200:203]
    ds_read_b64_tr_b16 v[102:103], v25 offset:25088
    v_mfma_f32_32x32x16_bf16 v[48:63], v[220:223], v[212:215], v[48:63]
    ds_read_b64_tr_b16 v[104:105], v25 offset:25600
    ds_read_b64_tr_b16 v[106:107], v25 offset:26112
    v_mfma_f32_16x16x32_bf16 v[204:207], v[220:223], v[116:119], v[204:207]
    ds_read_b64_tr_b16 v[108:109], v25 offset:26624
    v_mfma_f32_32x32x16_bf16 v[64:79], v[212:215], v[224:227], v[64:79]
    ds_read_b64_tr_b16 v[110:111], v25 offset:27136
    v_mfma_f32_16x16x32_bf16 v[208:211], v[224:227], v[116:119], v[208:211]
    s_waitcnt lgkmcnt(7)
    v_mfma_f32_32x32x16_bf16 v[32:47], v[84:87], v[80:83], v[32:47]
    ds_read_b128 v[212:215], v17 offset:57344
    ds_read_b64_tr_b16 v[216:217], v25 offset:30720
    v_mfma_f32_16x16x32_bf16 v[200:203], v[84:87], v[116:119], v[200:203]
    ds_read_b64_tr_b16 v[218:219], v25 offset:31232
    v_mfma_f32_32x32x16_bf16 v[48:63], v[88:91], v[80:83], v[48:63]
    ds_read_b64_tr_b16 v[220:221], v25 offset:31744
    ds_read_b64_tr_b16 v[222:223], v25 offset:32256
    v_mfma_f32_16x16x32_bf16 v[204:207], v[88:91], v[116:119], v[204:207]
    ds_read_b64_tr_b16 v[224:225], v25 offset:32768
    v_mfma_f32_32x32x16_bf16 v[64:79], v[80:83], v[92:95], v[64:79]
    ds_read_b64_tr_b16 v[226:227], v25 offset:33280
    v_mfma_f32_16x16x32_bf16 v[208:211], v[92:95], v[116:119], v[208:211]
    s_waitcnt lgkmcnt(7)
    v_mfma_f32_32x32x16_bf16 v[32:47], v[100:103], v[96:99], v[32:47]
    ds_read_b128 v[80:83], v18 offset:57344
    ds_read_b64_tr_b16 v[84:85], v25 offset:36864
    v_mfma_f32_16x16x32_bf16 v[200:203], v[100:103], v[116:119], v[200:203]
    ds_read_b64_tr_b16 v[86:87], v25 offset:37376
    v_mfma_f32_32x32x16_bf16 v[48:63], v[104:107], v[96:99], v[48:63]
    ds_read_b64_tr_b16 v[88:89], v25 offset:37888
    ds_read_b64_tr_b16 v[90:91], v25 offset:38400
    v_mfma_f32_16x16x32_bf16 v[204:207], v[104:107], v[116:119], v[204:207]
    ds_read_b64_tr_b16 v[92:93], v25 offset:38912
    v_mfma_f32_32x32x16_bf16 v[64:79], v[96:99], v[108:111], v[64:79]
    ds_read_b64_tr_b16 v[94:95], v25 offset:39424
    v_mfma_f32_16x16x32_bf16 v[208:211], v[108:111], v[116:119], v[208:211]
    s_waitcnt lgkmcnt(7)
    v_mfma_f32_32x32x16_bf16 v[32:47], v[216:219], v[212:215], v[32:47]
    ds_read_b128 v[96:99], v19 offset:57344
    ds_read_b64_tr_b16 v[100:101], v25 offset:43008
    v_mfma_f32_16x16x32_bf16 v[200:203], v[216:219], v[116:119], v[200:203]
    ds_read_b64_tr_b16 v[102:103], v25 offset:43520
    v_mfma_f32_32x32x16_bf16 v[48:63], v[220:223], v[212:215], v[48:63]
    ds_read_b64_tr_b16 v[104:105], v25 offset:44032
    ds_read_b64_tr_b16 v[106:107], v25 offset:44544
    v_mfma_f32_16x16x32_bf16 v[204:207], v[220:223], v[116:119], v[204:207]
    ds_read_b64_tr_b16 v[108:109], v25 offset:45056
    v_mfma_f32_32x32x16_bf16 v[64:79], v[212:215], v[224:227], v[64:79]
    ds_read_b64_tr_b16 v[110:111], v25 offset:45568
    v_mfma_f32_16x16x32_bf16 v[208:211], v[224:227], v[116:119], v[208:211]
    s_waitcnt lgkmcnt(7)
    v_mfma_f32_32x32x16_bf16 v[32:47], v[84:87], v[80:83], v[32:47]
    v_mfma_f32_16x16x32_bf16 v[200:203], v[84:87], v[116:119], v[200:203]
    v_mfma_f32_32x32x16_bf16 v[48:63], v[88:91], v[80:83], v[48:63]
    v_mfma_f32_16x16x32_bf16 v[204:207], v[88:91], v[116:119], v[204:207]
    v_mfma_f32_32x32x16_bf16 v[64:79], v[80:83], v[92:95], v[64:79]
    v_mfma_f32_16x16x32_bf16 v[208:211], v[92:95], v[116:119], v[208:211]
    s_waitcnt lgkmcnt(0)
    v_mfma_f32_32x32x16_bf16 v[32:47], v[100:103], v[96:99], v[32:47]
    v_mfma_f32_16x16x32_bf16 v[200:203], v[100:103], v[116:119], v[200:203]
    v_mfma_f32_32x32x16_bf16 v[48:63], v[104:107], v[96:99], v[48:63]
    v_mfma_f32_16x16x32_bf16 v[204:207], v[104:107], v[116:119], v[204:207]
    v_mfma_f32_32x32x16_bf16 v[64:79], v[96:99], v[108:111], v[64:79]
    v_mfma_f32_16x16x32_bf16 v[208:211], v[108:111], v[116:119], v[208:211]
    s_nop 3
    ds_write_b128 v11, v[200:203] offset:17408
    s_nop 0
    ds_write_b128 v11, v[204:207] offset:17664
    s_nop 0
    ds_write_b128 v11, v[208:211] offset:17920
    ds_read_b128 v[128:131], v31 offset:17664
    ds_read_b128 v[132:135], v31 offset:17696
    ds_read_b128 v[136:139], v31 offset:17728
    ds_read_b128 v[140:143], v31 offset:17760
    ds_read_b32 v194, v29 offset:17920
    ds_read_b128 v[176:179], v31 offset:17408
    ds_read_b128 v[180:183], v31 offset:17440
    ds_read_b128 v[184:187], v31 offset:17472
    ds_read_b128 v[188:191], v31 offset:17504
    s_waitcnt vmcnt(6)
    v_readfirstlane_b32 s56, v3
    s_mul_i32 s56, s56, 0x9e3779b1
    s_add_u32 s56, s56, 0x7f4a7c15
    s_barrier
    v_mov_b32 v113, 0
    ds_read_b32 v112, v113 offset:16896
    ds_read_b32 v192, v28 offset:16384
    ds_read_b32 v193, v28 offset:16640
    ds_read_b128 v[144:147], v30 offset:16384
    ds_read_b128 v[148:151], v30 offset:16416
    ds_read_b128 v[152:155], v30 offset:16448
    ds_read_b128 v[156:159], v30 offset:16480
    ds_read_b128 v[160:163], v30 offset:16640
    ds_read_b128 v[164:167], v30 offset:16672
    ds_read_b128 v[168:171], v30 offset:16704
    ds_read_b128 v[172:175], v30 offset:16736
    s_waitcnt lgkmcnt(10)
    v_readfirstlane_b32 s34, v112
    s_mov_b32 s35, s34
    s_waitcnt lgkmcnt(9)
    v_mul_f32 v48, v48, v192
    v_mul_f32 v49, v49, v192
    v_mul_f32 v50, v50, v192
    v_mul_f32 v51, v51, v192
    v_mul_f32 v52, v52, v192
    v_mul_f32 v53, v53, v192
    v_mul_f32 v54, v54, v192
    v_mul_f32 v55, v55, v192
    s_waitcnt lgkmcnt(8)
    v_fmac_f32 v48, v128, v193
    v_fmac_f32 v49, v129, v193
    v_fmac_f32 v50, v130, v193
    v_fmac_f32 v51, v131, v193
    v_fmac_f32 v52, v132, v193
    v_fmac_f32 v53, v133, v193
    v_fmac_f32 v54, v134, v193
    v_fmac_f32 v55, v135, v193
    v_cvt_pk_bf16_f32 v88, v48, v49
    v_cvt_pk_bf16_f32 v89, v50, v51
    v_cvt_pk_bf16_f32 v90, v52, v53
    v_cvt_pk_bf16_f32 v91, v54, v55
    s_cmp_eq_u32 s35, 0
    s_cbranch_scc1 L_sst0
    buffer_store_dwordx4 v[88:91], v2, s[16:19], s43 offen
L_ssd0:
    v_mul_f32 v56, v56, v192
    v_mul_f32 v57, v57, v192
    v_mul_f32 v58, v58, v192
    v_mul_f32 v59, v59, v192
    v_mul_f32 v60, v60, v192
    v_mul_f32 v61, v61, v192
    v_mul_f32 v62, v62, v192
    v_mul_f32 v63, v63, v192
    v_fmac_f32 v56, v136, v193
    v_fmac_f32 v57, v137, v193
    v_fmac_f32 v58, v138, v193
    v_fmac_f32 v59, v139, v193
    v_fmac_f32 v60, v140, v193
    v_fmac_f32 v61, v141, v193
    v_fmac_f32 v62, v142, v193
    v_fmac_f32 v63, v143, v193
    v_cvt_pk_bf16_f32 v92, v56, v57
    v_cvt_pk_bf16_f32 v93, v58, v59
    v_cvt_pk_bf16_f32 v94, v60, v61
    v_cvt_pk_bf16_f32 v95, v62, v63
    s_cmp_eq_u32 s35, 0
    s_cbranch_scc1 L_sst1
    buffer_store_dwordx4 v[92:95], v26, s[16:19], s43 offen
L_ssd1:
    s_waitcnt lgkmcnt(7)
    v_mul_f32 v64, v64, v144
    v_mul_f32 v65, v65, v145
    v_mul_f32 v66, v66, v146
    v_mul_f32 v67, v67, v147
    s_waitcnt lgkmcnt(6)
    v_mul_f32 v68, v68, v148
    v_mul_f32 v69, v69, v149
    v_mul_f32 v70, v70, v150
    v_mul_f32 v71, v71, v151
    s_waitcnt lgkmcnt(3)
    v_fmac_f32 v64, v160, v194
    v_fmac_f32 v65, v161, v194
    v_fmac_f32 v66, v162, v194
    v_fmac_f32 v67, v163, v194
    s_waitcnt lgkmcnt(2)
    v_fmac_f32 v68, v164, v194
    v_fmac_f32 v69, v165, v194
    v_fmac_f32 v70, v166, v194
    v_fmac_f32 v71, v167, v194
    v_cvt_pk_bf16_f32 v96, v64, v65
    v_cvt_pk_bf16_f32 v97, v66, v67
    v_cvt_pk_bf16_f32 v98, v68, v69
    v_cvt_pk_bf16_f32 v99, v70, v71
    s_cmp_eq_u32 s35, 0
    s_cbranch_scc1 L_sst2
    buffer_store_dwordx4 v[96:99], v27, s[16:19], s44 offen
L_ssd2:
    v_mul_f32 v72, v72, v152
    v_mul_f32 v73, v73, v153
    v_mul_f32 v74, v74, v154
    v_mul_f32 v75, v75, v155
    v_mul_f32 v76, v76, v156
    v_mul_f32 v77, v77, v157
    v_mul_f32 v78, v78, v158
    v_mul_f32 v79, v79, v159
    s_waitcnt lgkmcnt(1)
    v_fmac_f32 v72, v168, v194
    v_fmac_f32 v73, v169, v194
    v_fmac_f32 v74, v170, v194
    v_fmac_f32 v75, v171, v194
    s_waitcnt lgkmcnt(0)
    v_fmac_f32 v76, v172, v194
    v_fmac_f32 v77, v173, v194
    v_fmac_f32 v78, v174, v194
    v_fmac_f32 v79, v175, v194
    v_cvt_pk_bf16_f32 v100, v72, v73
    v_cvt_pk_bf16_f32 v101, v74, v75
    v_cvt_pk_bf16_f32 v102, v76, v77
    v_cvt_pk_bf16_f32 v103, v78, v79
    s_cmp_eq_u32 s35, 0
    s_cbranch_scc1 L_sst3
    buffer_store_dwordx4 v[100:103], v27, s[16:19], s44 offen offset:512
L_ssd3:
    v_mul_f32 v192, 0x3eb8aa3b, v192
    v_mul_f32 v193, 0x3eb8aa3b, v193
    v_mul_f32 v32, v32, v192
    v_mul_f32 v33, v33, v192
    v_mul_f32 v34, v34, v192
    v_mul_f32 v35, v35, v192
    v_mul_f32 v36, v36, v192
    v_mul_f32 v37, v37, v192
    v_mul_f32 v38, v38, v192
    v_mul_f32 v39, v39, v192
    v_fmac_f32 v32, v176, v193
    v_fmac_f32 v33, v177, v193
    v_fmac_f32 v34, v178, v193
    v_fmac_f32 v35, v179, v193
    v_fmac_f32 v36, v180, v193
    v_fmac_f32 v37, v181, v193
    v_fmac_f32 v38, v182, v193
    v_fmac_f32 v39, v183, v193
    v_cvt_pk_bf16_f32 v80, v32, v33
    v_cvt_pk_bf16_f32 v81, v34, v35
    v_cvt_pk_bf16_f32 v82, v36, v37
    v_cvt_pk_bf16_f32 v83, v38, v39
    s_cmp_eq_u32 s35, 0
    s_cbranch_scc1 L_sst4
    buffer_store_dwordx4 v[80:83], v2, s[16:19], s42 offen
L_ssd4:
    v_mul_f32 v40, v40, v192
    v_mul_f32 v41, v41, v192
    v_mul_f32 v42, v42, v192
    v_mul_f32 v43, v43, v192
    v_mul_f32 v44, v44, v192
    v_mul_f32 v45, v45, v192
    v_mul_f32 v46, v46, v192
    v_mul_f32 v47, v47, v192
    v_fmac_f32 v40, v184, v193
    v_fmac_f32 v41, v185, v193
    v_fmac_f32 v42, v186, v193
    v_fmac_f32 v43, v187, v193
    v_fmac_f32 v44, v188, v193
    v_fmac_f32 v45, v189, v193
    v_fmac_f32 v46, v190, v193
    v_fmac_f32 v47, v191, v193
    v_cvt_pk_bf16_f32 v84, v40, v41
    v_cvt_pk_bf16_f32 v85, v42, v43
    v_cvt_pk_bf16_f32 v86, v44, v45
    v_cvt_pk_bf16_f32 v87, v46, v47
    s_cmp_eq_u32 s35, 0
    s_cbranch_scc1 L_sst5
    buffer_store_dwordx4 v[84:87], v26, s[16:19], s42 offen
L_ssd5:
    v_mov_b32 v13, s56
    s_waitcnt vmcnt(0) lgkmcnt(0)
    s_mov_b64 exec, 1
    s_cmp_eq_u32 s35, 0
    s_cbranch_scc1 L_f1s
    buffer_store_dword v13, v2, s[16:19], s45 offen
    s_branch L_f1d
L_f1s:
    buffer_store_dword v13, v2, s[16:19], s45 offen sc1
L_f1d:
    s_mov_b64 exec, -1
L_q_join:
    s_and_b32 s8, s2, 7
    s_lshl_b32 s11, s8, 2
    s_bfe_u32 s10, s2, 0x20003
    s_add_u32 s11, s11, s10
    s_lshr_b32 s10, s2, 5
    s_lshl_b32 s38, s11, 16
    s_lshl_b32 s31, s10, 13
    s_add_u32 s52, s38, s31
    s_mov_b32 s38, s52
    s_lshl_b32 s39, s3, 10
    v_lshlrev_b32 v121, 2, v1
    s_lshr_b32 s54, s11, 1
    s_lshl_b32 s54, s54, 8
    s_add_u32 s54, s54, 0x1b06000
    s_lshl_b32 s55, s10, 3
    s_add_u32 s55, s55, s3
    s_lshl_b64 s[32:33], 1, s55
    s_load_dwordx2 s[6:7], s[0:1], 64
    s_mov_b32 s36, 0
    s_barrier
    buffer_load_dword v120, v121, s[16:19], s54 offen sc1
    v_and_b32 v124, 11, v1
    v_cmp_eq_u32 vcc, 0, v124
    v_mov_b32 v40, s37
    s_nop 0
    v_cndmask_b32 v40, 0, v40, vcc
    v_mov_b32 v41, v40
    v_mov_b32 v42, v40
    v_mov_b32 v43, v40
    v_add_u32 v124, 147456, v114
    ds_write_b128 v124, v[40:43]
    v_mov_b32 v127, 163832
    v_mov_b32 v126, 0
    ds_write2_b32 v127, v126, v126 offset0:0 offset1:1
    s_mov_b32 s46, 65536
    v_and_b32 v113, 15, v1
    v_lshlrev_b32 v113, 4, v113
    v_lshrrev_b32 v124, 5, v1
    v_lshl_add_u32 v113, v124, 8, v113
    v_bfe_u32 v124, v1, 4, 1
    v_mul_u32_u24 v112, 81920, v124
    v_add3_u32 v113, v113, v112, s46
    v_xor_b32 v112, 1, v124
    v_lshlrev_b32 v112, 13, v112
    v_mov_b32 v96, 0
    v_mov_b32 v97, 0
    v_mov_b32 v98, 0
    v_mov_b32 v99, 0
    v_mov_b32 v100, 0
    v_mov_b32 v101, 0
    v_mov_b32 v102, 0
    v_mov_b32 v103, 0
    v_mov_b32 v104, 0
    v_mov_b32 v105, 0
    v_mov_b32 v106, 0
    v_mov_b32 v107, 0
    v_mov_b32 v108, 0
    v_mov_b32 v109, 0
    v_mov_b32 v110, 0
    v_mov_b32 v111, 0
    s_waitcnt vmcnt(0)
    v_cmp_ne_u32 vcc, s56, v120
    s_and_b64 vcc, vcc, s[32:33]
    s_cbranch_scc0 L_f1ok
L_f1poll:
    buffer_load_dword v120, v121, s[16:19], s54 offen sc1
    s_add_u32 s36, s36, 1
    s_waitcnt vmcnt(0)
    v_cmp_ne_u32 vcc, s56, v120
    s_cmp_gt_u32 s36, 20000
    s_cselect_b64 vcc, 0, vcc
    s_and_b64 vcc, vcc, s[32:33]
    s_cbranch_scc1 L_f1poll
L_f1ok:
    buffer_load_dwordx4 v[12:15], v114, s[16:19], s52 offen sc1
    s_xor_b32 s30, s38, 0x200000
    s_add_u32 m0, s39, 0x0
    s_nop 0
    buffer_load_dwordx4 v114, s[16:19], s30 offen sc1 lds
    s_xor_b32 s30, s38, 0x400000
    s_add_u32 m0, s39, 0x10000
    s_nop 0
    buffer_load_dwordx4 v114, s[16:19], s30 offen sc1 lds
    s_waitcnt lgkmcnt(0)
    s_mov_b32 s60, s6
    s_mov_b32 s61, s7
    s_and_b32 s8, s2, 7
    s_lshr_b32 s9, s2, 3
    s_lshl_b32 s24, s8, 2
    s_lshr_b32 s30, s9, 3
    s_add_u32 s24, s24, s30
    s_and_b32 s25, s9, 7
    s_and_b32 s26, s3, 3
    s_lshr_b32 s27, s3, 2
    s_and_b32 s28, s3, 1
    s_lshr_b32 s29, s3, 1
    s_xor_b32 s58, s27, s28
    s_lshl_b32 s41, s24, 16
    s_lshl_b32 s30, s26, 14
    s_add_u32 s40, s41, s30
    s_lshl_b32 s31, s25, 11
    s_add_u32 s40, s40, s31
    s_lshl_b32 s31, s27, 10
    s_add_u32 s40, s40, s31
    s_mul_i32 s30, s25, 7
    s_min_u32 s31, s3, 6
    s_add_u32 s30, s30, s31
    s_lshl_b32 s57, s30, 11
    s_mul_i32 s31, s24, 229376
    s_add_u32 s57, s57, s31
    s_add_u32 s57, s57, 0xe00000
    s_mul_i32 s47, s30, 33792
    s_add_u32 s47, s47, 0x1700000
    s_cmp_eq_u32 s3, 7
    s_cselect_b32 s47, 0x7ff00000, s47
    s_cselect_b32 s57, 0x7ff00000, s57
    s_xor_b32 s4, s25, 0
    s_and_b32 s4, s4, 3
    s_lshl_b32 s4, s4, 10
    s_xor_b32 s5, s25, 1
    s_and_b32 s5, s5, 3
    s_lshl_b32 s5, s5, 10
    s_xor_b32 s6, s25, 2
    s_and_b32 s6, s6, 3
    s_lshl_b32 s6, s6, 10
    s_xor_b32 s7, s25, 3
    s_and_b32 s7, s7, 3
    s_lshl_b32 s7, s7, 10
    s_and_b32 s30, s24, 3
    s_lshl_b32 s30, s30, 2
    s_add_u32 s30, s30, s26
    s_add_u32 s30, s30, 1
    s_and_b32 s30, s30, 15
    s_cmp_gt_u32 s30, 1
    s_cselect_b32 s35, s34, 0
    s_mul_i32 s59, s25, 74752
    s_mul_i32 s30, s3, 9216
    s_add_u32 s59, s59, s30
    s_waitcnt vmcnt(0)
    s_waitcnt lgkmcnt(0)
    s_barrier
    buffer_load_dword v120, v121, s[16:19], s54 offen sc1
    ds_read_b128 v[16:19], v2 offset:0
    ds_read_b128 v[20:23], v2 offset:1024
    ds_read_b128 v[24:27], v113 offset:0
    ds_read_b128 v[28:31], v113 offset:512
    s_waitcnt lgkmcnt(3)
    v_mfma_f32_32x32x16_bf16 v[80:95], v[16:19], v[12:15], 0
    s_nop 11
    v_max3_f32 v124, v80, v81, v82
    v_max3_f32 v124, v124, v83, v84
    v_max3_f32 v124, v124, v85, v86
    v_max3_f32 v124, v124, v87, v88
    v_max3_f32 v124, v124, v89, v90
    v_max3_f32 v124, v124, v91, v92
    v_max3_f32 v124, v124, v93, v94
    v_max_f32 v124, v124, v95
    v_mov_b32 v125, v124
    s_nop 1
    v_permlane32_swap_b32 v124, v125
    v_max_f32 v124, v124, v125
    v_sub_f32 v48, 0, v124
    v_sub_f32 v49, 0, v124
    v_sub_f32 v50, 0, v124
    v_sub_f32 v51, 0, v124
    v_sub_f32 v52, 0, v124
    v_sub_f32 v53, 0, v124
    v_sub_f32 v54, 0, v124
    v_sub_f32 v55, 0, v124
    v_sub_f32 v56, 0, v124
    v_sub_f32 v57, 0, v124
    v_sub_f32 v58, 0, v124
    v_sub_f32 v59, 0, v124
    v_sub_f32 v60, 0, v124
    v_sub_f32 v61, 0, v124
    v_sub_f32 v62, 0, v124
    v_sub_f32 v63, 0, v124
    s_nop 1
    v_mfma_f32_32x32x16_bf16 v[64:79], v[16:19], v[12:15], v[48:63]
    s_setprio 3
    s_nop 10
    v_exp_f32 v64, v64
    v_exp_f32 v65, v65
    v_exp_f32 v66, v66
    v_exp_f32 v67, v67
    v_cvt_pk_bf16_f32 v40, v64, v65
    v_exp_f32 v68, v68
    v_exp_f32 v69, v69
    v_cvt_pk_bf16_f32 v41, v66, v67
    v_exp_f32 v70, v70
    s_waitcnt lgkmcnt(0)
    v_mfma_f32_32x32x16_bf16 v[80:95], v[20:23], v[12:15], v[48:63]
    ds_read_b128 v[16:19], v2 offset:2048
    ds_read_b128 v[32:35], v113 offset:1024
    ds_read_b128 v[36:39], v113 offset:1536
    v_exp_f32 v71, v71
    v_cvt_pk_bf16_f32 v42, v68, v69
    v_exp_f32 v72, v72
    v_cvt_pk_bf16_f32 v43, v70, v71
    v_exp_f32 v73, v73
    v_exp_f32 v74, v74
    v_exp_f32 v75, v75
    v_cvt_pk_bf16_f32 v44, v72, v73
    v_mfma_f32_32x32x16_bf16 v[96:111], v[24:27], v[40:43], v[96:111]
    v_exp_f32 v76, v76
    v_exp_f32 v77, v77
    v_cvt_pk_bf16_f32 v45, v74, v75
    s_mov_b32 s32, 0x01010101
    s_lshl_b32 s32, s32, s3
    s_mov_b32 s33, s32
    s_waitcnt vmcnt(0)
    v_cmp_ne_u32 vcc, s56, v120
    s_and_b64 vcc, vcc, s[32:33]
    s_cbranch_scc0 L_f8ok
L_f8wait:
    buffer_load_dword v120, v121, s[16:19], s54 offen sc1
    s_add_u32 s36, s36, 1
    s_waitcnt vmcnt(0)
    v_cmp_ne_u32 vcc, s56, v120
    s_cmp_gt_u32 s36, 20000
    s_cselect_b64 vcc, 0, vcc
    s_and_b64 vcc, vcc, s[32:33]
    s_cbranch_scc1 L_f8wait
L_f8ok:
    s_xor_b32 s30, s38, 0x202000
    s_add_u32 m0, s39, 0x2000
    s_nop 0
    buffer_load_dwordx4 v114, s[16:19], s30 offen sc1 lds
    s_xor_b32 s30, s38, 0x402000
    s_add_u32 m0, s39, 0x12000
    s_nop 0
    buffer_load_dwordx4 v114, s[16:19], s30 offen sc1 lds
    v_exp_f32 v78, v78
    v_exp_f32 v79, v79
    v_cvt_pk_bf16_f32 v46, v76, v77
    v_cvt_pk_bf16_f32 v47, v78, v79
    v_exp_f32 v80, v80
    v_exp_f32 v81, v81
    v_mfma_f32_32x32x16_bf16 v[96:111], v[28:31], v[44:47], v[96:111]
    v_exp_f32 v82, v82
    v_exp_f32 v83, v83
    v_cvt_pk_bf16_f32 v40, v80, v81
    v_exp_f32 v84, v84
    v_exp_f32 v85, v85
    v_cvt_pk_bf16_f32 v41, v82, v83
    v_exp_f32 v86, v86
    s_waitcnt lgkmcnt(0)
    v_mfma_f32_32x32x16_bf16 v[64:79], v[16:19], v[12:15], v[48:63]
    ds_read_b128 v[20:23], v2 offset:3072
    ds_read_b128 v[24:27], v113 offset:2048
    ds_read_b128 v[28:31], v113 offset:2560
    v_exp_f32 v87, v87
    v_cvt_pk_bf16_f32 v42, v84, v85
    v_exp_f32 v88, v88
    v_cvt_pk_bf16_f32 v43, v86, v87
    v_exp_f32 v89, v89
    v_exp_f32 v90, v90
    v_exp_f32 v91, v91
    v_cvt_pk_bf16_f32 v44, v88, v89
    v_mfma_f32_32x32x16_bf16 v[96:111], v[32:35], v[40:43], v[96:111]
    v_exp_f32 v92, v92
    v_exp_f32 v93, v93
    v_cvt_pk_bf16_f32 v45, v90, v91
    s_xor_b32 s30, s38, 0x204000
    s_add_u32 m0, s39, 0x4000
    s_nop 0
    buffer_load_dwordx4 v114, s[16:19], s30 offen sc1 lds
    s_xor_b32 s30, s38, 0x404000
    s_add_u32 m0, s39, 0x14000
    s_nop 0
    buffer_load_dwordx4 v114, s[16:19], s30 offen sc1 lds
    v_exp_f32 v94, v94
    v_exp_f32 v95, v95
    v_cvt_pk_bf16_f32 v46, v92, v93
    v_cvt_pk_bf16_f32 v47, v94, v95
    v_exp_f32 v64, v64
    v_exp_f32 v65, v65
    v_mfma_f32_32x32x16_bf16 v[96:111], v[36:39], v[44:47], v[96:111]
    v_exp_f32 v66, v66
    v_exp_f32 v67, v67
    v_cvt_pk_bf16_f32 v40, v64, v65
    v_exp_f32 v68, v68
    v_exp_f32 v69, v69
    v_cvt_pk_bf16_f32 v41, v66, v67
    v_exp_f32 v70, v70
    s_waitcnt lgkmcnt(0)
    v_mfma_f32_32x32x16_bf16 v[80:95], v[20:23], v[12:15], v[48:63]
    ds_read_b128 v[16:19], v2 offset:4096
    ds_read_b128 v[32:35], v113 offset:3072
    ds_read_b128 v[36:39], v113 offset:3584
    v_exp_f32 v71, v71
    v_cvt_pk_bf16_f32 v42, v68, v69
    v_exp_f32 v72, v72
    v_cvt_pk_bf16_f32 v43, v70, v71
    v_exp_f32 v73, v73
    v_exp_f32 v74, v74
    v_exp_f32 v75, v75
    v_cvt_pk_bf16_f32 v44, v72, v73
    v_mfma_f32_32x32x16_bf16 v[96:111], v[24:27], v[40:43], v[96:111]
    v_exp_f32 v76, v76
    v_exp_f32 v77, v77
    v_cvt_pk_bf16_f32 v45, v74, v75
    s_xor_b32 s30, s38, 0x206000
    s_add_u32 m0, s39, 0x6000
    s_nop 0
    buffer_load_dwordx4 v114, s[16:19], s30 offen sc1 lds
    s_xor_b32 s30, s38, 0x406000
    s_add_u32 m0, s39, 0x16000
    s_nop 0
    buffer_load_dwordx4 v114, s[16:19], s30 offen sc1 lds
    v_exp_f32 v78, v78
    v_exp_f32 v79, v79
    v_cvt_pk_bf16_f32 v46, v76, v77
    v_cvt_pk_bf16_f32 v47, v78, v79
    v_exp_f32 v80, v80
    v_exp_f32 v81, v81
    v_mfma_f32_32x32x16_bf16 v[96:111], v[28:31], v[44:47], v[96:111]
    v_exp_f32 v82, v82
    v_exp_f32 v83, v83
    v_cvt_pk_bf16_f32 v40, v80, v81
    v_exp_f32 v84, v84
    v_exp_f32 v85, v85
    v_cvt_pk_bf16_f32 v41, v82, v83
    v_exp_f32 v86, v86
    s_waitcnt lgkmcnt(0)
    v_mfma_f32_32x32x16_bf16 v[64:79], v[16:19], v[12:15], v[48:63]
    ds_read_b128 v[20:23], v2 offset:5120
    ds_read_b128 v[24:27], v113 offset:4096
    ds_read_b128 v[28:31], v113 offset:4608
    v_exp_f32 v87, v87
    v_cvt_pk_bf16_f32 v42, v84, v85
    v_exp_f32 v88, v88
    v_cvt_pk_bf16_f32 v43, v86, v87
    v_exp_f32 v89, v89
    v_exp_f32 v90, v90
    v_exp_f32 v91, v91
    v_cvt_pk_bf16_f32 v44, v88, v89
    v_mfma_f32_32x32x16_bf16 v[96:111], v[32:35], v[40:43], v[96:111]
    v_exp_f32 v92, v92
    v_exp_f32 v93, v93
    v_cvt_pk_bf16_f32 v45, v90, v91
    s_xor_b32 s30, s38, 0x208000
    s_add_u32 m0, s39, 0x8000
    s_nop 0
    buffer_load_dwordx4 v114, s[16:19], s30 offen sc1 lds
    s_xor_b32 s30, s38, 0x408000
    s_add_u32 m0, s39, 0x18000
    s_nop 0
    buffer_load_dwordx4 v114, s[16:19], s30 offen sc1 lds
    v_exp_f32 v94, v94
    v_exp_f32 v95, v95
    v_cvt_pk_bf16_f32 v46, v92, v93
    v_cvt_pk_bf16_f32 v47, v94, v95
    s_setprio 2
    v_exp_f32 v64, v64
    v_exp_f32 v65, v65
    v_mfma_f32_32x32x16_bf16 v[96:111], v[36:39], v[44:47], v[96:111]
    v_exp_f32 v66, v66
    v_exp_f32 v67, v67
    v_cvt_pk_bf16_f32 v40, v64, v65
    v_exp_f32 v68, v68
    v_exp_f32 v69, v69
    v_cvt_pk_bf16_f32 v41, v66, v67
    v_exp_f32 v70, v70
    s_waitcnt lgkmcnt(0)
    v_mfma_f32_32x32x16_bf16 v[80:95], v[20:23], v[12:15], v[48:63]
    ds_read_b128 v[16:19], v2 offset:6144
    ds_read_b128 v[32:35], v113 offset:5120
    ds_read_b128 v[36:39], v113 offset:5632
    v_exp_f32 v71, v71
    v_cvt_pk_bf16_f32 v42, v68, v69
    v_exp_f32 v72, v72
    v_cvt_pk_bf16_f32 v43, v70, v71
    v_exp_f32 v73, v73
    v_exp_f32 v74, v74
    v_exp_f32 v75, v75
    v_cvt_pk_bf16_f32 v44, v72, v73
    v_mfma_f32_32x32x16_bf16 v[96:111], v[24:27], v[40:43], v[96:111]
    v_exp_f32 v76, v76
    v_exp_f32 v77, v77
    v_cvt_pk_bf16_f32 v45, v74, v75
    s_xor_b32 s30, s38, 0x20a000
    s_add_u32 m0, s39, 0xa000
    s_nop 0
    buffer_load_dwordx4 v114, s[16:19], s30 offen sc1 lds
    s_xor_b32 s30, s38, 0x40a000
    s_add_u32 m0, s39, 0x1a000
    s_nop 0
    buffer_load_dwordx4 v114, s[16:19], s30 offen sc1 lds
    v_exp_f32 v78, v78
    v_exp_f32 v79, v79
    v_cvt_pk_bf16_f32 v46, v76, v77
    v_cvt_pk_bf16_f32 v47, v78, v79
    v_exp_f32 v80, v80
    v_exp_f32 v81, v81
    v_mfma_f32_32x32x16_bf16 v[96:111], v[28:31], v[44:47], v[96:111]
    v_exp_f32 v82, v82
    v_exp_f32 v83, v83
    v_cvt_pk_bf16_f32 v40, v80, v81
    v_exp_f32 v84, v84
    v_exp_f32 v85, v85
    v_cvt_pk_bf16_f32 v41, v82, v83
    v_exp_f32 v86, v86
    s_waitcnt lgkmcnt(0)
    v_mfma_f32_32x32x16_bf16 v[64:79], v[16:19], v[12:15], v[48:63]
    ds_read_b128 v[20:23], v2 offset:7168
    ds_read_b128 v[24:27], v113 offset:6144
    ds_read_b128 v[28:31], v113 offset:6656
    v_exp_f32 v87, v87
    v_cvt_pk_bf16_f32 v42, v84, v85
    v_exp_f32 v88, v88
    v_cvt_pk_bf16_f32 v43, v86, v87
    v_exp_f32 v89, v89
    v_exp_f32 v90, v90
    v_exp_f32 v91, v91
    v_cvt_pk_bf16_f32 v44, v88, v89
    v_mfma_f32_32x32x16_bf16 v[96:111], v[32:35], v[40:43], v[96:111]
    v_exp_f32 v92, v92
    v_exp_f32 v93, v93
    v_cvt_pk_bf16_f32 v45, v90, v91
    s_xor_b32 s30, s38, 0x20c000
    s_add_u32 m0, s39, 0xc000
    s_nop 0
    buffer_load_dwordx4 v114, s[16:19], s30 offen sc1 lds
    s_xor_b32 s30, s38, 0x40c000
    s_add_u32 m0, s39, 0x1c000
    s_nop 0
    buffer_load_dwordx4 v114, s[16:19], s30 offen sc1 lds
    v_exp_f32 v94, v94
    v_exp_f32 v95, v95
    v_cvt_pk_bf16_f32 v46, v92, v93
    v_cvt_pk_bf16_f32 v47, v94, v95
    s_waitcnt vmcnt(10)
    s_barrier
    s_setprio 3
    v_exp_f32 v64, v64
    v_exp_f32 v65, v65
    v_mfma_f32_32x32x16_bf16 v[96:111], v[36:39], v[44:47], v[96:111]
    v_exp_f32 v66, v66
    v_exp_f32 v67, v67
    v_cvt_pk_bf16_f32 v40, v64, v65
    v_exp_f32 v68, v68
    v_exp_f32 v69, v69
    v_cvt_pk_bf16_f32 v41, v66, v67
    v_exp_f32 v70, v70
    s_waitcnt lgkmcnt(0)
    v_mfma_f32_32x32x16_bf16 v[80:95], v[20:23], v[12:15], v[48:63]
    ds_read_b128 v[16:19], v2 offset:8192
    ds_read_b128 v[32:35], v113 offset:7168
    ds_read_b128 v[36:39], v113 offset:7680
    v_exp_f32 v71, v71
    v_cvt_pk_bf16_f32 v42, v68, v69
    v_exp_f32 v72, v72
    v_cvt_pk_bf16_f32 v43, v70, v71
    v_exp_f32 v73, v73
    v_exp_f32 v74, v74
    v_exp_f32 v75, v75
    v_cvt_pk_bf16_f32 v44, v72, v73
    v_mfma_f32_32x32x16_bf16 v[96:111], v[24:27], v[40:43], v[96:111]
    v_exp_f32 v76, v76
    v_exp_f32 v77, v77
    v_cvt_pk_bf16_f32 v45, v74, v75
    s_xor_b32 s30, s38, 0x20e000
    s_add_u32 m0, s39, 0xe000
    s_nop 0
    buffer_load_dwordx4 v114, s[16:19], s30 offen sc1 lds
    s_xor_b32 s30, s38, 0x40e000
    s_add_u32 m0, s39, 0x1e000
    s_nop 0
    buffer_load_dwordx4 v114, s[16:19], s30 offen sc1 lds
    v_exp_f32 v78, v78
    v_exp_f32 v79, v79
    v_cvt_pk_bf16_f32 v46, v76, v77
    v_cvt_pk_bf16_f32 v47, v78, v79
    v_exp_f32 v80, v80
    v_exp_f32 v81, v81
    v_mfma_f32_32x32x16_bf16 v[96:111], v[28:31], v[44:47], v[96:111]
    v_exp_f32 v82, v82
    v_exp_f32 v83, v83
    v_cvt_pk_bf16_f32 v40, v80, v81
    v_exp_f32 v84, v84
    v_exp_f32 v85, v85
    v_cvt_pk_bf16_f32 v41, v82, v83
    v_exp_f32 v86, v86
    s_waitcnt lgkmcnt(0)
    v_mfma_f32_32x32x16_bf16 v[64:79], v[16:19], v[12:15], v[48:63]
    ds_read_b128 v[20:23], v2 offset:9216
    v_add_u32 v113, v112, v113
    ds_read_b128 v[24:27], v113 offset:0
    ds_read_b128 v[28:31], v113 offset:512
    v_exp_f32 v87, v87
    v_cvt_pk_bf16_f32 v42, v84, v85
    v_exp_f32 v88, v88
    v_cvt_pk_bf16_f32 v43, v86, v87
    v_exp_f32 v89, v89
    v_exp_f32 v90, v90
    v_exp_f32 v91, v91
    v_cvt_pk_bf16_f32 v44, v88, v89
    v_mfma_f32_32x32x16_bf16 v[96:111], v[32:35], v[40:43], v[96:111]
    v_exp_f32 v92, v92
    v_exp_f32 v93, v93
    v_cvt_pk_bf16_f32 v45, v90, v91
    v_mov_b32 v116, -1
    v_mov_b32 v117, -1
    v_mov_b32 v118, -1
    v_mov_b32 v119, -1
    s_add_u32 s30, s40, 0x600000
    buffer_store_dwordx4 v[116:119], v2, s[16:19], s30 offen sc1
    v_exp_f32 v94, v94
    v_exp_f32 v95, v95
    v_cvt_pk_bf16_f32 v46, v92, v93
    v_cvt_pk_bf16_f32 v47, v94, v95
    v_exp_f32 v64, v64
    v_exp_f32 v65, v65
    v_mfma_f32_32x32x16_bf16 v[96:111], v[36:39], v[44:47], v[96:111]
    v_exp_f32 v66, v66
    v_exp_f32 v67, v67
    v_cvt_pk_bf16_f32 v40, v64, v65
    v_exp_f32 v68, v68
    v_exp_f32 v69, v69
    v_cvt_pk_bf16_f32 v41, v66, v67
    v_exp_f32 v70, v70
    s_waitcnt lgkmcnt(0)
    v_mfma_f32_32x32x16_bf16 v[80:95], v[20:23], v[12:15], v[48:63]
    ds_read_b128 v[16:19], v2 offset:10240
    ds_read_b128 v[32:35], v113 offset:1024
    ds_read_b128 v[36:39], v113 offset:1536
    v_exp_f32 v71, v71
    v_cvt_pk_bf16_f32 v42, v68, v69
    v_exp_f32 v72, v72
    v_cvt_pk_bf16_f32 v43, v70, v71
    v_exp_f32 v73, v73
    v_exp_f32 v74, v74
    v_exp_f32 v75, v75
    v_cvt_pk_bf16_f32 v44, v72, v73
    v_mfma_f32_32x32x16_bf16 v[96:111], v[24:27], v[40:43], v[96:111]
    v_exp_f32 v76, v76
    v_exp_f32 v77, v77
    v_cvt_pk_bf16_f32 v45, v74, v75
    s_add_u32 s30, s40, 0x800000
    s_cmp_eq_u32 s34, 0
    s_cbranch_scc1 L_sst6
    buffer_store_dwordx4 v[116:119], v2, s[16:19], s30 offen
L_ssd6:
    v_exp_f32 v78, v78
    v_exp_f32 v79, v79
    v_cvt_pk_bf16_f32 v46, v76, v77
    v_cvt_pk_bf16_f32 v47, v78, v79
    s_setprio 2
    v_exp_f32 v80, v80
    v_exp_f32 v81, v81
    v_mfma_f32_32x32x16_bf16 v[96:111], v[28:31], v[44:47], v[96:111]
    v_exp_f32 v82, v82
    v_exp_f32 v83, v83
    v_cvt_pk_bf16_f32 v40, v80, v81
    v_exp_f32 v84, v84
    v_exp_f32 v85, v85
    v_cvt_pk_bf16_f32 v41, v82, v83
    v_exp_f32 v86, v86
    s_waitcnt lgkmcnt(0)
    v_mfma_f32_32x32x16_bf16 v[64:79], v[16:19], v[12:15], v[48:63]
    ds_read_b128 v[20:23], v2 offset:11264
    ds_read_b128 v[24:27], v113 offset:2048
    ds_read_b128 v[28:31], v113 offset:2560
    v_exp_f32 v87, v87
    v_cvt_pk_bf16_f32 v42, v84, v85
    v_exp_f32 v88, v88
    v_cvt_pk_bf16_f32 v43, v86, v87
    v_exp_f32 v89, v89
    v_exp_f32 v90, v90
    v_exp_f32 v91, v91
    v_cvt_pk_bf16_f32 v44, v88, v89
    v_mfma_f32_32x32x16_bf16 v[96:111], v[32:35], v[40:43], v[96:111]
    v_exp_f32 v92, v92
    v_exp_f32 v93, v93
    v_cvt_pk_bf16_f32 v45, v90, v91
    s_add_u32 s30, s40, 0xa00000
    s_cmp_eq_u32 s35, 0
    s_cbranch_scc1 L_sst7
    buffer_store_dwordx4 v[116:119], v2, s[16:19], s30 offen
L_ssd7:
    v_exp_f32 v94, v94
    v_exp_f32 v95, v95
    v_cvt_pk_bf16_f32 v46, v92, v93
    v_cvt_pk_bf16_f32 v47, v94, v95
    s_waitcnt vmcnt(3)
    s_barrier
    s_setprio 3
    v_exp_f32 v64, v64
    v_exp_f32 v65, v65
    v_mfma_f32_32x32x16_bf16 v[96:111], v[36:39], v[44:47], v[96:111]
    v_exp_f32 v66, v66
    v_exp_f32 v67, v67
    v_cvt_pk_bf16_f32 v40, v64, v65
    v_exp_f32 v68, v68
    v_exp_f32 v69, v69
    v_cvt_pk_bf16_f32 v41, v66, v67
    v_exp_f32 v70, v70
    s_waitcnt lgkmcnt(0)
    v_mfma_f32_32x32x16_bf16 v[80:95], v[20:23], v[12:15], v[48:63]
    ds_read_b128 v[16:19], v2 offset:12288
    ds_read_b128 v[32:35], v113 offset:3072
    ds_read_b128 v[36:39], v113 offset:3584
    v_exp_f32 v71, v71
    v_cvt_pk_bf16_f32 v42, v68, v69
    v_exp_f32 v72, v72
    v_cvt_pk_bf16_f32 v43, v70, v71
    v_exp_f32 v73, v73
    v_exp_f32 v74, v74
    v_exp_f32 v75, v75
    v_cvt_pk_bf16_f32 v44, v72, v73
    v_mfma_f32_32x32x16_bf16 v[96:111], v[24:27], v[40:43], v[96:111]
    v_exp_f32 v76, v76
    v_exp_f32 v77, v77
    v_cvt_pk_bf16_f32 v45, v74, v75
    buffer_load_dwordx4 v[228:231], v244, s[20:23], 0 offen
    buffer_load_dwordx4 v[232:235], v245, s[20:23], 0 offen
    buffer_load_dwordx4 v[236:239], v246, s[64:67], 0 offen
    buffer_load_dwordx4 v[240:243], v247, s[64:67], 0 offen
    v_exp_f32 v78, v78
    v_exp_f32 v79, v79
    v_cvt_pk_bf16_f32 v46, v76, v77
    v_cvt_pk_bf16_f32 v47, v78, v79
    v_exp_f32 v80, v80
    v_exp_f32 v81, v81
    v_mfma_f32_32x32x16_bf16 v[96:111], v[28:31], v[44:47], v[96:111]
    v_exp_f32 v82, v82
    v_exp_f32 v83, v83
    v_cvt_pk_bf16_f32 v40, v80, v81
    v_exp_f32 v84, v84
    v_exp_f32 v85, v85
    v_cvt_pk_bf16_f32 v41, v82, v83
    v_exp_f32 v86, v86
    s_waitcnt lgkmcnt(0)
    v_mfma_f32_32x32x16_bf16 v[64:79], v[16:19], v[12:15], v[48:63]
    ds_read_b128 v[20:23], v2 offset:13312
    ds_read_b128 v[24:27], v113 offset:4096
    ds_read_b128 v[28:31], v113 offset:4608
    v_exp_f32 v87, v87
    v_cvt_pk_bf16_f32 v42, v84, v85
    v_exp_f32 v88, v88
    v_cvt_pk_bf16_f32 v43, v86, v87
    v_exp_f32 v89, v89
    v_exp_f32 v90, v90
    v_exp_f32 v91, v91
    v_cvt_pk_bf16_f32 v44, v88, v89
    v_mfma_f32_32x32x16_bf16 v[96:111], v[32:35], v[40:43], v[96:111]
    v_exp_f32 v92, v92
    v_exp_f32 v93, v93
    v_cvt_pk_bf16_f32 v45, v90, v91
    v_exp_f32 v94, v94
    v_exp_f32 v95, v95
    v_cvt_pk_bf16_f32 v46, v92, v93
    v_cvt_pk_bf16_f32 v47, v94, v95
    s_setprio 2
    v_exp_f32 v64, v64
    v_exp_f32 v65, v65
    v_mfma_f32_32x32x16_bf16 v[96:111], v[36:39], v[44:47], v[96:111]
    v_exp_f32 v66, v66
    v_exp_f32 v67, v67
    v_cvt_pk_bf16_f32 v40, v64, v65
    v_exp_f32 v68, v68
    v_exp_f32 v69, v69
    v_cvt_pk_bf16_f32 v41, v66, v67
    v_exp_f32 v70, v70
    s_waitcnt lgkmcnt(0)
    v_mfma_f32_32x32x16_bf16 v[80:95], v[20:23], v[12:15], v[48:63]
    ds_read_b128 v[16:19], v2 offset:14336
    ds_read_b128 v[32:35], v113 offset:5120
    ds_read_b128 v[36:39], v113 offset:5632
    v_exp_f32 v71, v71
    v_cvt_pk_bf16_f32 v42, v68, v69
    v_exp_f32 v72, v72
    v_cvt_pk_bf16_f32 v43, v70, v71
    v_exp_f32 v73, v73
    v_exp_f32 v74, v74
    v_exp_f32 v75, v75
    v_cvt_pk_bf16_f32 v44, v72, v73
    v_mfma_f32_32x32x16_bf16 v[96:111], v[24:27], v[40:43], v[96:111]
    v_exp_f32 v76, v76
    v_exp_f32 v77, v77
    v_cvt_pk_bf16_f32 v45, v74, v75
    v_exp_f32 v78, v78
    v_exp_f32 v79, v79
    v_cvt_pk_bf16_f32 v46, v76, v77
    v_cvt_pk_bf16_f32 v47, v78, v79
    v_exp_f32 v80, v80
    v_exp_f32 v81, v81
    v_mfma_f32_32x32x16_bf16 v[96:111], v[28:31], v[44:47], v[96:111]
    v_exp_f32 v82, v82
    v_exp_f32 v83, v83
    v_cvt_pk_bf16_f32 v40, v80, v81
    v_exp_f32 v84, v84
    v_exp_f32 v85, v85
    v_cvt_pk_bf16_f32 v41, v82, v83
    v_exp_f32 v86, v86
    s_waitcnt lgkmcnt(0)
    v_mfma_f32_32x32x16_bf16 v[64:79], v[16:19], v[12:15], v[48:63]
    ds_read_b128 v[20:23], v2 offset:15360
    ds_read_b128 v[24:27], v113 offset:6144
    ds_read_b128 v[28:31], v113 offset:6656
    v_exp_f32 v87, v87
    v_cvt_pk_bf16_f32 v42, v84, v85
    v_exp_f32 v88, v88
    v_cvt_pk_bf16_f32 v43, v86, v87
    v_exp_f32 v89, v89
    v_exp_f32 v90, v90
    v_exp_f32 v91, v91
    v_cvt_pk_bf16_f32 v44, v88, v89
    v_mfma_f32_32x32x16_bf16 v[96:111], v[32:35], v[40:43], v[96:111]
    v_exp_f32 v92, v92
    v_exp_f32 v93, v93
    v_cvt_pk_bf16_f32 v45, v90, v91
    v_exp_f32 v94, v94
    v_exp_f32 v95, v95
    v_cvt_pk_bf16_f32 v46, v92, v93
    v_cvt_pk_bf16_f32 v47, v94, v95
    v_exp_f32 v64, v64
    v_exp_f32 v65, v65
    v_mfma_f32_32x32x16_bf16 v[96:111], v[36:39], v[44:47], v[96:111]
    v_exp_f32 v66, v66
    v_exp_f32 v67, v67
    v_cvt_pk_bf16_f32 v40, v64, v65
    v_exp_f32 v68, v68
    v_exp_f32 v69, v69
    v_cvt_pk_bf16_f32 v41, v66, v67
    v_exp_f32 v70, v70
    s_waitcnt lgkmcnt(0)
    v_mfma_f32_32x32x16_bf16 v[80:95], v[20:23], v[12:15], v[48:63]
    ds_read_b128 v[16:19], v2 offset:16384
    ds_read_b128 v[32:35], v113 offset:7168
    ds_read_b128 v[36:39], v113 offset:7680
    v_exp_f32 v71, v71
    v_cvt_pk_bf16_f32 v42, v68, v69
    v_exp_f32 v72, v72
    v_cvt_pk_bf16_f32 v43, v70, v71
    v_exp_f32 v73, v73
    v_exp_f32 v74, v74
    v_exp_f32 v75, v75
    v_cvt_pk_bf16_f32 v44, v72, v73
    v_mfma_f32_32x32x16_bf16 v[96:111], v[24:27], v[40:43], v[96:111]
    v_exp_f32 v76, v76
    v_exp_f32 v77, v77
    v_cvt_pk_bf16_f32 v45, v74, v75
    v_exp_f32 v78, v78
    v_exp_f32 v79, v79
    v_cvt_pk_bf16_f32 v46, v76, v77
    v_cvt_pk_bf16_f32 v47, v78, v79
    v_exp_f32 v80, v80
    v_exp_f32 v81, v81
    v_mfma_f32_32x32x16_bf16 v[96:111], v[28:31], v[44:47], v[96:111]
    v_exp_f32 v82, v82
    v_exp_f32 v83, v83
    v_cvt_pk_bf16_f32 v40, v80, v81
    v_exp_f32 v84, v84
    v_exp_f32 v85, v85
    v_cvt_pk_bf16_f32 v41, v82, v83
    v_exp_f32 v86, v86
    s_waitcnt lgkmcnt(0)
    v_mfma_f32_32x32x16_bf16 v[64:79], v[16:19], v[12:15], v[48:63]
    ds_read_b128 v[20:23], v2 offset:17408
    v_add_u32 v113, v112, v113
    ds_read_b128 v[24:27], v113 offset:0
    ds_read_b128 v[28:31], v113 offset:512
    v_exp_f32 v87, v87
    v_cvt_pk_bf16_f32 v42, v84, v85
    v_exp_f32 v88, v88
    v_cvt_pk_bf16_f32 v43, v86, v87
    v_exp_f32 v89, v89
    v_exp_f32 v90, v90
    v_exp_f32 v91, v91
    v_cvt_pk_bf16_f32 v44, v88, v89
    v_mfma_f32_32x32x16_bf16 v[96:111], v[32:35], v[40:43], v[96:111]
    v_exp_f32 v92, v92
    v_exp_f32 v93, v93
    v_cvt_pk_bf16_f32 v45, v90, v91
    v_exp_f32 v94, v94
    v_exp_f32 v95, v95
    v_cvt_pk_bf16_f32 v46, v92, v93
    v_cvt_pk_bf16_f32 v47, v94, v95
    v_exp_f32 v64, v64
    v_exp_f32 v65, v65
    v_mfma_f32_32x32x16_bf16 v[96:111], v[36:39], v[44:47], v[96:111]
    v_exp_f32 v66, v66
    v_exp_f32 v67, v67
    v_cvt_pk_bf16_f32 v40, v64, v65
    v_exp_f32 v68, v68
    v_exp_f32 v69, v69
    v_cvt_pk_bf16_f32 v41, v66, v67
    v_exp_f32 v70, v70
    s_waitcnt lgkmcnt(0)
    v_mfma_f32_32x32x16_bf16 v[80:95], v[20:23], v[12:15], v[48:63]
    ds_read_b128 v[16:19], v2 offset:18432
    ds_read_b128 v[32:35], v113 offset:1024
    ds_read_b128 v[36:39], v113 offset:1536
    v_exp_f32 v71, v71
    v_cvt_pk_bf16_f32 v42, v68, v69
    v_exp_f32 v72, v72
    v_cvt_pk_bf16_f32 v43, v70, v71
    v_exp_f32 v73, v73
    v_exp_f32 v74, v74
    v_exp_f32 v75, v75
    v_cvt_pk_bf16_f32 v44, v72, v73
    v_mfma_f32_32x32x16_bf16 v[96:111], v[24:27], v[40:43], v[96:111]
    v_exp_f32 v76, v76
    v_exp_f32 v77, v77
    v_cvt_pk_bf16_f32 v45, v74, v75
    v_exp_f32 v78, v78
    v_exp_f32 v79, v79
    v_cvt_pk_bf16_f32 v46, v76, v77
    v_cvt_pk_bf16_f32 v47, v78, v79
    v_exp_f32 v80, v80
    v_exp_f32 v81, v81
    v_mfma_f32_32x32x16_bf16 v[96:111], v[28:31], v[44:47], v[96:111]
    v_exp_f32 v82, v82
    v_exp_f32 v83, v83
    v_cvt_pk_bf16_f32 v40, v80, v81
    v_exp_f32 v84, v84
    v_exp_f32 v85, v85
    v_cvt_pk_bf16_f32 v41, v82, v83
    v_exp_f32 v86, v86
    s_waitcnt lgkmcnt(0)
    v_mfma_f32_32x32x16_bf16 v[64:79], v[16:19], v[12:15], v[48:63]
    ds_read_b128 v[20:23], v2 offset:19456
    ds_read_b128 v[24:27], v113 offset:2048
    ds_read_b128 v[28:31], v113 offset:2560
    v_exp_f32 v87, v87
    v_cvt_pk_bf16_f32 v42, v84, v85
    v_exp_f32 v88, v88
    v_cvt_pk_bf16_f32 v43, v86, v87
    v_exp_f32 v89, v89
    v_exp_f32 v90, v90
    v_exp_f32 v91, v91
    v_cvt_pk_bf16_f32 v44, v88, v89
    v_mfma_f32_32x32x16_bf16 v[96:111], v[32:35], v[40:43], v[96:111]
    v_exp_f32 v92, v92
    v_exp_f32 v93, v93
    v_cvt_pk_bf16_f32 v45, v90, v91
    v_exp_f32 v94, v94
    v_exp_f32 v95, v95
    v_cvt_pk_bf16_f32 v46, v92, v93
    v_cvt_pk_bf16_f32 v47, v94, v95
    v_exp_f32 v64, v64
    v_exp_f32 v65, v65
    v_mfma_f32_32x32x16_bf16 v[96:111], v[36:39], v[44:47], v[96:111]
    v_exp_f32 v66, v66
    v_exp_f32 v67, v67
    v_cvt_pk_bf16_f32 v40, v64, v65
    v_exp_f32 v68, v68
    v_exp_f32 v69, v69
    v_cvt_pk_bf16_f32 v41, v66, v67
    v_exp_f32 v70, v70
    s_waitcnt lgkmcnt(0)
    v_mfma_f32_32x32x16_bf16 v[80:95], v[20:23], v[12:15], v[48:63]
    ds_read_b128 v[16:19], v2 offset:20480
    ds_read_b128 v[32:35], v113 offset:3072
    ds_read_b128 v[36:39], v113 offset:3584
    v_exp_f32 v71, v71
    v_cvt_pk_bf16_f32 v42, v68, v69
    v_exp_f32 v72, v72
    v_cvt_pk_bf16_f32 v43, v70, v71
    v_exp_f32 v73, v73
    v_exp_f32 v74, v74
    v_exp_f32 v75, v75
    v_cvt_pk_bf16_f32 v44, v72, v73
    v_mfma_f32_32x32x16_bf16 v[96:111], v[24:27], v[40:43], v[96:111]
    v_exp_f32 v76, v76
    v_exp_f32 v77, v77
    v_cvt_pk_bf16_f32 v45, v74, v75
    s_lshl_b32 s30, s3, 11
    s_add_u32 s30, s30, 131072
    v_add_u32 v5, s30, v2
    v_and_b32 v124, 0x300, v2
    v_add_u32 v6, v124, v5
    v_and_b32 v7, 0x2c0, v2
    v_bfe_u32 v124, v1, 4, 1
    v_lshl_add_u32 v7, v124, 5, v7
    v_and_b32 v124, 1, v1
    v_lshl_add_u32 v7, v124, 4, v7
    v_bfe_u32 v124, v1, 1, 1
    v_lshl_add_u32 v7, v124, 3, v7
    v_xor_b32 v7, s63, v7
    v_add_u32 v7, s30, v7
    v_exp_f32 v78, v78
    v_exp_f32 v79, v79
    v_cvt_pk_bf16_f32 v46, v76, v77
    v_cvt_pk_bf16_f32 v47, v78, v79
    v_exp_f32 v80, v80
    v_exp_f32 v81, v81
    v_mfma_f32_32x32x16_bf16 v[96:111], v[28:31], v[44:47], v[96:111]
    v_exp_f32 v82, v82
    v_exp_f32 v83, v83
    v_cvt_pk_bf16_f32 v40, v80, v81
    v_exp_f32 v84, v84
    v_exp_f32 v85, v85
    v_cvt_pk_bf16_f32 v41, v82, v83
    v_exp_f32 v86, v86
    s_waitcnt lgkmcnt(0)
    v_mfma_f32_32x32x16_bf16 v[64:79], v[16:19], v[12:15], v[48:63]
    ds_read_b128 v[20:23], v2 offset:21504
    ds_read_b128 v[24:27], v113 offset:4096
    ds_read_b128 v[28:31], v113 offset:4608
    v_exp_f32 v87, v87
    v_cvt_pk_bf16_f32 v42, v84, v85
    v_exp_f32 v88, v88
    v_cvt_pk_bf16_f32 v43, v86, v87
    v_exp_f32 v89, v89
    v_exp_f32 v90, v90
    v_exp_f32 v91, v91
    v_cvt_pk_bf16_f32 v44, v88, v89
    v_mfma_f32_32x32x16_bf16 v[96:111], v[32:35], v[40:43], v[96:111]
    v_exp_f32 v92, v92
    v_exp_f32 v93, v93
    v_cvt_pk_bf16_f32 v45, v90, v91
    s_waitcnt vmcnt(3)
    ds_write_b128 v5, v[228:231]
    s_waitcnt vmcnt(2)
    ds_write_b128 v5, v[232:235] offset:1024
    ds_read_b64_tr_b16 v[228:229], v7 offset:0
    ds_read_b64_tr_b16 v[230:231], v7 offset:256
    ds_read_b64_tr_b16 v[232:233], v7 offset:1024
    ds_read_b64_tr_b16 v[234:235], v7 offset:1280
    v_exp_f32 v94, v94
    v_exp_f32 v95, v95
    v_cvt_pk_bf16_f32 v46, v92, v93
    v_cvt_pk_bf16_f32 v47, v94, v95
    v_exp_f32 v64, v64
    v_exp_f32 v65, v65
    v_mfma_f32_32x32x16_bf16 v[96:111], v[36:39], v[44:47], v[96:111]
    v_exp_f32 v66, v66
    v_exp_f32 v67, v67
    v_cvt_pk_bf16_f32 v40, v64, v65
    v_exp_f32 v68, v68
    v_exp_f32 v69, v69
    v_cvt_pk_bf16_f32 v41, v66, v67
    v_exp_f32 v70, v70
    s_waitcnt lgkmcnt(0)
    v_mfma_f32_32x32x16_bf16 v[80:95], v[20:23], v[12:15], v[48:63]
    ds_read_b128 v[16:19], v2 offset:22528
    ds_read_b128 v[32:35], v113 offset:5120
    ds_read_b128 v[36:39], v113 offset:5632
    v_exp_f32 v71, v71
    v_cvt_pk_bf16_f32 v42, v68, v69
    v_exp_f32 v72, v72
    v_cvt_pk_bf16_f32 v43, v70, v71
    v_exp_f32 v73, v73
    v_exp_f32 v74, v74
    v_exp_f32 v75, v75
    v_cvt_pk_bf16_f32 v44, v72, v73
    v_mfma_f32_32x32x16_bf16 v[96:111], v[24:27], v[40:43], v[96:111]
    v_exp_f32 v76, v76
    v_exp_f32 v77, v77
    v_cvt_pk_bf16_f32 v45, v74, v75
    s_waitcnt vmcnt(1)
    ds_write_b128 v5, v[236:239]
    s_waitcnt vmcnt(0)
    ds_write_b128 v5, v[240:243] offset:1024
    ds_read_b64_tr_b16 v[236:237], v6 offset:0
    ds_read_b64_tr_b16 v[238:239], v6 offset:256
    ds_read_b64_tr_b16 v[240:241], v6 offset:8
    ds_read_b64_tr_b16 v[242:243], v6 offset:264
    buffer_store_dwordx4 v[228:231], v2, s[16:19], s68 offen offset:0 sc1
    v_exp_f32 v78, v78
    v_exp_f32 v79, v79
    v_cvt_pk_bf16_f32 v46, v76, v77
    v_cvt_pk_bf16_f32 v47, v78, v79
    v_exp_f32 v80, v80
    v_exp_f32 v81, v81
    v_mfma_f32_32x32x16_bf16 v[96:111], v[28:31], v[44:47], v[96:111]
    v_exp_f32 v82, v82
    v_exp_f32 v83, v83
    v_cvt_pk_bf16_f32 v40, v80, v81
    v_exp_f32 v84, v84
    v_exp_f32 v85, v85
    v_cvt_pk_bf16_f32 v41, v82, v83
    v_exp_f32 v86, v86
    s_waitcnt lgkmcnt(0)
    v_mfma_f32_32x32x16_bf16 v[64:79], v[16:19], v[12:15], v[48:63]
    ds_read_b128 v[20:23], v2 offset:23552
    ds_read_b128 v[24:27], v113 offset:6144
    ds_read_b128 v[28:31], v113 offset:6656
    v_exp_f32 v87, v87
    v_cvt_pk_bf16_f32 v42, v84, v85
    v_exp_f32 v88, v88
    v_cvt_pk_bf16_f32 v43, v86, v87
    v_exp_f32 v89, v89
    v_exp_f32 v90, v90
    v_exp_f32 v91, v91
    v_cvt_pk_bf16_f32 v44, v88, v89
    v_mfma_f32_32x32x16_bf16 v[96:111], v[32:35], v[40:43], v[96:111]
    v_exp_f32 v92, v92
    v_exp_f32 v93, v93
    v_cvt_pk_bf16_f32 v45, v90, v91
    buffer_store_dwordx4 v[232:235], v2, s[16:19], s68 offen offset:1024 sc1
    v_exp_f32 v94, v94
    v_exp_f32 v95, v95
    v_cvt_pk_bf16_f32 v46, v92, v93
    v_cvt_pk_bf16_f32 v47, v94, v95
    v_exp_f32 v64, v64
    v_exp_f32 v65, v65
    v_mfma_f32_32x32x16_bf16 v[96:111], v[36:39], v[44:47], v[96:111]
    v_exp_f32 v66, v66
    v_exp_f32 v67, v67
    v_cvt_pk_bf16_f32 v40, v64, v65
    v_exp_f32 v68, v68
    v_exp_f32 v69, v69
    v_cvt_pk_bf16_f32 v41, v66, v67
    v_exp_f32 v70, v70
    s_waitcnt lgkmcnt(0)
    v_mfma_f32_32x32x16_bf16 v[80:95], v[20:23], v[12:15], v[48:63]
    ds_read_b128 v[16:19], v2 offset:24576
    ds_read_b128 v[32:35], v113 offset:7168
    ds_read_b128 v[36:39], v113 offset:7680
    v_exp_f32 v71, v71
    v_cvt_pk_bf16_f32 v42, v68, v69
    v_exp_f32 v72, v72
    v_cvt_pk_bf16_f32 v43, v70, v71
    v_exp_f32 v73, v73
    v_exp_f32 v74, v74
    v_exp_f32 v75, v75
    v_cvt_pk_bf16_f32 v44, v72, v73
    v_mfma_f32_32x32x16_bf16 v[96:111], v[24:27], v[40:43], v[96:111]
    v_exp_f32 v76, v76
    v_exp_f32 v77, v77
    v_cvt_pk_bf16_f32 v45, v74, v75
    buffer_store_dwordx4 v[236:239], v2, s[16:19], s69 offen offset:0 sc1
    v_exp_f32 v78, v78
    v_exp_f32 v79, v79
    v_cvt_pk_bf16_f32 v46, v76, v77
    v_cvt_pk_bf16_f32 v47, v78, v79
    v_exp_f32 v80, v80
    v_exp_f32 v81, v81
    v_mfma_f32_32x32x16_bf16 v[96:111], v[28:31], v[44:47], v[96:111]
    v_exp_f32 v82, v82
    v_exp_f32 v83, v83
    v_cvt_pk_bf16_f32 v40, v80, v81
    v_exp_f32 v84, v84
    v_exp_f32 v85, v85
    v_cvt_pk_bf16_f32 v41, v82, v83
    v_exp_f32 v86, v86
    s_waitcnt lgkmcnt(0)
    v_mfma_f32_32x32x16_bf16 v[64:79], v[16:19], v[12:15], v[48:63]
    ds_read_b128 v[20:23], v2 offset:25600
    v_add_u32 v113, v112, v113
    ds_read_b128 v[24:27], v113 offset:0
    ds_read_b128 v[28:31], v113 offset:512
    v_exp_f32 v87, v87
    v_cvt_pk_bf16_f32 v42, v84, v85
    v_exp_f32 v88, v88
    v_cvt_pk_bf16_f32 v43, v86, v87
    v_exp_f32 v89, v89
    v_exp_f32 v90, v90
    v_exp_f32 v91, v91
    v_cvt_pk_bf16_f32 v44, v88, v89
    v_mfma_f32_32x32x16_bf16 v[96:111], v[32:35], v[40:43], v[96:111]
    v_exp_f32 v92, v92
    v_exp_f32 v93, v93
    v_cvt_pk_bf16_f32 v45, v90, v91
    buffer_store_dwordx4 v[240:243], v2, s[16:19], s69 offen offset:1024 sc1
    v_exp_f32 v94, v94
    v_exp_f32 v95, v95
    v_cvt_pk_bf16_f32 v46, v92, v93
    v_cvt_pk_bf16_f32 v47, v94, v95
    v_exp_f32 v64, v64
    v_exp_f32 v65, v65
    v_mfma_f32_32x32x16_bf16 v[96:111], v[36:39], v[44:47], v[96:111]
    v_exp_f32 v66, v66
    v_exp_f32 v67, v67
    v_cvt_pk_bf16_f32 v40, v64, v65
    v_exp_f32 v68, v68
    v_exp_f32 v69, v69
    v_cvt_pk_bf16_f32 v41, v66, v67
    v_exp_f32 v70, v70
    s_waitcnt lgkmcnt(0)
    v_mfma_f32_32x32x16_bf16 v[80:95], v[20:23], v[12:15], v[48:63]
    ds_read_b128 v[16:19], v2 offset:26624
    ds_read_b128 v[32:35], v113 offset:1024
    ds_read_b128 v[36:39], v113 offset:1536
    v_exp_f32 v71, v71
    v_cvt_pk_bf16_f32 v42, v68, v69
    v_exp_f32 v72, v72
    v_cvt_pk_bf16_f32 v43, v70, v71
    v_exp_f32 v73, v73
    v_exp_f32 v74, v74
    v_exp_f32 v75, v75
    v_cvt_pk_bf16_f32 v44, v72, v73
    v_mfma_f32_32x32x16_bf16 v[96:111], v[24:27], v[40:43], v[96:111]
    v_exp_f32 v76, v76
    v_exp_f32 v77, v77
    v_cvt_pk_bf16_f32 v45, v74, v75
    v_exp_f32 v78, v78
    v_exp_f32 v79, v79
    v_cvt_pk_bf16_f32 v46, v76, v77
    v_cvt_pk_bf16_f32 v47, v78, v79
    v_exp_f32 v80, v80
    v_exp_f32 v81, v81
    v_mfma_f32_32x32x16_bf16 v[96:111], v[28:31], v[44:47], v[96:111]
    v_exp_f32 v82, v82
    v_exp_f32 v83, v83
    v_cvt_pk_bf16_f32 v40, v80, v81
    v_exp_f32 v84, v84
    v_exp_f32 v85, v85
    v_cvt_pk_bf16_f32 v41, v82, v83
    v_exp_f32 v86, v86
    s_waitcnt lgkmcnt(0)
    v_mfma_f32_32x32x16_bf16 v[64:79], v[16:19], v[12:15], v[48:63]
    ds_read_b128 v[20:23], v2 offset:27648
    ds_read_b128 v[24:27], v113 offset:2048
    ds_read_b128 v[28:31], v113 offset:2560
    v_exp_f32 v87, v87
    v_cvt_pk_bf16_f32 v42, v84, v85
    v_exp_f32 v88, v88
    v_cvt_pk_bf16_f32 v43, v86, v87
    v_exp_f32 v89, v89
    v_exp_f32 v90, v90
    v_exp_f32 v91, v91
    v_cvt_pk_bf16_f32 v44, v88, v89
    v_mfma_f32_32x32x16_bf16 v[96:111], v[32:35], v[40:43], v[96:111]
    v_exp_f32 v92, v92
    v_exp_f32 v93, v93
    v_cvt_pk_bf16_f32 v45, v90, v91
    v_exp_f32 v94, v94
    v_exp_f32 v95, v95
    v_cvt_pk_bf16_f32 v46, v92, v93
    v_cvt_pk_bf16_f32 v47, v94, v95
    s_setprio 1
    v_exp_f32 v64, v64
    v_exp_f32 v65, v65
    v_mfma_f32_32x32x16_bf16 v[96:111], v[36:39], v[44:47], v[96:111]
    v_exp_f32 v66, v66
    v_exp_f32 v67, v67
    v_cvt_pk_bf16_f32 v40, v64, v65
    v_exp_f32 v68, v68
    v_exp_f32 v69, v69
    v_cvt_pk_bf16_f32 v41, v66, v67
    v_exp_f32 v70, v70
    s_waitcnt lgkmcnt(0)
    v_mfma_f32_32x32x16_bf16 v[80:95], v[20:23], v[12:15], v[48:63]
    ds_read_b128 v[16:19], v2 offset:28672
    ds_read_b128 v[32:35], v113 offset:3072
    ds_read_b128 v[36:39], v113 offset:3584
    v_exp_f32 v71, v71
    v_cvt_pk_bf16_f32 v42, v68, v69
    v_exp_f32 v72, v72
    v_cvt_pk_bf16_f32 v43, v70, v71
    v_exp_f32 v73, v73
    v_exp_f32 v74, v74
    v_exp_f32 v75, v75
    v_cvt_pk_bf16_f32 v44, v72, v73
    v_mfma_f32_32x32x16_bf16 v[96:111], v[24:27], v[40:43], v[96:111]
    v_exp_f32 v76, v76
    v_exp_f32 v77, v77
    v_cvt_pk_bf16_f32 v45, v74, v75
    v_exp_f32 v78, v78
    v_exp_f32 v79, v79
    v_cvt_pk_bf16_f32 v46, v76, v77
    v_cvt_pk_bf16_f32 v47, v78, v79
    v_exp_f32 v80, v80
    v_exp_f32 v81, v81
    v_mfma_f32_32x32x16_bf16 v[96:111], v[28:31], v[44:47], v[96:111]
    v_exp_f32 v82, v82
    v_exp_f32 v83, v83
    v_cvt_pk_bf16_f32 v40, v80, v81
    v_exp_f32 v84, v84
    v_exp_f32 v85, v85
    v_cvt_pk_bf16_f32 v41, v82, v83
    v_exp_f32 v86, v86
    s_waitcnt lgkmcnt(0)
    v_mfma_f32_32x32x16_bf16 v[64:79], v[16:19], v[12:15], v[48:63]
    ds_read_b128 v[20:23], v2 offset:29696
    ds_read_b128 v[24:27], v113 offset:4096
    ds_read_b128 v[28:31], v113 offset:4608
    v_exp_f32 v87, v87
    v_cvt_pk_bf16_f32 v42, v84, v85
    v_exp_f32 v88, v88
    v_cvt_pk_bf16_f32 v43, v86, v87
    v_exp_f32 v89, v89
    v_exp_f32 v90, v90
    v_exp_f32 v91, v91
    v_cvt_pk_bf16_f32 v44, v88, v89
    v_mfma_f32_32x32x16_bf16 v[96:111], v[32:35], v[40:43], v[96:111]
    v_exp_f32 v92, v92
    v_exp_f32 v93, v93
    v_cvt_pk_bf16_f32 v45, v90, v91
    v_exp_f32 v94, v94
    v_exp_f32 v95, v95
    v_cvt_pk_bf16_f32 v46, v92, v93
    v_cvt_pk_bf16_f32 v47, v94, v95
    v_exp_f32 v64, v64
    v_exp_f32 v65, v65
    v_mfma_f32_32x32x16_bf16 v[96:111], v[36:39], v[44:47], v[96:111]
    v_exp_f32 v66, v66
    v_exp_f32 v67, v67
    v_cvt_pk_bf16_f32 v40, v64, v65
    v_exp_f32 v68, v68
    v_exp_f32 v69, v69
    v_cvt_pk_bf16_f32 v41, v66, v67
    v_exp_f32 v70, v70
    s_waitcnt lgkmcnt(0)
    v_mfma_f32_32x32x16_bf16 v[80:95], v[20:23], v[12:15], v[48:63]
    ds_read_b128 v[16:19], v2 offset:30720
    ds_read_b128 v[32:35], v113 offset:5120
    ds_read_b128 v[36:39], v113 offset:5632
    v_exp_f32 v71, v71
    v_cvt_pk_bf16_f32 v42, v68, v69
    v_exp_f32 v72, v72
    v_cvt_pk_bf16_f32 v43, v70, v71
    v_exp_f32 v73, v73
    v_exp_f32 v74, v74
    v_exp_f32 v75, v75
    v_cvt_pk_bf16_f32 v44, v72, v73
    v_mfma_f32_32x32x16_bf16 v[96:111], v[24:27], v[40:43], v[96:111]
    v_exp_f32 v76, v76
    v_exp_f32 v77, v77
    v_cvt_pk_bf16_f32 v45, v74, v75
    s_waitcnt vmcnt(0)
    s_mov_b64 exec, 1
    v_mov_b32 v125, 163832
    v_mov_b32 v124, 1
    ds_add_rtn_u32 v126, v125, v124
    s_mov_b64 exec, -1
    v_exp_f32 v78, v78
    v_exp_f32 v79, v79
    v_cvt_pk_bf16_f32 v46, v76, v77
    v_cvt_pk_bf16_f32 v47, v78, v79
    v_exp_f32 v80, v80
    v_exp_f32 v81, v81
    v_mfma_f32_32x32x16_bf16 v[96:111], v[28:31], v[44:47], v[96:111]
    v_exp_f32 v82, v82
    v_exp_f32 v83, v83
    v_cvt_pk_bf16_f32 v40, v80, v81
    v_exp_f32 v84, v84
    v_exp_f32 v85, v85
    v_cvt_pk_bf16_f32 v41, v82, v83
    v_exp_f32 v86, v86
    s_waitcnt lgkmcnt(0)
    v_mfma_f32_32x32x16_bf16 v[64:79], v[16:19], v[12:15], v[48:63]
    ds_read_b128 v[20:23], v2 offset:31744
    ds_read_b128 v[24:27], v113 offset:6144
    ds_read_b128 v[28:31], v113 offset:6656
    v_exp_f32 v87, v87
    v_cvt_pk_bf16_f32 v42, v84, v85
    v_exp_f32 v88, v88
    v_cvt_pk_bf16_f32 v43, v86, v87
    v_exp_f32 v89, v89
    v_exp_f32 v90, v90
    v_exp_f32 v91, v91
    v_cvt_pk_bf16_f32 v44, v88, v89
    v_mfma_f32_32x32x16_bf16 v[96:111], v[32:35], v[40:43], v[96:111]
    v_exp_f32 v92, v92
    v_exp_f32 v93, v93
    v_cvt_pk_bf16_f32 v45, v90, v91
    v_readfirstlane_b32 s30, v126
    s_lshl_b32 s31, s2, 2
    s_add_u32 s31, s31, 0x1b00000
    s_cmp_eq_u32 s30, 7
    s_cselect_b32 s31, s31, 0x7ff00000
    s_mov_b64 exec, 1
    v_mov_b32 v124, s56
    buffer_store_dword v124, v2, s[16:19], s31 offen sc1
    s_mov_b64 exec, -1
    v_exp_f32 v94, v94
    v_exp_f32 v95, v95
    v_cvt_pk_bf16_f32 v46, v92, v93
    v_cvt_pk_bf16_f32 v47, v94, v95
    v_exp_f32 v64, v64
    v_exp_f32 v65, v65
    v_mfma_f32_32x32x16_bf16 v[96:111], v[36:39], v[44:47], v[96:111]
    v_exp_f32 v66, v66
    v_exp_f32 v67, v67
    v_cvt_pk_bf16_f32 v40, v64, v65
    v_exp_f32 v68, v68
    v_exp_f32 v69, v69
    v_cvt_pk_bf16_f32 v41, v66, v67
    v_exp_f32 v70, v70
    s_waitcnt lgkmcnt(0)
    v_mfma_f32_32x32x16_bf16 v[80:95], v[20:23], v[12:15], v[48:63]
    ds_read_b128 v[16:19], v2 offset:32768
    ds_read_b128 v[32:35], v113 offset:7168
    ds_read_b128 v[36:39], v113 offset:7680
    v_exp_f32 v71, v71
    v_cvt_pk_bf16_f32 v42, v68, v69
    v_exp_f32 v72, v72
    v_cvt_pk_bf16_f32 v43, v70, v71
    v_exp_f32 v73, v73
    v_exp_f32 v74, v74
    v_exp_f32 v75, v75
    v_cvt_pk_bf16_f32 v44, v72, v73
    v_mfma_f32_32x32x16_bf16 v[96:111], v[24:27], v[40:43], v[96:111]
    v_exp_f32 v76, v76
    v_exp_f32 v77, v77
    v_cvt_pk_bf16_f32 v45, v74, v75
    s_add_u32 s30, s40, 0xc00000
    s_cmp_eq_u32 s34, 0
    s_cbranch_scc1 L_sst8
    buffer_store_dwordx4 v[116:119], v2, s[16:19], s30 offen
L_ssd8:
    s_mov_b32 s20, s60
    s_and_b32 s21, s61, 0xffff
    s_mov_b32 s22, 0x200000
    s_mov_b32 s23, 0x20000
    s_and_b32 s39, s24, 0
    s_lshl_b32 s39, s39, 13
    s_lshl_b32 s30, s26, 14
    s_lshl_b32 s31, s27, 13
    s_add_u32 s30, s30, s31
    s_lshr_b32 s31, s25, 2
    s_lshl_b32 s31, s31, 12
    s_add_u32 s30, s30, s31
    s_add_u32 s30, s30, s41
    v_add_u32 v4, s30, v2
    v_xor_b32 v5, 0x1000, v4
    s_andn2_b32 s30, s30, 0x1000
    v_and_b32 v3, 15, v1
    v_lshl_add_u32 v3, v3, 9, s30
    s_mul_i32 s30, s27, 0x10800
    v_add_u32 v8, s30, v2
    v_xor_b32 v9, 0x800, v8
    s_lshl_b32 s30, s3, 11
    s_add_u32 s30, s30, 131072
    v_add_u32 v11, s30, v2
    v_xor_b32 v10, 0x2000, v11
    v_mov_b32 v0, 0
    s_lshl_b32 s38, s26, 1
    s_xor_b32 s38, s38, s25
    s_lshl_b32 s38, s38, 12
    s_lshl_b32 s30, s27, 16
    s_add_u32 s38, s38, s30
    v_exp_f32 v78, v78
    v_exp_f32 v79, v79
    v_cvt_pk_bf16_f32 v46, v76, v77
    v_cvt_pk_bf16_f32 v47, v78, v79
    s_setprio 0
    v_exp_f32 v80, v80
    v_exp_f32 v81, v81
    v_mfma_f32_32x32x16_bf16 v[96:111], v[28:31], v[44:47], v[96:111]
    v_exp_f32 v82, v82
    v_exp_f32 v83, v83
    v_cvt_pk_bf16_f32 v40, v80, v81
    v_exp_f32 v84, v84
    v_exp_f32 v85, v85
    v_cvt_pk_bf16_f32 v41, v82, v83
    v_exp_f32 v86, v86
    s_waitcnt lgkmcnt(0)
    v_mfma_f32_32x32x16_bf16 v[64:79], v[16:19], v[12:15], v[48:63]
    ds_read_b128 v[20:23], v2 offset:33792
    v_add_u32 v113, v112, v113
    ds_read_b128 v[24:27], v113 offset:0
    ds_read_b128 v[28:31], v113 offset:512
    v_exp_f32 v87, v87
    v_cvt_pk_bf16_f32 v42, v84, v85
    v_exp_f32 v88, v88
    v_cvt_pk_bf16_f32 v43, v86, v87
    v_exp_f32 v89, v89
    v_exp_f32 v90, v90
    v_exp_f32 v91, v91
    v_cvt_pk_bf16_f32 v44, v88, v89
    v_mfma_f32_32x32x16_bf16 v[96:111], v[32:35], v[40:43], v[96:111]
    v_exp_f32 v92, v92
    v_exp_f32 v93, v93
    v_cvt_pk_bf16_f32 v45, v90, v91
    s_lshl_b32 s30, s26, 14
    s_add_u32 s30, s30, s41
    s_lshl_b32 s31, s25, 7
    s_add_u32 s30, s30, s31
    s_lshl_b32 s31, s27, 6
    s_add_u32 s30, s30, s31
    v_and_b32 v124, 15, v1
    v_and_b32 v125, 48, v1
    v_lshl_add_u32 v124, v124, 10, v125
    buffer_load_dwordx4 v[120:123], v124, s[12:15], s30 offen
    v_exp_f32 v94, v94
    v_exp_f32 v95, v95
    v_cvt_pk_bf16_f32 v46, v92, v93
    v_cvt_pk_bf16_f32 v47, v94, v95
    s_barrier
    s_setprio 3
    v_exp_f32 v64, v64
    v_exp_f32 v65, v65
    v_mfma_f32_32x32x16_bf16 v[96:111], v[36:39], v[44:47], v[96:111]
    v_exp_f32 v66, v66
    v_exp_f32 v67, v67
    v_cvt_pk_bf16_f32 v40, v64, v65
    v_exp_f32 v68, v68
    v_exp_f32 v69, v69
    v_cvt_pk_bf16_f32 v41, v66, v67
    v_exp_f32 v70, v70
    s_waitcnt lgkmcnt(0)
    v_mfma_f32_32x32x16_bf16 v[80:95], v[20:23], v[12:15], v[48:63]
    ds_read_b128 v[16:19], v2 offset:34816
    ds_read_b128 v[32:35], v113 offset:1024
    ds_read_b128 v[36:39], v113 offset:1536
    v_exp_f32 v71, v71
    v_cvt_pk_bf16_f32 v42, v68, v69
    v_exp_f32 v72, v72
    v_cvt_pk_bf16_f32 v43, v70, v71
    v_exp_f32 v73, v73
    v_exp_f32 v74, v74
    v_exp_f32 v75, v75
    v_cvt_pk_bf16_f32 v44, v72, v73
    v_mfma_f32_32x32x16_bf16 v[96:111], v[24:27], v[40:43], v[96:111]
    v_exp_f32 v76, v76
    v_exp_f32 v77, v77
    v_cvt_pk_bf16_f32 v45, v74, v75
    s_mov_b32 s30, s57
    s_cmp_eq_u32 s34, 0
    s_cbranch_scc1 L_sst9
    buffer_store_dwordx4 v[116:119], v2, s[16:19], s30 offen
L_ssd9:
    v_exp_f32 v78, v78
    v_exp_f32 v79, v79
    v_cvt_pk_bf16_f32 v46, v76, v77
    v_cvt_pk_bf16_f32 v47, v78, v79
    v_exp_f32 v80, v80
    v_exp_f32 v81, v81
    v_mfma_f32_32x32x16_bf16 v[96:111], v[28:31], v[44:47], v[96:111]
    v_exp_f32 v82, v82
    v_exp_f32 v83, v83
    v_cvt_pk_bf16_f32 v40, v80, v81
    v_exp_f32 v84, v84
    v_exp_f32 v85, v85
    v_cvt_pk_bf16_f32 v41, v82, v83
    v_exp_f32 v86, v86
    s_waitcnt lgkmcnt(0)
    v_mfma_f32_32x32x16_bf16 v[64:79], v[16:19], v[12:15], v[48:63]
    ds_read_b128 v[20:23], v2 offset:35840
    ds_read_b128 v[24:27], v113 offset:2048
    ds_read_b128 v[28:31], v113 offset:2560
    v_exp_f32 v87, v87
    v_cvt_pk_bf16_f32 v42, v84, v85
    v_exp_f32 v88, v88
    v_cvt_pk_bf16_f32 v43, v86, v87
    v_exp_f32 v89, v89
    v_exp_f32 v90, v90
    v_exp_f32 v91, v91
    v_cvt_pk_bf16_f32 v44, v88, v89
    v_mfma_f32_32x32x16_bf16 v[96:111], v[32:35], v[40:43], v[96:111]
    v_exp_f32 v92, v92
    v_exp_f32 v93, v93
    v_cvt_pk_bf16_f32 v45, v90, v91
    s_mov_b32 s30, s57
    s_cmp_eq_u32 s34, 0
    s_cbranch_scc1 L_sst10
    buffer_store_dwordx4 v[116:119], v2, s[16:19], s30 offen offset:1024
L_ssd10:
    v_exp_f32 v94, v94
    v_exp_f32 v95, v95
    v_cvt_pk_bf16_f32 v46, v92, v93
    v_cvt_pk_bf16_f32 v47, v94, v95
    v_exp_f32 v64, v64
    v_exp_f32 v65, v65
    v_mfma_f32_32x32x16_bf16 v[96:111], v[36:39], v[44:47], v[96:111]
    v_exp_f32 v66, v66
    v_exp_f32 v67, v67
    v_cvt_pk_bf16_f32 v40, v64, v65
    v_exp_f32 v68, v68
    v_exp_f32 v69, v69
    v_cvt_pk_bf16_f32 v41, v66, v67
    v_exp_f32 v70, v70
    s_waitcnt lgkmcnt(0)
    v_mfma_f32_32x32x16_bf16 v[80:95], v[20:23], v[12:15], v[48:63]
    ds_read_b128 v[16:19], v2 offset:36864
    ds_read_b128 v[32:35], v113 offset:3072
    ds_read_b128 v[36:39], v113 offset:3584
    v_exp_f32 v71, v71
    v_cvt_pk_bf16_f32 v42, v68, v69
    v_exp_f32 v72, v72
    v_cvt_pk_bf16_f32 v43, v70, v71
    v_exp_f32 v73, v73
    v_exp_f32 v74, v74
    v_exp_f32 v75, v75
    v_cvt_pk_bf16_f32 v44, v72, v73
    v_mfma_f32_32x32x16_bf16 v[96:111], v[24:27], v[40:43], v[96:111]
    v_exp_f32 v76, v76
    v_exp_f32 v77, v77
    v_cvt_pk_bf16_f32 v45, v74, v75
    s_mov_b32 s30, s57
    s_add_u32 s30, s30, 114688
    s_cmp_eq_u32 s34, 0
    s_cbranch_scc1 L_sst11
    buffer_store_dwordx4 v[116:119], v2, s[16:19], s30 offen
L_ssd11:
    v_exp_f32 v78, v78
    v_exp_f32 v79, v79
    v_cvt_pk_bf16_f32 v46, v76, v77
    v_cvt_pk_bf16_f32 v47, v78, v79
    v_exp_f32 v80, v80
    v_exp_f32 v81, v81
    v_mfma_f32_32x32x16_bf16 v[96:111], v[28:31], v[44:47], v[96:111]
    v_exp_f32 v82, v82
    v_exp_f32 v83, v83
    v_cvt_pk_bf16_f32 v40, v80, v81
    v_exp_f32 v84, v84
    v_exp_f32 v85, v85
    v_cvt_pk_bf16_f32 v41, v82, v83
    v_exp_f32 v86, v86
    s_waitcnt lgkmcnt(0)
    v_mfma_f32_32x32x16_bf16 v[64:79], v[16:19], v[12:15], v[48:63]
    ds_read_b128 v[20:23], v2 offset:37888
    ds_read_b128 v[24:27], v113 offset:4096
    ds_read_b128 v[28:31], v113 offset:4608
    v_exp_f32 v87, v87
    v_cvt_pk_bf16_f32 v42, v84, v85
    v_exp_f32 v88, v88
    v_cvt_pk_bf16_f32 v43, v86, v87
    v_exp_f32 v89, v89
    v_exp_f32 v90, v90
    v_exp_f32 v91, v91
    v_cvt_pk_bf16_f32 v44, v88, v89
    v_mfma_f32_32x32x16_bf16 v[96:111], v[32:35], v[40:43], v[96:111]
    v_exp_f32 v92, v92
    v_exp_f32 v93, v93
    v_cvt_pk_bf16_f32 v45, v90, v91
    s_mov_b32 s30, s57
    s_add_u32 s30, s30, 114688
    s_cmp_eq_u32 s34, 0
    s_cbranch_scc1 L_sst12
    buffer_store_dwordx4 v[116:119], v2, s[16:19], s30 offen offset:1024
L_ssd12:
    v_exp_f32 v94, v94
    v_exp_f32 v95, v95
    v_cvt_pk_bf16_f32 v46, v92, v93
    v_cvt_pk_bf16_f32 v47, v94, v95
    v_exp_f32 v64, v64
    v_exp_f32 v65, v65
    v_mfma_f32_32x32x16_bf16 v[96:111], v[36:39], v[44:47], v[96:111]
    v_exp_f32 v66, v66
    v_exp_f32 v67, v67
    v_cvt_pk_bf16_f32 v40, v64, v65
    v_exp_f32 v68, v68
    v_exp_f32 v69, v69
    v_cvt_pk_bf16_f32 v41, v66, v67
    v_exp_f32 v70, v70
    s_waitcnt lgkmcnt(0)
    v_mfma_f32_32x32x16_bf16 v[80:95], v[20:23], v[12:15], v[48:63]
    ds_read_b128 v[16:19], v2 offset:38912
    ds_read_b128 v[32:35], v113 offset:5120
    ds_read_b128 v[36:39], v113 offset:5632
    v_exp_f32 v71, v71
    v_cvt_pk_bf16_f32 v42, v68, v69
    v_exp_f32 v72, v72
    v_cvt_pk_bf16_f32 v43, v70, v71
    v_exp_f32 v73, v73
    v_exp_f32 v74, v74
    v_exp_f32 v75, v75
    v_cvt_pk_bf16_f32 v44, v72, v73
    v_mfma_f32_32x32x16_bf16 v[96:111], v[24:27], v[40:43], v[96:111]
    v_exp_f32 v76, v76
    v_exp_f32 v77, v77
    v_cvt_pk_bf16_f32 v45, v74, v75
    v_exp_f32 v78, v78
    v_exp_f32 v79, v79
    v_cvt_pk_bf16_f32 v46, v76, v77
    v_cvt_pk_bf16_f32 v47, v78, v79
    v_exp_f32 v80, v80
    v_exp_f32 v81, v81
    v_mfma_f32_32x32x16_bf16 v[96:111], v[28:31], v[44:47], v[96:111]
    v_exp_f32 v82, v82
    v_exp_f32 v83, v83
    v_cvt_pk_bf16_f32 v40, v80, v81
    v_exp_f32 v84, v84
    v_exp_f32 v85, v85
    v_cvt_pk_bf16_f32 v41, v82, v83
    v_exp_f32 v86, v86
    s_waitcnt lgkmcnt(0)
    v_mfma_f32_32x32x16_bf16 v[64:79], v[16:19], v[12:15], v[48:63]
    ds_read_b128 v[20:23], v2 offset:39936
    ds_read_b128 v[24:27], v113 offset:6144
    ds_read_b128 v[28:31], v113 offset:6656
    v_exp_f32 v87, v87
    v_cvt_pk_bf16_f32 v42, v84, v85
    v_exp_f32 v88, v88
    v_cvt_pk_bf16_f32 v43, v86, v87
    v_exp_f32 v89, v89
    v_exp_f32 v90, v90
    v_exp_f32 v91, v91
    v_cvt_pk_bf16_f32 v44, v88, v89
    v_mfma_f32_32x32x16_bf16 v[96:111], v[32:35], v[40:43], v[96:111]
    v_exp_f32 v92, v92
    v_exp_f32 v93, v93
    v_cvt_pk_bf16_f32 v45, v90, v91
    v_exp_f32 v94, v94
    v_exp_f32 v95, v95
    v_cvt_pk_bf16_f32 v46, v92, v93
    v_cvt_pk_bf16_f32 v47, v94, v95
    v_exp_f32 v64, v64
    v_exp_f32 v65, v65
    v_mfma_f32_32x32x16_bf16 v[96:111], v[36:39], v[44:47], v[96:111]
    v_exp_f32 v66, v66
    v_exp_f32 v67, v67
    v_cvt_pk_bf16_f32 v40, v64, v65
    v_exp_f32 v68, v68
    v_exp_f32 v69, v69
    v_cvt_pk_bf16_f32 v41, v66, v67
    v_exp_f32 v70, v70
    s_waitcnt lgkmcnt(0)
    v_mfma_f32_32x32x16_bf16 v[80:95], v[20:23], v[12:15], v[48:63]
    ds_read_b128 v[16:19], v2 offset:40960
    ds_read_b128 v[32:35], v113 offset:7168
    ds_read_b128 v[36:39], v113 offset:7680
    v_exp_f32 v71, v71
    v_cvt_pk_bf16_f32 v42, v68, v69
    v_exp_f32 v72, v72
    v_cvt_pk_bf16_f32 v43, v70, v71
    v_exp_f32 v73, v73
    v_exp_f32 v74, v74
    v_exp_f32 v75, v75
    v_cvt_pk_bf16_f32 v44, v72, v73
    v_mfma_f32_32x32x16_bf16 v[96:111], v[24:27], v[40:43], v[96:111]
    v_exp_f32 v76, v76
    v_exp_f32 v77, v77
    v_cvt_pk_bf16_f32 v45, v74, v75
    v_exp_f32 v78, v78
    v_exp_f32 v79, v79
    v_cvt_pk_bf16_f32 v46, v76, v77
    v_cvt_pk_bf16_f32 v47, v78, v79
    v_exp_f32 v80, v80
    v_exp_f32 v81, v81
    v_mfma_f32_32x32x16_bf16 v[96:111], v[28:31], v[44:47], v[96:111]
    v_exp_f32 v82, v82
    v_exp_f32 v83, v83
    v_cvt_pk_bf16_f32 v40, v80, v81
    v_exp_f32 v84, v84
    v_exp_f32 v85, v85
    v_cvt_pk_bf16_f32 v41, v82, v83
    v_exp_f32 v86, v86
    s_waitcnt lgkmcnt(0)
    v_mfma_f32_32x32x16_bf16 v[64:79], v[16:19], v[12:15], v[48:63]
    ds_read_b128 v[20:23], v2 offset:41984
    v_add_u32 v113, v112, v113
    ds_read_b128 v[24:27], v113 offset:0
    ds_read_b128 v[28:31], v113 offset:512
    v_exp_f32 v87, v87
    v_cvt_pk_bf16_f32 v42, v84, v85
    v_exp_f32 v88, v88
    v_cvt_pk_bf16_f32 v43, v86, v87
    v_exp_f32 v89, v89
    v_exp_f32 v90, v90
    v_exp_f32 v91, v91
    v_cvt_pk_bf16_f32 v44, v88, v89
    v_mfma_f32_32x32x16_bf16 v[96:111], v[32:35], v[40:43], v[96:111]
    v_exp_f32 v92, v92
    v_exp_f32 v93, v93
    v_cvt_pk_bf16_f32 v45, v90, v91
    v_exp_f32 v94, v94
    v_exp_f32 v95, v95
    v_cvt_pk_bf16_f32 v46, v92, v93
    v_cvt_pk_bf16_f32 v47, v94, v95
    v_exp_f32 v64, v64
    v_exp_f32 v65, v65
    v_mfma_f32_32x32x16_bf16 v[96:111], v[36:39], v[44:47], v[96:111]
    v_exp_f32 v66, v66
    v_exp_f32 v67, v67
    v_cvt_pk_bf16_f32 v40, v64, v65
    v_exp_f32 v68, v68
    v_exp_f32 v69, v69
    v_cvt_pk_bf16_f32 v41, v66, v67
    v_exp_f32 v70, v70
    s_waitcnt lgkmcnt(0)
    v_mfma_f32_32x32x16_bf16 v[80:95], v[20:23], v[12:15], v[48:63]
    ds_read_b128 v[16:19], v2 offset:43008
    ds_read_b128 v[32:35], v113 offset:1024
    ds_read_b128 v[36:39], v113 offset:1536
    v_exp_f32 v71, v71
    v_cvt_pk_bf16_f32 v42, v68, v69
    v_exp_f32 v72, v72
    v_cvt_pk_bf16_f32 v43, v70, v71
    v_exp_f32 v73, v73
    v_exp_f32 v74, v74
    v_exp_f32 v75, v75
    v_cvt_pk_bf16_f32 v44, v72, v73
    v_mfma_f32_32x32x16_bf16 v[96:111], v[24:27], v[40:43], v[96:111]
    v_exp_f32 v76, v76
    v_exp_f32 v77, v77
    v_cvt_pk_bf16_f32 v45, v74, v75
    v_exp_f32 v78, v78
    v_exp_f32 v79, v79
    v_cvt_pk_bf16_f32 v46, v76, v77
    v_cvt_pk_bf16_f32 v47, v78, v79
    v_exp_f32 v80, v80
    v_exp_f32 v81, v81
    v_mfma_f32_32x32x16_bf16 v[96:111], v[28:31], v[44:47], v[96:111]
    v_exp_f32 v82, v82
    v_exp_f32 v83, v83
    v_cvt_pk_bf16_f32 v40, v80, v81
    v_exp_f32 v84, v84
    v_exp_f32 v85, v85
    v_cvt_pk_bf16_f32 v41, v82, v83
    v_exp_f32 v86, v86
    s_waitcnt lgkmcnt(0)
    v_mfma_f32_32x32x16_bf16 v[64:79], v[16:19], v[12:15], v[48:63]
    ds_read_b128 v[20:23], v2 offset:44032
    ds_read_b128 v[24:27], v113 offset:2048
    ds_read_b128 v[28:31], v113 offset:2560
    v_exp_f32 v87, v87
    v_cvt_pk_bf16_f32 v42, v84, v85
    v_exp_f32 v88, v88
    v_cvt_pk_bf16_f32 v43, v86, v87
    v_exp_f32 v89, v89
    v_exp_f32 v90, v90
    v_exp_f32 v91, v91
    v_cvt_pk_bf16_f32 v44, v88, v89
    v_mfma_f32_32x32x16_bf16 v[96:111], v[32:35], v[40:43], v[96:111]
    v_exp_f32 v92, v92
    v_exp_f32 v93, v93
    v_cvt_pk_bf16_f32 v45, v90, v91
    s_cmp_eq_u32 s3, 0
    s_mov_b32 s55, 0x7ff00000
    s_cselect_b32 s55, 0x1b00000, s55
    buffer_load_dwordx4 v[244:247], v2, s[16:19], s55 offen sc1
    v_exp_f32 v94, v94
    v_exp_f32 v95, v95
    v_cvt_pk_bf16_f32 v46, v92, v93
    v_cvt_pk_bf16_f32 v47, v94, v95
    v_exp_f32 v64, v64
    v_exp_f32 v65, v65
    v_mfma_f32_32x32x16_bf16 v[96:111], v[36:39], v[44:47], v[96:111]
    v_exp_f32 v66, v66
    v_exp_f32 v67, v67
    v_cvt_pk_bf16_f32 v40, v64, v65
    v_exp_f32 v68, v68
    v_exp_f32 v69, v69
    v_cvt_pk_bf16_f32 v41, v66, v67
    v_exp_f32 v70, v70
    s_waitcnt lgkmcnt(0)
    v_mfma_f32_32x32x16_bf16 v[80:95], v[20:23], v[12:15], v[48:63]
    ds_read_b128 v[16:19], v2 offset:45056
    ds_read_b128 v[32:35], v113 offset:3072
    ds_read_b128 v[36:39], v113 offset:3584
    v_exp_f32 v71, v71
    v_cvt_pk_bf16_f32 v42, v68, v69
    v_exp_f32 v72, v72
    v_cvt_pk_bf16_f32 v43, v70, v71
    v_exp_f32 v73, v73
    v_exp_f32 v74, v74
    v_exp_f32 v75, v75
    v_cvt_pk_bf16_f32 v44, v72, v73
    v_mfma_f32_32x32x16_bf16 v[96:111], v[24:27], v[40:43], v[96:111]
    v_exp_f32 v76, v76
    v_exp_f32 v77, v77
    v_cvt_pk_bf16_f32 v45, v74, v75
    v_exp_f32 v78, v78
    v_exp_f32 v79, v79
    v_cvt_pk_bf16_f32 v46, v76, v77
    v_cvt_pk_bf16_f32 v47, v78, v79
    v_exp_f32 v80, v80
    v_exp_f32 v81, v81
    v_mfma_f32_32x32x16_bf16 v[96:111], v[28:31], v[44:47], v[96:111]
    v_exp_f32 v82, v82
    v_exp_f32 v83, v83
    v_cvt_pk_bf16_f32 v40, v80, v81
    v_exp_f32 v84, v84
    v_exp_f32 v85, v85
    v_cvt_pk_bf16_f32 v41, v82, v83
    v_exp_f32 v86, v86
    s_waitcnt lgkmcnt(0)
    v_mfma_f32_32x32x16_bf16 v[64:79], v[16:19], v[12:15], v[48:63]
    ds_read_b128 v[20:23], v2 offset:46080
    ds_read_b128 v[24:27], v113 offset:4096
    ds_read_b128 v[28:31], v113 offset:4608
    v_exp_f32 v87, v87
    v_cvt_pk_bf16_f32 v42, v84, v85
    v_exp_f32 v88, v88
    v_cvt_pk_bf16_f32 v43, v86, v87
    v_exp_f32 v89, v89
    v_exp_f32 v90, v90
    v_exp_f32 v91, v91
    v_cvt_pk_bf16_f32 v44, v88, v89
    v_mfma_f32_32x32x16_bf16 v[96:111], v[32:35], v[40:43], v[96:111]
    v_exp_f32 v92, v92
    v_exp_f32 v93, v93
    v_cvt_pk_bf16_f32 v45, v90, v91
    v_exp_f32 v94, v94
    v_exp_f32 v95, v95
    v_cvt_pk_bf16_f32 v46, v92, v93
    v_cvt_pk_bf16_f32 v47, v94, v95
    v_exp_f32 v64, v64
    v_exp_f32 v65, v65
    v_mfma_f32_32x32x16_bf16 v[96:111], v[36:39], v[44:47], v[96:111]
    v_exp_f32 v66, v66
    v_exp_f32 v67, v67
    v_cvt_pk_bf16_f32 v40, v64, v65
    v_exp_f32 v68, v68
    v_exp_f32 v69, v69
    v_cvt_pk_bf16_f32 v41, v66, v67
    v_exp_f32 v70, v70
    s_waitcnt lgkmcnt(0)
    v_mfma_f32_32x32x16_bf16 v[80:95], v[20:23], v[12:15], v[48:63]
    ds_read_b128 v[16:19], v2 offset:47104
    ds_read_b128 v[32:35], v113 offset:5120
    ds_read_b128 v[36:39], v113 offset:5632
    v_exp_f32 v71, v71
    v_cvt_pk_bf16_f32 v42, v68, v69
    v_exp_f32 v72, v72
    v_cvt_pk_bf16_f32 v43, v70, v71
    v_exp_f32 v73, v73
    v_exp_f32 v74, v74
    v_exp_f32 v75, v75
    v_cvt_pk_bf16_f32 v44, v72, v73
    v_mfma_f32_32x32x16_bf16 v[96:111], v[24:27], v[40:43], v[96:111]
    v_exp_f32 v76, v76
    v_exp_f32 v77, v77
    v_cvt_pk_bf16_f32 v45, v74, v75
    s_cmp_lg_u32 s3, 0
    s_cbranch_scc1 L_pkskip
    s_mov_b32 s36, 0
L_pkchk:
    s_waitcnt vmcnt(0)
    v_xor_b32 v244, s56, v244
    v_xor_b32 v245, s56, v245
    v_xor_b32 v246, s56, v246
    v_xor_b32 v247, s56, v247
    v_or3_b32 v126, v244, v245, v246
    v_or_b32 v126, v126, v247
    v_cmp_ne_u32 vcc, 0, v126
    s_cbranch_vccnz L_pkretry
L_pkok:
    v_mov_b32 v126, 163836
    ds_write_b32 v126, v126
    s_cmp_eq_u32 s2, 0
    s_mov_b32 s30, 0x7ff00000
    s_cselect_b32 s30, 0x1b05000, s30
    s_mov_b64 exec, 1
    v_mov_b32 v127, s56
    buffer_store_dword v127, v2, s[16:19], s30 offen sc1
    s_mov_b64 exec, -1
    s_waitcnt lgkmcnt(0)
L_pkskip:
    s_nop 1
    v_exp_f32 v78, v78
    v_exp_f32 v79, v79
    v_cvt_pk_bf16_f32 v46, v76, v77
    v_cvt_pk_bf16_f32 v47, v78, v79
    v_exp_f32 v80, v80
    v_exp_f32 v81, v81
    v_mfma_f32_32x32x16_bf16 v[96:111], v[28:31], v[44:47], v[96:111]
    v_exp_f32 v82, v82
    v_exp_f32 v83, v83
    v_cvt_pk_bf16_f32 v40, v80, v81
    v_exp_f32 v84, v84
    v_exp_f32 v85, v85
    v_cvt_pk_bf16_f32 v41, v82, v83
    v_exp_f32 v86, v86
    s_waitcnt lgkmcnt(0)
    v_mfma_f32_32x32x16_bf16 v[64:79], v[16:19], v[12:15], v[48:63]
    ds_read_b128 v[20:23], v2 offset:48128
    ds_read_b128 v[24:27], v113 offset:6144
    ds_read_b128 v[28:31], v113 offset:6656
    v_exp_f32 v87, v87
    v_cvt_pk_bf16_f32 v42, v84, v85
    v_exp_f32 v88, v88
    v_cvt_pk_bf16_f32 v43, v86, v87
    v_exp_f32 v89, v89
    v_exp_f32 v90, v90
    v_exp_f32 v91, v91
    v_cvt_pk_bf16_f32 v44, v88, v89
    v_mfma_f32_32x32x16_bf16 v[96:111], v[32:35], v[40:43], v[96:111]
    v_exp_f32 v92, v92
    v_exp_f32 v93, v93
    v_cvt_pk_bf16_f32 v45, v90, v91
    v_mov_b32 v125, 163836
    ds_read_b32 v124, v125
    v_exp_f32 v94, v94
    v_exp_f32 v95, v95
    v_cvt_pk_bf16_f32 v46, v92, v93
    v_cvt_pk_bf16_f32 v47, v94, v95
    v_exp_f32 v64, v64
    v_exp_f32 v65, v65
    v_mfma_f32_32x32x16_bf16 v[96:111], v[36:39], v[44:47], v[96:111]
    v_exp_f32 v66, v66
    v_exp_f32 v67, v67
    v_cvt_pk_bf16_f32 v40, v64, v65
    v_exp_f32 v68, v68
    v_exp_f32 v69, v69
    v_cvt_pk_bf16_f32 v41, v66, v67
    v_exp_f32 v70, v70
    s_waitcnt lgkmcnt(0)
    v_mfma_f32_32x32x16_bf16 v[80:95], v[20:23], v[12:15], v[48:63]
    ds_read_b128 v[16:19], v2 offset:49152
    ds_read_b128 v[32:35], v113 offset:7168
    ds_read_b128 v[36:39], v113 offset:7680
    v_exp_f32 v71, v71
    v_cvt_pk_bf16_f32 v42, v68, v69
    v_exp_f32 v72, v72
    v_cvt_pk_bf16_f32 v43, v70, v71
    v_exp_f32 v73, v73
    v_exp_f32 v74, v74
    v_exp_f32 v75, v75
    v_cvt_pk_bf16_f32 v44, v72, v73
    v_mfma_f32_32x32x16_bf16 v[96:111], v[24:27], v[40:43], v[96:111]
    v_exp_f32 v76, v76
    v_exp_f32 v77, v77
    v_cvt_pk_bf16_f32 v45, v74, v75
L_rdchk:
    v_cmp_eq_u32 vcc, 0, v124
    s_cbranch_vccnz L_rdwait
    s_lshr_b32 s33, s39, 2
    s_xor_b32 s33, s33, 0x0
    s_xor_b32 m0, s38, s33
    s_add_u32 s33, s33, s59
    s_add_u32 s33, s33, 0x1500000
    buffer_load_dwordx4 v2, s[16:19], s33 offen offset:0 sc1 lds
    s_lshr_b32 s33, s39, 2
    s_xor_b32 s33, s33, 0x0
    s_xor_b32 m0, s38, s33
    s_add_u32 s33, s33, s59
    s_add_u32 s33, s33, 0x1500000
    buffer_load_dwordx4 v2, s[16:19], s33 offen offset:1024 sc1 lds
    v_exp_f32 v78, v78
    v_exp_f32 v79, v79
    v_cvt_pk_bf16_f32 v46, v76, v77
    v_cvt_pk_bf16_f32 v47, v78, v79
    v_exp_f32 v80, v80
    v_exp_f32 v81, v81
    v_mfma_f32_32x32x16_bf16 v[96:111], v[28:31], v[44:47], v[96:111]
    v_exp_f32 v82, v82
    v_exp_f32 v83, v83
    v_cvt_pk_bf16_f32 v40, v80, v81
    v_exp_f32 v84, v84
    v_exp_f32 v85, v85
    v_cvt_pk_bf16_f32 v41, v82, v83
    v_exp_f32 v86, v86
    s_waitcnt lgkmcnt(0)
    v_mfma_f32_32x32x16_bf16 v[64:79], v[16:19], v[12:15], v[48:63]
    ds_read_b128 v[20:23], v2 offset:50176
    v_add_u32 v113, v112, v113
    ds_read_b128 v[24:27], v113 offset:0
    ds_read_b128 v[28:31], v113 offset:512
    v_exp_f32 v87, v87
    v_cvt_pk_bf16_f32 v42, v84, v85
    v_exp_f32 v88, v88
    v_cvt_pk_bf16_f32 v43, v86, v87
    v_exp_f32 v89, v89
    v_exp_f32 v90, v90
    v_exp_f32 v91, v91
    v_cvt_pk_bf16_f32 v44, v88, v89
    v_mfma_f32_32x32x16_bf16 v[96:111], v[32:35], v[40:43], v[96:111]
    v_exp_f32 v92, v92
    v_exp_f32 v93, v93
    v_cvt_pk_bf16_f32 v45, v90, v91
    s_lshr_b32 s33, s39, 2
    s_xor_b32 s33, s33, 0x800
    s_xor_b32 m0, s38, s33
    s_add_u32 s33, s33, s59
    s_add_u32 s33, s33, 0x1500000
    buffer_load_dwordx4 v2, s[16:19], s33 offen offset:0 sc1 lds
    s_lshr_b32 s33, s39, 2
    s_xor_b32 s33, s33, 0x800
    s_xor_b32 m0, s38, s33
    s_add_u32 s33, s33, s59
    s_add_u32 s33, s33, 0x1500000
    buffer_load_dwordx4 v2, s[16:19], s33 offen offset:1024 sc1 lds
    v_exp_f32 v94, v94
    v_exp_f32 v95, v95
    v_cvt_pk_bf16_f32 v46, v92, v93
    v_cvt_pk_bf16_f32 v47, v94, v95
    v_exp_f32 v64, v64
    v_exp_f32 v65, v65
    v_mfma_f32_32x32x16_bf16 v[96:111], v[36:39], v[44:47], v[96:111]
    v_exp_f32 v66, v66
    v_exp_f32 v67, v67
    v_cvt_pk_bf16_f32 v40, v64, v65
    v_exp_f32 v68, v68
    v_exp_f32 v69, v69
    v_cvt_pk_bf16_f32 v41, v66, v67
    v_exp_f32 v70, v70
    s_waitcnt lgkmcnt(0)
    v_mfma_f32_32x32x16_bf16 v[80:95], v[20:23], v[12:15], v[48:63]
    ds_read_b128 v[16:19], v2 offset:51200
    ds_read_b128 v[32:35], v113 offset:1024
    ds_read_b128 v[36:39], v113 offset:1536
    v_exp_f32 v71, v71
    v_cvt_pk_bf16_f32 v42, v68, v69
    v_exp_f32 v72, v72
    v_cvt_pk_bf16_f32 v43, v70, v71
    v_exp_f32 v73, v73
    v_exp_f32 v74, v74
    v_exp_f32 v75, v75
    v_cvt_pk_bf16_f32 v44, v72, v73
    v_mfma_f32_32x32x16_bf16 v[96:111], v[24:27], v[40:43], v[96:111]
    v_exp_f32 v76, v76
    v_exp_f32 v77, v77
    v_cvt_pk_bf16_f32 v45, v74, v75
    s_lshr_b32 s33, s39, 2
    s_xor_b32 s33, s33, 0x1000
    s_xor_b32 m0, s38, s33
    s_add_u32 s33, s33, s59
    s_add_u32 s33, s33, 0x1500000
    buffer_load_dwordx4 v2, s[16:19], s33 offen offset:0 sc1 lds
    s_lshr_b32 s33, s39, 2
    s_xor_b32 s33, s33, 0x1000
    s_xor_b32 m0, s38, s33
    s_add_u32 s33, s33, s59
    s_add_u32 s33, s33, 0x1500000
    buffer_load_dwordx4 v2, s[16:19], s33 offen offset:1024 sc1 lds
    v_exp_f32 v78, v78
    v_exp_f32 v79, v79
    v_cvt_pk_bf16_f32 v46, v76, v77
    v_cvt_pk_bf16_f32 v47, v78, v79
    v_exp_f32 v80, v80
    v_exp_f32 v81, v81
    v_mfma_f32_32x32x16_bf16 v[96:111], v[28:31], v[44:47], v[96:111]
    v_exp_f32 v82, v82
    v_exp_f32 v83, v83
    v_cvt_pk_bf16_f32 v40, v80, v81
    v_exp_f32 v84, v84
    v_exp_f32 v85, v85
    v_cvt_pk_bf16_f32 v41, v82, v83
    v_exp_f32 v86, v86
    s_waitcnt lgkmcnt(0)
    v_mfma_f32_32x32x16_bf16 v[64:79], v[16:19], v[12:15], v[48:63]
    ds_read_b128 v[20:23], v2 offset:52224
    ds_read_b128 v[24:27], v113 offset:2048
    ds_read_b128 v[28:31], v113 offset:2560
    v_exp_f32 v87, v87
    v_cvt_pk_bf16_f32 v42, v84, v85
    v_exp_f32 v88, v88
    v_cvt_pk_bf16_f32 v43, v86, v87
    v_exp_f32 v89, v89
    v_exp_f32 v90, v90
    v_exp_f32 v91, v91
    v_cvt_pk_bf16_f32 v44, v88, v89
    v_mfma_f32_32x32x16_bf16 v[96:111], v[32:35], v[40:43], v[96:111]
    v_exp_f32 v92, v92
    v_exp_f32 v93, v93
    v_cvt_pk_bf16_f32 v45, v90, v91
    s_lshr_b32 s33, s39, 2
    s_xor_b32 s33, s33, 0x1800
    s_xor_b32 m0, s38, s33
    s_add_u32 s33, s33, s59
    s_add_u32 s33, s33, 0x1500000
    buffer_load_dwordx4 v2, s[16:19], s33 offen offset:0 sc1 lds
    s_lshr_b32 s33, s39, 2
    s_xor_b32 s33, s33, 0x1800
    s_xor_b32 m0, s38, s33
    s_add_u32 s33, s33, s59
    s_add_u32 s33, s33, 0x1500000
    buffer_load_dwordx4 v2, s[16:19], s33 offen offset:1024 sc1 lds
    v_exp_f32 v94, v94
    v_exp_f32 v95, v95
    v_cvt_pk_bf16_f32 v46, v92, v93
    v_cvt_pk_bf16_f32 v47, v94, v95
    s_setprio 2
    v_exp_f32 v64, v64
    v_exp_f32 v65, v65
    v_mfma_f32_32x32x16_bf16 v[96:111], v[36:39], v[44:47], v[96:111]
    v_exp_f32 v66, v66
    v_exp_f32 v67, v67
    v_cvt_pk_bf16_f32 v40, v64, v65
    v_exp_f32 v68, v68
    v_exp_f32 v69, v69
    v_cvt_pk_bf16_f32 v41, v66, v67
    v_exp_f32 v70, v70
    s_waitcnt lgkmcnt(0)
    v_mfma_f32_32x32x16_bf16 v[80:95], v[20:23], v[12:15], v[48:63]
    ds_read_b128 v[16:19], v2 offset:53248
    ds_read_b128 v[32:35], v113 offset:3072
    ds_read_b128 v[36:39], v113 offset:3584
    v_exp_f32 v71, v71
    v_cvt_pk_bf16_f32 v42, v68, v69
    v_exp_f32 v72, v72
    v_cvt_pk_bf16_f32 v43, v70, v71
    v_exp_f32 v73, v73
    v_exp_f32 v74, v74
    v_exp_f32 v75, v75
    v_cvt_pk_bf16_f32 v44, v72, v73
    v_mfma_f32_32x32x16_bf16 v[96:111], v[24:27], v[40:43], v[96:111]
    v_exp_f32 v76, v76
    v_exp_f32 v77, v77
    v_cvt_pk_bf16_f32 v45, v74, v75
    s_xor_b32 s33, s39, 0
    s_add_u32 s33, s33, s47
    buffer_load_dwordx4 v[128:131], v2, s[16:19], s33 offen offset:0 sc1
    s_xor_b32 s33, s39, 0
    s_add_u32 s33, s33, s47
    buffer_load_dwordx4 v[132:135], v2, s[16:19], s33 offen offset:1024 sc1
    v_exp_f32 v78, v78
    v_exp_f32 v79, v79
    v_cvt_pk_bf16_f32 v46, v76, v77
    v_cvt_pk_bf16_f32 v47, v78, v79
    v_exp_f32 v80, v80
    v_exp_f32 v81, v81
    v_mfma_f32_32x32x16_bf16 v[96:111], v[28:31], v[44:47], v[96:111]
    v_exp_f32 v82, v82
    v_exp_f32 v83, v83
    v_cvt_pk_bf16_f32 v40, v80, v81
    v_exp_f32 v84, v84
    v_exp_f32 v85, v85
    v_cvt_pk_bf16_f32 v41, v82, v83
    v_exp_f32 v86, v86
    s_waitcnt lgkmcnt(0)
    v_mfma_f32_32x32x16_bf16 v[64:79], v[16:19], v[12:15], v[48:63]
    ds_read_b128 v[20:23], v2 offset:54272
    ds_read_b128 v[24:27], v113 offset:4096
    ds_read_b128 v[28:31], v113 offset:4608
    v_exp_f32 v87, v87
    v_cvt_pk_bf16_f32 v42, v84, v85
    v_exp_f32 v88, v88
    v_cvt_pk_bf16_f32 v43, v86, v87
    v_exp_f32 v89, v89
    v_exp_f32 v90, v90
    v_exp_f32 v91, v91
    v_cvt_pk_bf16_f32 v44, v88, v89
    v_mfma_f32_32x32x16_bf16 v[96:111], v[32:35], v[40:43], v[96:111]
    v_exp_f32 v92, v92
    v_exp_f32 v93, v93
    v_cvt_pk_bf16_f32 v45, v90, v91
    s_xor_b32 s33, s39, 0
    s_add_u32 s33, s33, s47
    buffer_load_dwordx4 v[136:139], v2, s[16:19], s33 offen offset:2048 sc1
    s_xor_b32 s33, s39, 0
    s_add_u32 s33, s33, s47
    buffer_load_dwordx4 v[140:143], v2, s[16:19], s33 offen offset:3072 sc1
    v_exp_f32 v94, v94
    v_exp_f32 v95, v95
    v_cvt_pk_bf16_f32 v46, v92, v93
    v_cvt_pk_bf16_f32 v47, v94, v95
    v_exp_f32 v64, v64
    v_exp_f32 v65, v65
    v_mfma_f32_32x32x16_bf16 v[96:111], v[36:39], v[44:47], v[96:111]
    v_exp_f32 v66, v66
    v_exp_f32 v67, v67
    v_cvt_pk_bf16_f32 v40, v64, v65
    v_exp_f32 v68, v68
    v_exp_f32 v69, v69
    v_cvt_pk_bf16_f32 v41, v66, v67
    v_exp_f32 v70, v70
    s_waitcnt lgkmcnt(0)
    v_mfma_f32_32x32x16_bf16 v[80:95], v[20:23], v[12:15], v[48:63]
    ds_read_b128 v[16:19], v2 offset:55296
    ds_read_b128 v[32:35], v113 offset:5120
    ds_read_b128 v[36:39], v113 offset:5632
    v_exp_f32 v71, v71
    v_cvt_pk_bf16_f32 v42, v68, v69
    v_exp_f32 v72, v72
    v_cvt_pk_bf16_f32 v43, v70, v71
    v_exp_f32 v73, v73
    v_exp_f32 v74, v74
    v_exp_f32 v75, v75
    v_cvt_pk_bf16_f32 v44, v72, v73
    v_mfma_f32_32x32x16_bf16 v[96:111], v[24:27], v[40:43], v[96:111]
    v_exp_f32 v76, v76
    v_exp_f32 v77, v77
    v_cvt_pk_bf16_f32 v45, v74, v75
    s_xor_b32 s33, s39, 4096
    s_add_u32 s33, s33, s47
    buffer_load_dwordx4 v[144:147], v2, s[16:19], s33 offen offset:0 sc1
    s_xor_b32 s33, s39, 4096
    s_add_u32 s33, s33, s47
    buffer_load_dwordx4 v[148:151], v2, s[16:19], s33 offen offset:1024 sc1
    v_exp_f32 v78, v78
    v_exp_f32 v79, v79
    v_cvt_pk_bf16_f32 v46, v76, v77
    v_cvt_pk_bf16_f32 v47, v78, v79
    v_exp_f32 v80, v80
    v_exp_f32 v81, v81
    v_mfma_f32_32x32x16_bf16 v[96:111], v[28:31], v[44:47], v[96:111]
    v_exp_f32 v82, v82
    v_exp_f32 v83, v83
    v_cvt_pk_bf16_f32 v40, v80, v81
    v_exp_f32 v84, v84
    v_exp_f32 v85, v85
    v_cvt_pk_bf16_f32 v41, v82, v83
    v_exp_f32 v86, v86
    s_waitcnt lgkmcnt(0)
    v_mfma_f32_32x32x16_bf16 v[64:79], v[16:19], v[12:15], v[48:63]
    ds_read_b128 v[20:23], v2 offset:56320
    ds_read_b128 v[24:27], v113 offset:6144
    ds_read_b128 v[28:31], v113 offset:6656
    v_exp_f32 v87, v87
    v_cvt_pk_bf16_f32 v42, v84, v85
    v_exp_f32 v88, v88
    v_cvt_pk_bf16_f32 v43, v86, v87
    v_exp_f32 v89, v89
    v_exp_f32 v90, v90
    v_exp_f32 v91, v91
    v_cvt_pk_bf16_f32 v44, v88, v89
    v_mfma_f32_32x32x16_bf16 v[96:111], v[32:35], v[40:43], v[96:111]
    v_exp_f32 v92, v92
    v_exp_f32 v93, v93
    v_cvt_pk_bf16_f32 v45, v90, v91
    s_xor_b32 s33, s39, 4096
    s_add_u32 s33, s33, s47
    buffer_load_dwordx4 v[152:155], v2, s[16:19], s33 offen offset:2048 sc1
    s_xor_b32 s33, s39, 4096
    s_add_u32 s33, s33, s47
    buffer_load_dwordx4 v[156:159], v2, s[16:19], s33 offen offset:3072 sc1
    v_exp_f32 v94, v94
    v_exp_f32 v95, v95
    v_cvt_pk_bf16_f32 v46, v92, v93
    v_cvt_pk_bf16_f32 v47, v94, v95
    v_exp_f32 v64, v64
    v_exp_f32 v65, v65
    v_mfma_f32_32x32x16_bf16 v[96:111], v[36:39], v[44:47], v[96:111]
    v_exp_f32 v66, v66
    v_exp_f32 v67, v67
    v_cvt_pk_bf16_f32 v40, v64, v65
    v_exp_f32 v68, v68
    v_exp_f32 v69, v69
    v_cvt_pk_bf16_f32 v41, v66, v67
    v_exp_f32 v70, v70
    s_waitcnt lgkmcnt(0)
    v_mfma_f32_32x32x16_bf16 v[80:95], v[20:23], v[12:15], v[48:63]
    ds_read_b128 v[16:19], v2 offset:57344
    ds_read_b128 v[32:35], v113 offset:7168
    ds_read_b128 v[36:39], v113 offset:7680
    v_exp_f32 v71, v71
    v_cvt_pk_bf16_f32 v42, v68, v69
    v_exp_f32 v72, v72
    v_cvt_pk_bf16_f32 v43, v70, v71
    v_exp_f32 v73, v73
    v_exp_f32 v74, v74
    v_exp_f32 v75, v75
    v_cvt_pk_bf16_f32 v44, v72, v73
    v_mfma_f32_32x32x16_bf16 v[96:111], v[24:27], v[40:43], v[96:111]
    v_exp_f32 v76, v76
    v_exp_f32 v77, v77
    v_cvt_pk_bf16_f32 v45, v74, v75
    s_xor_b32 s33, s39, 8192
    s_add_u32 s33, s33, s47
    buffer_load_dwordx4 v[160:163], v2, s[16:19], s33 offen offset:0 sc1
    s_xor_b32 s33, s39, 8192
    s_add_u32 s33, s33, s47
    buffer_load_dwordx4 v[164:167], v2, s[16:19], s33 offen offset:1024 sc1
    v_exp_f32 v78, v78
    v_exp_f32 v79, v79
    v_cvt_pk_bf16_f32 v46, v76, v77
    v_cvt_pk_bf16_f32 v47, v78, v79
    v_exp_f32 v80, v80
    v_exp_f32 v81, v81
    v_mfma_f32_32x32x16_bf16 v[96:111], v[28:31], v[44:47], v[96:111]
    v_exp_f32 v82, v82
    v_exp_f32 v83, v83
    v_cvt_pk_bf16_f32 v40, v80, v81
    v_exp_f32 v84, v84
    v_exp_f32 v85, v85
    v_cvt_pk_bf16_f32 v41, v82, v83
    v_exp_f32 v86, v86
    s_waitcnt lgkmcnt(0)
    v_mfma_f32_32x32x16_bf16 v[64:79], v[16:19], v[12:15], v[48:63]
    ds_read_b128 v[20:23], v2 offset:58368
    v_add_u32 v113, v112, v113
    ds_read_b128 v[24:27], v113 offset:0
    ds_read_b128 v[28:31], v113 offset:512
    v_exp_f32 v87, v87
    v_cvt_pk_bf16_f32 v42, v84, v85
    v_exp_f32 v88, v88
    v_cvt_pk_bf16_f32 v43, v86, v87
    v_exp_f32 v89, v89
    v_exp_f32 v90, v90
    v_exp_f32 v91, v91
    v_cvt_pk_bf16_f32 v44, v88, v89
    v_mfma_f32_32x32x16_bf16 v[96:111], v[32:35], v[40:43], v[96:111]
    v_exp_f32 v92, v92
    v_exp_f32 v93, v93
    v_cvt_pk_bf16_f32 v45, v90, v91
    s_xor_b32 s33, s39, 8192
    s_add_u32 s33, s33, s47
    buffer_load_dwordx4 v[168:171], v2, s[16:19], s33 offen offset:2048 sc1
    s_xor_b32 s33, s39, 8192
    s_add_u32 s33, s33, s47
    buffer_load_dwordx4 v[172:175], v2, s[16:19], s33 offen offset:3072 sc1
    v_exp_f32 v94, v94
    v_exp_f32 v95, v95
    v_cvt_pk_bf16_f32 v46, v92, v93
    v_cvt_pk_bf16_f32 v47, v94, v95
    v_exp_f32 v64, v64
    v_exp_f32 v65, v65
    v_mfma_f32_32x32x16_bf16 v[96:111], v[36:39], v[44:47], v[96:111]
    v_exp_f32 v66, v66
    v_exp_f32 v67, v67
    v_cvt_pk_bf16_f32 v40, v64, v65
    v_exp_f32 v68, v68
    v_exp_f32 v69, v69
    v_cvt_pk_bf16_f32 v41, v66, v67
    v_exp_f32 v70, v70
    s_waitcnt lgkmcnt(0)
    v_mfma_f32_32x32x16_bf16 v[80:95], v[20:23], v[12:15], v[48:63]
    ds_read_b128 v[16:19], v2 offset:59392
    ds_read_b128 v[32:35], v113 offset:1024
    ds_read_b128 v[36:39], v113 offset:1536
    v_exp_f32 v71, v71
    v_cvt_pk_bf16_f32 v42, v68, v69
    v_exp_f32 v72, v72
    v_cvt_pk_bf16_f32 v43, v70, v71
    v_exp_f32 v73, v73
    v_exp_f32 v74, v74
    v_exp_f32 v75, v75
    v_cvt_pk_bf16_f32 v44, v72, v73
    v_mfma_f32_32x32x16_bf16 v[96:111], v[24:27], v[40:43], v[96:111]
    v_exp_f32 v76, v76
    v_exp_f32 v77, v77
    v_cvt_pk_bf16_f32 v45, v74, v75
    s_xor_b32 s33, s39, 12288
    s_add_u32 s33, s33, s47
    buffer_load_dwordx4 v[176:179], v2, s[16:19], s33 offen offset:0 sc1
    s_xor_b32 s33, s39, 12288
    s_add_u32 s33, s33, s47
    buffer_load_dwordx4 v[180:183], v2, s[16:19], s33 offen offset:1024 sc1
    v_exp_f32 v78, v78
    v_exp_f32 v79, v79
    v_cvt_pk_bf16_f32 v46, v76, v77
    v_cvt_pk_bf16_f32 v47, v78, v79
    v_exp_f32 v80, v80
    v_exp_f32 v81, v81
    v_mfma_f32_32x32x16_bf16 v[96:111], v[28:31], v[44:47], v[96:111]
    v_exp_f32 v82, v82
    v_exp_f32 v83, v83
    v_cvt_pk_bf16_f32 v40, v80, v81
    v_exp_f32 v84, v84
    v_exp_f32 v85, v85
    v_cvt_pk_bf16_f32 v41, v82, v83
    v_exp_f32 v86, v86
    s_waitcnt lgkmcnt(0)
    v_mfma_f32_32x32x16_bf16 v[64:79], v[16:19], v[12:15], v[48:63]
    ds_read_b128 v[20:23], v2 offset:60416
    ds_read_b128 v[24:27], v113 offset:2048
    ds_read_b128 v[28:31], v113 offset:2560
    v_exp_f32 v87, v87
    v_cvt_pk_bf16_f32 v42, v84, v85
    v_exp_f32 v88, v88
    v_cvt_pk_bf16_f32 v43, v86, v87
    v_exp_f32 v89, v89
    v_exp_f32 v90, v90
    v_exp_f32 v91, v91
    v_cvt_pk_bf16_f32 v44, v88, v89
    v_mfma_f32_32x32x16_bf16 v[96:111], v[32:35], v[40:43], v[96:111]
    v_exp_f32 v92, v92
    v_exp_f32 v93, v93
    v_cvt_pk_bf16_f32 v45, v90, v91
    s_xor_b32 s33, s39, 12288
    s_add_u32 s33, s33, s47
    buffer_load_dwordx4 v[184:187], v2, s[16:19], s33 offen offset:2048 sc1
    s_xor_b32 s33, s39, 12288
    s_add_u32 s33, s33, s47
    buffer_load_dwordx4 v[188:191], v2, s[16:19], s33 offen offset:3072 sc1
    v_exp_f32 v94, v94
    v_exp_f32 v95, v95
    v_cvt_pk_bf16_f32 v46, v92, v93
    v_cvt_pk_bf16_f32 v47, v94, v95
    v_exp_f32 v64, v64
    v_exp_f32 v65, v65
    v_mfma_f32_32x32x16_bf16 v[96:111], v[36:39], v[44:47], v[96:111]
    v_exp_f32 v66, v66
    v_exp_f32 v67, v67
    v_cvt_pk_bf16_f32 v40, v64, v65
    v_exp_f32 v68, v68
    v_exp_f32 v69, v69
    v_cvt_pk_bf16_f32 v41, v66, v67
    v_exp_f32 v70, v70
    s_waitcnt lgkmcnt(0)
    v_mfma_f32_32x32x16_bf16 v[80:95], v[20:23], v[12:15], v[48:63]
    ds_read_b128 v[16:19], v2 offset:61440
    ds_read_b128 v[32:35], v113 offset:3072
    ds_read_b128 v[36:39], v113 offset:3584
    v_exp_f32 v71, v71
    v_cvt_pk_bf16_f32 v42, v68, v69
    v_exp_f32 v72, v72
    v_cvt_pk_bf16_f32 v43, v70, v71
    v_exp_f32 v73, v73
    v_exp_f32 v74, v74
    v_exp_f32 v75, v75
    v_cvt_pk_bf16_f32 v44, v72, v73
    v_mfma_f32_32x32x16_bf16 v[96:111], v[24:27], v[40:43], v[96:111]
    v_exp_f32 v76, v76
    v_exp_f32 v77, v77
    v_cvt_pk_bf16_f32 v45, v74, v75
    s_xor_b32 s33, s39, 16384
    s_add_u32 s33, s33, s47
    buffer_load_dwordx4 v[192:195], v2, s[16:19], s33 offen offset:0 sc1
    s_xor_b32 s33, s39, 16384
    s_add_u32 s33, s33, s47
    buffer_load_dwordx4 v[196:199], v2, s[16:19], s33 offen offset:1024 sc1
    v_exp_f32 v78, v78
    v_exp_f32 v79, v79
    v_cvt_pk_bf16_f32 v46, v76, v77
    v_cvt_pk_bf16_f32 v47, v78, v79
    s_setprio 1
    v_exp_f32 v80, v80
    v_exp_f32 v81, v81
    v_mfma_f32_32x32x16_bf16 v[96:111], v[28:31], v[44:47], v[96:111]
    v_exp_f32 v82, v82
    v_exp_f32 v83, v83
    v_cvt_pk_bf16_f32 v40, v80, v81
    v_exp_f32 v84, v84
    v_exp_f32 v85, v85
    v_cvt_pk_bf16_f32 v41, v82, v83
    v_exp_f32 v86, v86
    s_waitcnt lgkmcnt(0)
    v_mfma_f32_32x32x16_bf16 v[64:79], v[16:19], v[12:15], v[48:63]
    ds_read_b128 v[20:23], v2 offset:62464
    ds_read_b128 v[24:27], v113 offset:4096
    ds_read_b128 v[28:31], v113 offset:4608
    v_exp_f32 v87, v87
    v_cvt_pk_bf16_f32 v42, v84, v85
    v_exp_f32 v88, v88
    v_cvt_pk_bf16_f32 v43, v86, v87
    v_exp_f32 v89, v89
    v_exp_f32 v90, v90
    v_exp_f32 v91, v91
    v_cvt_pk_bf16_f32 v44, v88, v89
    v_mfma_f32_32x32x16_bf16 v[96:111], v[32:35], v[40:43], v[96:111]
    v_exp_f32 v92, v92
    v_exp_f32 v93, v93
    v_cvt_pk_bf16_f32 v45, v90, v91
    s_xor_b32 s33, s39, 16384
    s_add_u32 s33, s33, s47
    buffer_load_dwordx4 v[200:203], v2, s[16:19], s33 offen offset:2048 sc1
    s_xor_b32 s33, s39, 16384
    s_add_u32 s33, s33, s47
    buffer_load_dwordx4 v[204:207], v2, s[16:19], s33 offen offset:3072 sc1
    v_exp_f32 v94, v94
    v_exp_f32 v95, v95
    v_cvt_pk_bf16_f32 v46, v92, v93
    v_cvt_pk_bf16_f32 v47, v94, v95
    v_exp_f32 v64, v64
    v_exp_f32 v65, v65
    v_mfma_f32_32x32x16_bf16 v[96:111], v[36:39], v[44:47], v[96:111]
    v_exp_f32 v66, v66
    v_exp_f32 v67, v67
    v_cvt_pk_bf16_f32 v40, v64, v65
    v_exp_f32 v68, v68
    v_exp_f32 v69, v69
    v_cvt_pk_bf16_f32 v41, v66, v67
    v_exp_f32 v70, v70
    s_waitcnt lgkmcnt(0)
    v_mfma_f32_32x32x16_bf16 v[80:95], v[20:23], v[12:15], v[48:63]
    ds_read_b128 v[16:19], v2 offset:63488
    ds_read_b128 v[32:35], v113 offset:5120
    ds_read_b128 v[36:39], v113 offset:5632
    v_exp_f32 v71, v71
    v_cvt_pk_bf16_f32 v42, v68, v69
    v_exp_f32 v72, v72
    v_cvt_pk_bf16_f32 v43, v70, v71
    v_exp_f32 v73, v73
    v_exp_f32 v74, v74
    v_exp_f32 v75, v75
    v_cvt_pk_bf16_f32 v44, v72, v73
    v_mfma_f32_32x32x16_bf16 v[96:111], v[24:27], v[40:43], v[96:111]
    v_exp_f32 v76, v76
    v_exp_f32 v77, v77
    v_cvt_pk_bf16_f32 v45, v74, v75
    s_xor_b32 s33, s39, 20480
    s_add_u32 s33, s33, s47
    buffer_load_dwordx4 v[208:211], v2, s[16:19], s33 offen offset:0 sc1
    s_xor_b32 s33, s39, 20480
    s_add_u32 s33, s33, s47
    buffer_load_dwordx4 v[212:215], v2, s[16:19], s33 offen offset:1024 sc1
    v_exp_f32 v78, v78
    v_exp_f32 v79, v79
    v_cvt_pk_bf16_f32 v46, v76, v77
    v_cvt_pk_bf16_f32 v47, v78, v79
    v_exp_f32 v80, v80
    v_exp_f32 v81, v81
    v_mfma_f32_32x32x16_bf16 v[96:111], v[28:31], v[44:47], v[96:111]
    v_exp_f32 v82, v82
    v_exp_f32 v83, v83
    v_cvt_pk_bf16_f32 v40, v80, v81
    v_exp_f32 v84, v84
    v_exp_f32 v85, v85
    v_cvt_pk_bf16_f32 v41, v82, v83
    v_exp_f32 v86, v86
    s_waitcnt lgkmcnt(0)
    v_mfma_f32_32x32x16_bf16 v[64:79], v[16:19], v[12:15], v[48:63]
    ds_read_b128 v[20:23], v2 offset:64512
    ds_read_b128 v[24:27], v113 offset:6144
    ds_read_b128 v[28:31], v113 offset:6656
    v_exp_f32 v87, v87
    v_cvt_pk_bf16_f32 v42, v84, v85
    v_exp_f32 v88, v88
    v_cvt_pk_bf16_f32 v43, v86, v87
    v_exp_f32 v89, v89
    v_exp_f32 v90, v90
    v_exp_f32 v91, v91
    v_cvt_pk_bf16_f32 v44, v88, v89
    v_mfma_f32_32x32x16_bf16 v[96:111], v[32:35], v[40:43], v[96:111]
    v_exp_f32 v92, v92
    v_exp_f32 v93, v93
    v_cvt_pk_bf16_f32 v45, v90, v91
    s_xor_b32 s33, s39, 20480
    s_add_u32 s33, s33, s47
    buffer_load_dwordx4 v[216:219], v2, s[16:19], s33 offen offset:2048 sc1
    s_xor_b32 s33, s39, 20480
    s_add_u32 s33, s33, s47
    buffer_load_dwordx4 v[220:223], v2, s[16:19], s33 offen offset:3072 sc1
    v_exp_f32 v94, v94
    v_exp_f32 v95, v95
    v_cvt_pk_bf16_f32 v46, v92, v93
    v_cvt_pk_bf16_f32 v47, v94, v95
    v_exp_f32 v64, v64
    v_exp_f32 v65, v65
    v_mfma_f32_32x32x16_bf16 v[96:111], v[36:39], v[44:47], v[96:111]
    v_exp_f32 v66, v66
    v_exp_f32 v67, v67
    v_cvt_pk_bf16_f32 v40, v64, v65
    v_exp_f32 v68, v68
    v_exp_f32 v69, v69
    v_cvt_pk_bf16_f32 v41, v66, v67
    v_exp_f32 v70, v70
    s_waitcnt lgkmcnt(0)
    v_mfma_f32_32x32x16_bf16 v[80:95], v[20:23], v[12:15], v[48:63]
    ds_read_b128 v[32:35], v113 offset:7168
    ds_read_b128 v[36:39], v113 offset:7680
    v_exp_f32 v71, v71
    v_cvt_pk_bf16_f32 v42, v68, v69
    v_exp_f32 v72, v72
    v_cvt_pk_bf16_f32 v43, v70, v71
    v_exp_f32 v73, v73
    v_exp_f32 v74, v74
    v_exp_f32 v75, v75
    v_cvt_pk_bf16_f32 v44, v72, v73
    v_mfma_f32_32x32x16_bf16 v[96:111], v[24:27], v[40:43], v[96:111]
    v_exp_f32 v76, v76
    v_exp_f32 v77, v77
    v_cvt_pk_bf16_f32 v45, v74, v75
    v_exp_f32 v78, v78
    v_exp_f32 v79, v79
    v_cvt_pk_bf16_f32 v46, v76, v77
    v_cvt_pk_bf16_f32 v47, v78, v79
    s_setprio 0
    v_exp_f32 v80, v80
    v_exp_f32 v81, v81
    v_mfma_f32_32x32x16_bf16 v[96:111], v[28:31], v[44:47], v[96:111]
    v_exp_f32 v82, v82
    v_exp_f32 v83, v83
    v_cvt_pk_bf16_f32 v40, v80, v81
    v_exp_f32 v84, v84
    v_exp_f32 v85, v85
    v_cvt_pk_bf16_f32 v41, v82, v83
    v_exp_f32 v86, v86
    s_waitcnt lgkmcnt(0)
    v_exp_f32 v87, v87
    v_cvt_pk_bf16_f32 v42, v84, v85
    v_exp_f32 v88, v88
    v_cvt_pk_bf16_f32 v43, v86, v87
    v_exp_f32 v89, v89
    v_exp_f32 v90, v90
    v_exp_f32 v91, v91
    v_cvt_pk_bf16_f32 v44, v88, v89
    v_mfma_f32_32x32x16_bf16 v[96:111], v[32:35], v[40:43], v[96:111]
    v_exp_f32 v92, v92
    v_exp_f32 v93, v93
    v_cvt_pk_bf16_f32 v45, v90, v91
    v_exp_f32 v94, v94
    v_exp_f32 v95, v95
    v_cvt_pk_bf16_f32 v46, v92, v93
    v_cvt_pk_bf16_f32 v47, v94, v95
    s_nop 1
    v_mfma_f32_32x32x16_bf16 v[96:111], v[36:39], v[44:47], v[96:111]
    v_bfe_u32 v16, v1, 4, 1
    v_and_b32 v17, 0x1ff, v113
    v_lshl_add_u32 v114, v16, 14, v17
    s_lshl_b32 s31, s10, 3
    s_add_u32 s31, s31, s3
    s_lshl_b32 s31, s31, 15
    s_lshl_b32 s32, s11, 9
    s_add_u32 s31, s31, s32
    s_add_u32 s31, s31, 0x600000
    s_mov_b32 s30, 0x5d800000
    s_nop 1
    v_cmp_nle_f32 vcc, v104, s30
    s_cbranch_vccnz L_att_fallback
L_att_done:
    v_rcp_f32 v16, v104
    s_nop 0
    v_mul_f32 v96, v96, v16
    v_mul_f32 v97, v97, v16
    v_mul_f32 v98, v98, v16
    v_mul_f32 v99, v99, v16
    v_mul_f32 v100, v100, v16
    v_mul_f32 v101, v101, v16
    v_mul_f32 v102, v102, v16
    v_mul_f32 v103, v103, v16
    v_cvt_pk_bf16_f32 v40, v96, v97
    v_cvt_pk_bf16_f32 v41, v98, v99
    v_cvt_pk_bf16_f32 v42, v100, v101
    v_cvt_pk_bf16_f32 v43, v102, v103
    buffer_store_dwordx4 v[40:43], v114, s[16:19], s31 offen sc1
    s_waitcnt vmcnt(25)
    s_barrier
    s_mov_b32 s62, s57
    s_add_u32 s32, s40, 0x800000
    s_add_u32 s42, s4, 0x600000
    s_add_u32 s43, s5, 0x600000
    s_add_u32 s44, s6, 0x600000
    s_add_u32 s45, s7, 0x600000
    s_mov_b32 s36, 0
    v_lshlrev_b32 v98, 16, v123
    v_and_b32 v99, 0xffff0000, v123
    v_lshlrev_b32 v92, 16, v120
    v_and_b32 v93, 0xffff0000, v120
    v_lshlrev_b32 v94, 16, v121
    v_and_b32 v95, 0xffff0000, v121
    v_lshlrev_b32 v96, 16, v122
    v_and_b32 v97, 0xffff0000, v122
    s_mov_b32 s52, 0x22222222
    s_mov_b32 s53, 0x22222222
    s_mov_b32 s54, 0x44444444
    s_mov_b32 s55, 0x44444444
    s_mov_b32 s56, 0x88888888
    s_mov_b32 s57, 0x88888888
    s_lshr_b32 s31, s25, 2
    s_add_u32 s30, s27, 1
    s_sub_u32 s33, 0, s30
    s_cmp_eq_u32 s31, 0
    s_cselect_b32 s30, s33, s30
    s_lshl_b32 s33, s24, 6
    s_add_u32 s30, s30, s33
    s_lshl_b32 s33, s26, 4
    s_add_u32 s30, s30, s33
    v_and_b32 v124, 15, v1
    v_add_u32 v124, s30, v124
    v_cmp_gt_u32 vcc, 0x800, v124
    v_lshrrev_b32 v6, 4, v124
    v_lshlrev_b32 v6, 14, v6
    v_and_b32 v124, 15, v124
    v_lshl_add_u32 v6, v124, 4, v6
    v_and_b32 v124, 48, v1
    v_lshl_add_u32 v6, v124, 4, v6
    s_lshl_b32 s30, s27, 13
    s_lshl_b32 s31, s31, 12
    s_add_u32 s30, s30, s31
    v_add_u32 v6, s30, v6
    v_mov_b32 v124, 0x7ff00000
    v_cndmask_b32 v6, v124, v6, vcc
    s_lshr_b32 s31, s25, 2
    s_xor_b32 s31, s31, 1
    s_add_u32 s30, s27, 1
    s_sub_u32 s33, 0, s30
    s_cmp_eq_u32 s31, 0
    s_cselect_b32 s30, s33, s30
    s_lshl_b32 s33, s24, 6
    s_add_u32 s30, s30, s33
    s_lshl_b32 s33, s26, 4
    s_add_u32 s30, s30, s33
    v_and_b32 v124, 15, v1
    v_add_u32 v124, s30, v124
    v_cmp_gt_u32 vcc, 0x800, v124
    v_lshrrev_b32 v7, 4, v124
    v_lshlrev_b32 v7, 14, v7
    v_and_b32 v124, 15, v124
    v_lshl_add_u32 v7, v124, 4, v7
    v_and_b32 v124, 48, v1
    v_lshl_add_u32 v7, v124, 4, v7
    s_lshl_b32 s30, s27, 13
    s_lshl_b32 s31, s31, 12
    s_add_u32 s30, s30, s31
    v_add_u32 v7, s30, v7
    v_mov_b32 v124, 0x7ff00000
    v_cndmask_b32 v7, v124, v7, vcc
    s_waitcnt vmcnt(24)
    v_dot2c_f32_bf16 v0, s37, v128
    v_dot2c_f32_bf16 v0, s37, v129
    v_dot2c_f32_bf16 v0, s37, v130
    v_dot2c_f32_bf16 v0, s37, v131
    s_waitcnt vmcnt(23)
    v_dot2c_f32_bf16 v0, s37, v132
    v_dot2c_f32_bf16 v0, s37, v133
    v_dot2c_f32_bf16 v0, s37, v134
    v_dot2c_f32_bf16 v0, s37, v135
    s_waitcnt vmcnt(22)
    v_dot2c_f32_bf16 v0, s37, v136
    v_dot2c_f32_bf16 v0, s37, v137
    v_dot2c_f32_bf16 v0, s37, v138
    v_dot2c_f32_bf16 v0, s37, v139
    s_waitcnt vmcnt(21)
    v_dot2c_f32_bf16 v0, s37, v140
    v_dot2c_f32_bf16 v0, s37, v141
    v_dot2c_f32_bf16 v0, s37, v142
    v_dot2c_f32_bf16 v0, s37, v143
    s_waitcnt vmcnt(20)
    v_dot2c_f32_bf16 v0, s37, v144
    v_dot2c_f32_bf16 v0, s37, v145
    v_dot2c_f32_bf16 v0, s37, v146
    v_dot2c_f32_bf16 v0, s37, v147
    s_waitcnt vmcnt(19)
    v_dot2c_f32_bf16 v0, s37, v148
    v_dot2c_f32_bf16 v0, s37, v149
    v_dot2c_f32_bf16 v0, s37, v150
    v_dot2c_f32_bf16 v0, s37, v151
    s_waitcnt vmcnt(18)
    v_dot2c_f32_bf16 v0, s37, v152
    v_dot2c_f32_bf16 v0, s37, v153
    v_dot2c_f32_bf16 v0, s37, v154
    v_dot2c_f32_bf16 v0, s37, v155
    s_waitcnt vmcnt(17)
    v_dot2c_f32_bf16 v0, s37, v156
    v_dot2c_f32_bf16 v0, s37, v157
    v_dot2c_f32_bf16 v0, s37, v158
    v_dot2c_f32_bf16 v0, s37, v159
    s_waitcnt vmcnt(16)
    v_dot2c_f32_bf16 v0, s37, v160
    v_dot2c_f32_bf16 v0, s37, v161
    v_dot2c_f32_bf16 v0, s37, v162
    v_dot2c_f32_bf16 v0, s37, v163
    s_waitcnt vmcnt(15)
    v_dot2c_f32_bf16 v0, s37, v164
    v_dot2c_f32_bf16 v0, s37, v165
    v_dot2c_f32_bf16 v0, s37, v166
    v_dot2c_f32_bf16 v0, s37, v167
    s_waitcnt vmcnt(0)
    s_mov_b32 s63, 0x600000
    buffer_load_dword v123, v3, s[16:19], s63 offen offset:508 sc1
    buffer_load_dwordx4 v[12:15], v4, s[16:19], s42 offen sc1
    buffer_load_dwordx4 v[16:19], v4, s[16:19], s43 offen sc1
    buffer_load_dwordx4 v[20:23], v4, s[16:19], s44 offen sc1
    buffer_load_dwordx4 v[24:27], v4, s[16:19], s45 offen sc1
    ds_read_b128 v[52:55], v9 offset:0
    ds_read_b128 v[56:59], v9 offset:1024
    ds_read_b128 v[44:47], v8 offset:0
    ds_read_b128 v[48:51], v8 offset:1024
    s_waitcnt vmcnt(4)
    v_cmp_eq_u32 vcc, -1, v123
    s_cbranch_vccz L_go3
L_spin3:
    buffer_load_dword v123, v3, s[16:19], s63 offen offset:508 sc1
    s_add_u32 s36, s36, 1
    s_waitcnt vmcnt(0)
    v_cmp_eq_u32 vcc, -1, v123
    s_cmp_gt_u32 s36, 20000
    s_cselect_b64 vcc, 0, vcc
    s_cbranch_vccnz L_spin3
    buffer_load_dwordx4 v[12:15], v4, s[16:19], s42 offen sc1
    buffer_load_dwordx4 v[16:19], v4, s[16:19], s43 offen sc1
    buffer_load_dwordx4 v[20:23], v4, s[16:19], s44 offen sc1
    buffer_load_dwordx4 v[24:27], v4, s[16:19], s45 offen sc1
L_go3:
    ds_read_b128 v[68:71], v9 offset:4096
    ds_read_b128 v[72:75], v9 offset:5120
L_chk13:
    s_waitcnt vmcnt(3)
    v_max3_u32 v124, v12, v13, v14
    v_max_u32 v124, v124, v15
    v_cmp_eq_u32 vcc, -1, v124
    s_cbranch_vccnz L_rty13
L_ok13:
    buffer_load_dwordx4 v[28:31], v5, s[16:19], s42 offen sc1
    s_waitcnt lgkmcnt(5)
    v_mfma_f32_16x16x32_bf16 v[84:87], v[52:55], v[12:15], 0
    ds_read_b128 v[60:63], v8 offset:4096
    s_waitcnt lgkmcnt(5)
    v_mfma_f32_16x16x32_bf16 v[88:91], v[56:59], v[12:15], 0
    ds_read_b128 v[64:67], v8 offset:5120
    s_waitcnt lgkmcnt(5)
    v_mfma_f32_16x16x32_bf16 v[76:79], v[44:47], v[12:15], 0
    s_waitcnt lgkmcnt(4)
    v_mfma_f32_16x16x32_bf16 v[80:83], v[48:51], v[12:15], 0
    ds_read_b128 v[52:55], v9 offset:8192
    ds_read_b128 v[56:59], v9 offset:9216
L_chk14:
    s_waitcnt vmcnt(3)
    v_max3_u32 v124, v16, v17, v18
    v_max_u32 v124, v124, v19
    v_cmp_eq_u32 vcc, -1, v124
    s_cbranch_vccnz L_rty14
L_ok14:
    buffer_load_dwordx4 v[32:35], v5, s[16:19], s43 offen sc1
    s_waitcnt lgkmcnt(5)
    v_mfma_f32_16x16x32_bf16 v[84:87], v[68:71], v[16:19], v[84:87]
    ds_read_b128 v[44:47], v8 offset:8192
    s_waitcnt lgkmcnt(5)
    v_mfma_f32_16x16x32_bf16 v[88:91], v[72:75], v[16:19], v[88:91]
    ds_read_b128 v[48:51], v8 offset:9216
    s_waitcnt lgkmcnt(5)
    v_mfma_f32_16x16x32_bf16 v[76:79], v[60:63], v[16:19], v[76:79]
    s_waitcnt lgkmcnt(4)
    v_mfma_f32_16x16x32_bf16 v[80:83], v[64:67], v[16:19], v[80:83]
    ds_read_b128 v[68:71], v9 offset:12288
    ds_read_b128 v[72:75], v9 offset:13312
L_chk15:
    s_waitcnt vmcnt(3)
    v_max3_u32 v124, v20, v21, v22
    v_max_u32 v124, v124, v23
    v_cmp_eq_u32 vcc, -1, v124
    s_cbranch_vccnz L_rty15
L_ok15:
    buffer_load_dwordx4 v[36:39], v5, s[16:19], s44 offen sc1
    s_waitcnt lgkmcnt(5)
    v_mfma_f32_16x16x32_bf16 v[84:87], v[52:55], v[20:23], v[84:87]
    ds_read_b128 v[60:63], v8 offset:12288
    s_waitcnt lgkmcnt(5)
    v_mfma_f32_16x16x32_bf16 v[88:91], v[56:59], v[20:23], v[88:91]
    ds_read_b128 v[64:67], v8 offset:13312
    s_waitcnt lgkmcnt(5)
    v_mfma_f32_16x16x32_bf16 v[76:79], v[44:47], v[20:23], v[76:79]
    s_waitcnt lgkmcnt(4)
    v_mfma_f32_16x16x32_bf16 v[80:83], v[48:51], v[20:23], v[80:83]
    ds_read_b128 v[52:55], v9 offset:16384
    ds_read_b128 v[56:59], v9 offset:17408
L_chk16:
    s_waitcnt vmcnt(3)
    v_max3_u32 v124, v24, v25, v26
    v_max_u32 v124, v124, v27
    v_cmp_eq_u32 vcc, -1, v124
    s_cbranch_vccnz L_rty16
L_ok16:
    buffer_load_dwordx4 v[40:43], v5, s[16:19], s45 offen sc1
    s_waitcnt lgkmcnt(5)
    v_mfma_f32_16x16x32_bf16 v[84:87], v[68:71], v[24:27], v[84:87]
    ds_read_b128 v[44:47], v8 offset:16384
    s_waitcnt lgkmcnt(5)
    v_mfma_f32_16x16x32_bf16 v[88:91], v[72:75], v[24:27], v[88:91]
    ds_read_b128 v[48:51], v8 offset:17408
    s_waitcnt lgkmcnt(5)
    v_mfma_f32_16x16x32_bf16 v[76:79], v[60:63], v[24:27], v[76:79]
    s_waitcnt lgkmcnt(4)
    v_mfma_f32_16x16x32_bf16 v[80:83], v[64:67], v[24:27], v[80:83]
    ds_read_b128 v[68:71], v9 offset:20480
    ds_read_b128 v[72:75], v9 offset:21504
L_chk17:
    s_waitcnt vmcnt(3)
    v_max3_u32 v124, v28, v29, v30
    v_max_u32 v124, v124, v31
    v_cmp_eq_u32 vcc, -1, v124
    s_cbranch_vccnz L_rty17
L_ok17:
    s_waitcnt lgkmcnt(5)
    v_mfma_f32_16x16x32_bf16 v[84:87], v[52:55], v[28:31], v[84:87]
    ds_read_b128 v[60:63], v8 offset:20480
    s_waitcnt lgkmcnt(5)
    v_mfma_f32_16x16x32_bf16 v[88:91], v[56:59], v[28:31], v[88:91]
    ds_read_b128 v[64:67], v8 offset:21504
    s_waitcnt lgkmcnt(5)
    v_mfma_f32_16x16x32_bf16 v[76:79], v[44:47], v[28:31], v[76:79]
    s_waitcnt lgkmcnt(4)
    v_mfma_f32_16x16x32_bf16 v[80:83], v[48:51], v[28:31], v[80:83]
    s_lshr_b32 s33, s39, 2
    s_xor_b32 s33, s33, 0x0
    s_xor_b32 m0, s38, s33
    s_add_u32 m0, m0, 0x8000
    s_add_u32 s33, s33, s59
    s_add_u32 s33, s33, 0x15a0000
    buffer_load_dwordx4 v2, s[16:19], s33 offen offset:0 sc1 lds
    buffer_load_dwordx4 v2, s[16:19], s33 offen offset:1024 sc1 lds
    ds_read_b128 v[52:55], v9 offset:24576
    ds_read_b128 v[56:59], v9 offset:25600
L_chk18:
    s_waitcnt vmcnt(4)
    v_max3_u32 v124, v32, v33, v34
    v_max_u32 v124, v124, v35
    v_cmp_eq_u32 vcc, -1, v124
    s_cbranch_vccnz L_rty18
L_ok18:
    s_waitcnt lgkmcnt(5)
    v_mfma_f32_16x16x32_bf16 v[84:87], v[68:71], v[32:35], v[84:87]
    ds_read_b128 v[44:47], v8 offset:24576
    s_waitcnt lgkmcnt(5)
    v_mfma_f32_16x16x32_bf16 v[88:91], v[72:75], v[32:35], v[88:91]
    ds_read_b128 v[48:51], v8 offset:25600
    s_waitcnt lgkmcnt(5)
    v_mfma_f32_16x16x32_bf16 v[76:79], v[60:63], v[32:35], v[76:79]
    s_waitcnt lgkmcnt(4)
    v_mfma_f32_16x16x32_bf16 v[80:83], v[64:67], v[32:35], v[80:83]
    s_lshr_b32 s33, s39, 2
    s_xor_b32 s33, s33, 0x800
    s_xor_b32 m0, s38, s33
    s_add_u32 m0, m0, 0x8000
    s_add_u32 s33, s33, s59
    s_add_u32 s33, s33, 0x15a0000
    buffer_load_dwordx4 v2, s[16:19], s33 offen offset:0 sc1 lds
    buffer_load_dwordx4 v2, s[16:19], s33 offen offset:1024 sc1 lds
    ds_read_b128 v[68:71], v9 offset:28672
    ds_read_b128 v[72:75], v9 offset:29696
L_chk19:
    s_waitcnt vmcnt(5)
    v_max3_u32 v124, v36, v37, v38
    v_max_u32 v124, v124, v39
    v_cmp_eq_u32 vcc, -1, v124
    s_cbranch_vccnz L_rty19
L_ok19:
    s_waitcnt lgkmcnt(5)
    v_mfma_f32_16x16x32_bf16 v[84:87], v[52:55], v[36:39], v[84:87]
    ds_read_b128 v[60:63], v8 offset:28672
    s_waitcnt lgkmcnt(5)
    v_mfma_f32_16x16x32_bf16 v[88:91], v[56:59], v[36:39], v[88:91]
    ds_read_b128 v[64:67], v8 offset:29696
    s_waitcnt lgkmcnt(5)
    v_mfma_f32_16x16x32_bf16 v[76:79], v[44:47], v[36:39], v[76:79]
    s_waitcnt lgkmcnt(4)
    v_mfma_f32_16x16x32_bf16 v[80:83], v[48:51], v[36:39], v[80:83]
    s_lshr_b32 s33, s39, 2
    s_xor_b32 s33, s33, 0x1000
    s_xor_b32 m0, s38, s33
    s_add_u32 m0, m0, 0x8000
    s_add_u32 s33, s33, s59
    s_add_u32 s33, s33, 0x15a0000
    buffer_load_dwordx4 v2, s[16:19], s33 offen offset:0 sc1 lds
    buffer_load_dwordx4 v2, s[16:19], s33 offen offset:1024 sc1 lds
L_chk20:
    s_waitcnt vmcnt(6)
    v_max3_u32 v124, v40, v41, v42
    v_max_u32 v124, v124, v43
    v_cmp_eq_u32 vcc, -1, v124
    s_cbranch_vccnz L_rty20
L_ok20:
    s_waitcnt lgkmcnt(3)
    v_mfma_f32_16x16x32_bf16 v[84:87], v[68:71], v[40:43], v[84:87]
    s_waitcnt lgkmcnt(2)
    v_mfma_f32_16x16x32_bf16 v[88:91], v[72:75], v[40:43], v[88:91]
    s_waitcnt lgkmcnt(1)
    v_mfma_f32_16x16x32_bf16 v[76:79], v[60:63], v[40:43], v[76:79]
    s_waitcnt lgkmcnt(0)
    v_mfma_f32_16x16x32_bf16 v[80:83], v[64:67], v[40:43], v[80:83]
    s_lshr_b32 s33, s39, 2
    s_xor_b32 s33, s33, 0x1800
    s_xor_b32 m0, s38, s33
    s_add_u32 m0, m0, 0x8000
    s_add_u32 s33, s33, s59
    s_add_u32 s33, s33, 0x15a0000
    buffer_load_dwordx4 v2, s[16:19], s33 offen offset:0 sc1 lds
    buffer_load_dwordx4 v2, s[16:19], s33 offen offset:1024 sc1 lds
    ds_write_b128 v10, v[84:87]
    ds_write_b128 v10, v[88:91] offset:1024
    s_waitcnt lgkmcnt(0)
    s_barrier
    ds_read_b128 v[12:15], v11
    ds_read_b128 v[16:19], v11 offset:1024
    v_add_f32 v92, v92, v76
    v_add_f32 v93, v93, v77
    v_add_f32 v94, v94, v78
    v_add_f32 v95, v95, v79
    v_add_f32 v96, v96, v80
    v_add_f32 v97, v97, v81
    v_add_f32 v98, v98, v82
    v_add_f32 v99, v99, v83
    s_waitcnt lgkmcnt(1)
    v_add_f32 v92, v92, v12
    v_add_f32 v93, v93, v13
    v_add_f32 v94, v94, v14
    v_add_f32 v95, v95, v15
    s_waitcnt lgkmcnt(0)
    v_add_f32 v96, v96, v16
    v_add_f32 v97, v97, v17
    v_add_f32 v98, v98, v18
    v_add_f32 v99, v99, v19
    v_cvt_pk_bf16_f32 v20, v92, v93
    v_cvt_pk_bf16_f32 v21, v94, v95
    v_cvt_pk_bf16_f32 v22, v96, v97
    v_cvt_pk_bf16_f32 v23, v98, v99
    s_cmp_eq_u32 s34, 0
    s_cbranch_scc1 L_sst21
    buffer_store_dwordx4 v[20:23], v2, s[16:19], s32 offen
L_ssd21:
    v_add_u32 v8, 32768, v8
    v_add_u32 v9, 32768, v9
    s_waitcnt vmcnt(1)
    s_barrier
    s_add_u32 s32, s40, 0xa00000
    s_add_u32 s42, s4, 0x800000
    s_add_u32 s43, s5, 0x800000
    s_add_u32 s44, s6, 0x800000
    s_add_u32 s45, s7, 0x800000
    s_mov_b32 s36, 0
    v_mov_b32 v108, s37
    v_mov_b32 v109, s37
    v_mov_b32 v110, s37
    v_mov_b32 v111, s37
    s_xor_b32 s30, s26, s27
    s_and_b32 s30, s30, 1
    s_lshl_b32 s30, s30, 16
    v_xor_b32 v120, s30, v8
    ds_read_b128 v[44:47], v120 offset:0
    ds_read_b128 v[48:51], v120 offset:1024
    ds_read_b128 v[52:55], v120 offset:4096
    ds_read_b128 v[56:59], v120 offset:5120
    ds_read_b128 v[60:63], v120 offset:8192
    ds_read_b128 v[64:67], v120 offset:9216
    ds_read_b128 v[68:71], v120 offset:12288
    ds_read_b128 v[72:75], v120 offset:13312
    s_mov_b32 s63, 0x800000
    buffer_load_dwordx4 v[12:15], v4, s[16:19], s42 offen sc1
    buffer_load_dwordx4 v[16:19], v4, s[16:19], s43 offen sc1
    buffer_load_dwordx4 v[20:23], v4, s[16:19], s44 offen sc1
    buffer_load_dwordx4 v[24:27], v4, s[16:19], s45 offen sc1
    s_waitcnt lgkmcnt(7)
    v_mfma_f32_16x16x32_bf16 v[100:103], v[44:47], v[108:111], 0
    s_waitcnt lgkmcnt(6)
    v_mfma_f32_16x16x32_bf16 v[104:107], v[48:51], v[108:111], 0
    ds_read_b128 v[44:47], v120 offset:16384
    ds_read_b128 v[48:51], v120 offset:17408
    s_waitcnt lgkmcnt(7)
    v_mfma_f32_16x16x32_bf16 v[100:103], v[52:55], v[108:111], v[100:103]
    s_waitcnt lgkmcnt(6)
    v_mfma_f32_16x16x32_bf16 v[104:107], v[56:59], v[108:111], v[104:107]
    ds_read_b128 v[52:55], v120 offset:20480
    ds_read_b128 v[56:59], v120 offset:21504
    s_waitcnt lgkmcnt(7)
    v_mfma_f32_16x16x32_bf16 v[100:103], v[60:63], v[108:111], v[100:103]
    s_waitcnt lgkmcnt(6)
    v_mfma_f32_16x16x32_bf16 v[104:107], v[64:67], v[108:111], v[104:107]
    ds_read_b128 v[60:63], v120 offset:24576
    ds_read_b128 v[64:67], v120 offset:25600
    s_waitcnt lgkmcnt(7)
    v_mfma_f32_16x16x32_bf16 v[100:103], v[68:71], v[108:111], v[100:103]
    s_waitcnt lgkmcnt(6)
    v_mfma_f32_16x16x32_bf16 v[104:107], v[72:75], v[108:111], v[104:107]
    ds_read_b128 v[68:71], v120 offset:28672
    ds_read_b128 v[72:75], v120 offset:29696
    s_waitcnt lgkmcnt(7)
    v_mfma_f32_16x16x32_bf16 v[100:103], v[44:47], v[108:111], v[100:103]
    s_waitcnt lgkmcnt(6)
    v_mfma_f32_16x16x32_bf16 v[104:107], v[48:51], v[108:111], v[104:107]
    s_waitcnt lgkmcnt(5)
    v_mfma_f32_16x16x32_bf16 v[100:103], v[52:55], v[108:111], v[100:103]
    s_waitcnt lgkmcnt(4)
    v_mfma_f32_16x16x32_bf16 v[104:107], v[56:59], v[108:111], v[104:107]
    s_waitcnt lgkmcnt(3)
    v_mfma_f32_16x16x32_bf16 v[100:103], v[60:63], v[108:111], v[100:103]
    s_waitcnt lgkmcnt(2)
    v_mfma_f32_16x16x32_bf16 v[104:107], v[64:67], v[108:111], v[104:107]
    s_waitcnt lgkmcnt(1)
    v_mfma_f32_16x16x32_bf16 v[100:103], v[68:71], v[108:111], v[100:103]
    s_waitcnt lgkmcnt(0)
    v_mfma_f32_16x16x32_bf16 v[104:107], v[72:75], v[108:111], v[104:107]
    s_lshl_b32 s30, s3, 9
    s_add_u32 s30, s30, 155648
    v_lshl_add_u32 v125, v1, 3, s30
    v_and_b32 v126, 15, v1
    v_lshrrev_b32 v127, 2, v126
    v_lshl_add_u32 v126, v127, 4, v126
    v_lshl_add_u32 v126, v126, 3, s30
    v_xor_b32 v127, 0x800, v126
    v_lshrrev_b32 v121, 4, v1
    s_lshl_b32 s30, s3, 7
    s_add_u32 s30, s30, 147456
    v_lshl_add_u32 v121, v121, 5, s30
    v_xor_b32 v122, 0x80, v121
    ds_write_b128 v121, v[100:103]
    ds_write_b128 v121, v[104:107] offset:16
    ds_read_b128 v[52:55], v9 offset:0
    ds_read_b128 v[56:59], v9 offset:1024
    ds_read_b128 v[44:47], v8 offset:0
    ds_read_b128 v[48:51], v8 offset:1024
    ds_read_b128 v[68:71], v9 offset:4096
    ds_read_b128 v[72:75], v9 offset:5120
L_chk22:
    s_waitcnt vmcnt(3)
    v_max3_u32 v124, v12, v13, v14
    v_max_u32 v124, v124, v15
    v_cmp_eq_u32 vcc, -1, v124
    s_cbranch_vccnz L_rty22
L_ok22:
    buffer_load_dwordx4 v[28:31], v5, s[16:19], s42 offen sc1
    v_mfma_f32_16x16x32_bf16 v[112:115], v[108:111], v[12:15], 0
    v_mfma_f32_16x16x32_bf16 v[116:119], v[12:15], v[12:15], 0
    s_waitcnt lgkmcnt(5)
    v_mfma_f32_16x16x32_bf16 v[84:87], v[52:55], v[12:15], 0
    ds_read_b128 v[60:63], v8 offset:4096
    s_waitcnt lgkmcnt(5)
    v_mfma_f32_16x16x32_bf16 v[88:91], v[56:59], v[12:15], 0
    ds_read_b128 v[64:67], v8 offset:5120
    s_waitcnt lgkmcnt(5)
    v_mfma_f32_16x16x32_bf16 v[76:79], v[44:47], v[12:15], 0
    s_waitcnt lgkmcnt(4)
    v_mfma_f32_16x16x32_bf16 v[80:83], v[48:51], v[12:15], 0
    ds_read_b128 v[52:55], v9 offset:8192
    ds_read_b128 v[56:59], v9 offset:9216
L_chk23:
    s_waitcnt vmcnt(3)
    v_max3_u32 v124, v16, v17, v18
    v_max_u32 v124, v124, v19
    v_cmp_eq_u32 vcc, -1, v124
    s_cbranch_vccnz L_rty23
L_ok23:
    buffer_load_dwordx4 v[32:35], v5, s[16:19], s43 offen sc1
    v_mfma_f32_16x16x32_bf16 v[112:115], v[108:111], v[16:19], v[112:115]
    v_mfma_f32_16x16x32_bf16 v[116:119], v[16:19], v[16:19], v[116:119]
    s_waitcnt lgkmcnt(5)
    v_mfma_f32_16x16x32_bf16 v[84:87], v[68:71], v[16:19], v[84:87]
    ds_read_b128 v[44:47], v8 offset:8192
    s_waitcnt lgkmcnt(5)
    v_mfma_f32_16x16x32_bf16 v[88:91], v[72:75], v[16:19], v[88:91]
    ds_read_b128 v[48:51], v8 offset:9216
    s_waitcnt lgkmcnt(5)
    v_mfma_f32_16x16x32_bf16 v[76:79], v[60:63], v[16:19], v[76:79]
    s_waitcnt lgkmcnt(4)
    v_mfma_f32_16x16x32_bf16 v[80:83], v[64:67], v[16:19], v[80:83]
    ds_read_b128 v[68:71], v9 offset:12288
    ds_read_b128 v[72:75], v9 offset:13312
L_chk24:
    s_waitcnt vmcnt(3)
    v_max3_u32 v124, v20, v21, v22
    v_max_u32 v124, v124, v23
    v_cmp_eq_u32 vcc, -1, v124
    s_cbranch_vccnz L_rty24
L_ok24:
    buffer_load_dwordx4 v[36:39], v5, s[16:19], s44 offen sc1
    v_mfma_f32_16x16x32_bf16 v[112:115], v[108:111], v[20:23], v[112:115]
    v_mfma_f32_16x16x32_bf16 v[116:119], v[20:23], v[20:23], v[116:119]
    s_waitcnt lgkmcnt(5)
    v_mfma_f32_16x16x32_bf16 v[84:87], v[52:55], v[20:23], v[84:87]
    ds_read_b128 v[60:63], v8 offset:12288
    s_waitcnt lgkmcnt(5)
    v_mfma_f32_16x16x32_bf16 v[88:91], v[56:59], v[20:23], v[88:91]
    ds_read_b128 v[64:67], v8 offset:13312
    s_waitcnt lgkmcnt(5)
    v_mfma_f32_16x16x32_bf16 v[76:79], v[44:47], v[20:23], v[76:79]
    s_waitcnt lgkmcnt(4)
    v_mfma_f32_16x16x32_bf16 v[80:83], v[48:51], v[20:23], v[80:83]
    ds_read_b128 v[52:55], v9 offset:16384
    ds_read_b128 v[56:59], v9 offset:17408
L_chk25:
    s_waitcnt vmcnt(3)
    v_max3_u32 v124, v24, v25, v26
    v_max_u32 v124, v124, v27
    v_cmp_eq_u32 vcc, -1, v124
    s_cbranch_vccnz L_rty25
L_ok25:
    buffer_load_dwordx4 v[40:43], v5, s[16:19], s45 offen sc1
    v_mfma_f32_16x16x32_bf16 v[112:115], v[108:111], v[24:27], v[112:115]
    v_mfma_f32_16x16x32_bf16 v[116:119], v[24:27], v[24:27], v[116:119]
    s_waitcnt lgkmcnt(5)
    v_mfma_f32_16x16x32_bf16 v[84:87], v[68:71], v[24:27], v[84:87]
    ds_read_b128 v[44:47], v8 offset:16384
    s_waitcnt lgkmcnt(5)
    v_mfma_f32_16x16x32_bf16 v[88:91], v[72:75], v[24:27], v[88:91]
    ds_read_b128 v[48:51], v8 offset:17408
    s_waitcnt lgkmcnt(5)
    v_mfma_f32_16x16x32_bf16 v[76:79], v[60:63], v[24:27], v[76:79]
    s_waitcnt lgkmcnt(4)
    v_mfma_f32_16x16x32_bf16 v[80:83], v[64:67], v[24:27], v[80:83]
    ds_read_b128 v[68:71], v9 offset:20480
    ds_read_b128 v[72:75], v9 offset:21504
L_chk26:
    s_waitcnt vmcnt(3)
    v_max3_u32 v124, v28, v29, v30
    v_max_u32 v124, v124, v31
    v_cmp_eq_u32 vcc, -1, v124
    s_cbranch_vccnz L_rty26
L_ok26:
    v_mfma_f32_16x16x32_bf16 v[112:115], v[108:111], v[28:31], v[112:115]
    v_mfma_f32_16x16x32_bf16 v[116:119], v[28:31], v[28:31], v[116:119]
    s_waitcnt lgkmcnt(5)
    v_mfma_f32_16x16x32_bf16 v[84:87], v[52:55], v[28:31], v[84:87]
    ds_read_b128 v[60:63], v8 offset:20480
    s_waitcnt lgkmcnt(5)
    v_mfma_f32_16x16x32_bf16 v[88:91], v[56:59], v[28:31], v[88:91]
    ds_read_b128 v[64:67], v8 offset:21504
    s_waitcnt lgkmcnt(5)
    v_mfma_f32_16x16x32_bf16 v[76:79], v[44:47], v[28:31], v[76:79]
    s_waitcnt lgkmcnt(4)
    v_mfma_f32_16x16x32_bf16 v[80:83], v[48:51], v[28:31], v[80:83]
    s_lshr_b32 s33, s39, 2
    s_xor_b32 s33, s33, 0x0
    s_xor_b32 m0, s38, s33
    s_add_u32 s33, s33, s59
    s_add_u32 s33, s33, 0x1640000
    buffer_load_dwordx4 v2, s[16:19], s33 offen offset:0 sc1 lds
    buffer_load_dwordx4 v2, s[16:19], s33 offen offset:1024 sc1 lds
    ds_read_b128 v[52:55], v9 offset:24576
    ds_read_b128 v[56:59], v9 offset:25600
L_chk27:
    s_waitcnt vmcnt(4)
    v_max3_u32 v124, v32, v33, v34
    v_max_u32 v124, v124, v35
    v_cmp_eq_u32 vcc, -1, v124
    s_cbranch_vccnz L_rty27
L_ok27:
    v_mfma_f32_16x16x32_bf16 v[112:115], v[108:111], v[32:35], v[112:115]
    v_mfma_f32_16x16x32_bf16 v[116:119], v[32:35], v[32:35], v[116:119]
    s_waitcnt lgkmcnt(5)
    v_mfma_f32_16x16x32_bf16 v[84:87], v[68:71], v[32:35], v[84:87]
    ds_read_b128 v[44:47], v8 offset:24576
    s_waitcnt lgkmcnt(5)
    v_mfma_f32_16x16x32_bf16 v[88:91], v[72:75], v[32:35], v[88:91]
    ds_read_b128 v[48:51], v8 offset:25600
    s_waitcnt lgkmcnt(5)
    v_mfma_f32_16x16x32_bf16 v[76:79], v[60:63], v[32:35], v[76:79]
    s_waitcnt lgkmcnt(4)
    v_mfma_f32_16x16x32_bf16 v[80:83], v[64:67], v[32:35], v[80:83]
    s_lshr_b32 s33, s39, 2
    s_xor_b32 s33, s33, 0x800
    s_xor_b32 m0, s38, s33
    s_add_u32 s33, s33, s59
    s_add_u32 s33, s33, 0x1640000
    buffer_load_dwordx4 v2, s[16:19], s33 offen offset:0 sc1 lds
    buffer_load_dwordx4 v2, s[16:19], s33 offen offset:1024 sc1 lds
    ds_read_b128 v[68:71], v9 offset:28672
    ds_read_b128 v[72:75], v9 offset:29696
L_chk28:
    s_waitcnt vmcnt(5)
    v_max3_u32 v124, v36, v37, v38
    v_max_u32 v124, v124, v39
    v_cmp_eq_u32 vcc, -1, v124
    s_cbranch_vccnz L_rty28
L_ok28:
    v_mfma_f32_16x16x32_bf16 v[112:115], v[108:111], v[36:39], v[112:115]
    v_mfma_f32_16x16x32_bf16 v[116:119], v[36:39], v[36:39], v[116:119]
    s_waitcnt lgkmcnt(5)
    v_mfma_f32_16x16x32_bf16 v[84:87], v[52:55], v[36:39], v[84:87]
    ds_read_b128 v[60:63], v8 offset:28672
    s_waitcnt lgkmcnt(5)
    v_mfma_f32_16x16x32_bf16 v[88:91], v[56:59], v[36:39], v[88:91]
    ds_read_b128 v[64:67], v8 offset:29696
    s_waitcnt lgkmcnt(5)
    v_mfma_f32_16x16x32_bf16 v[76:79], v[44:47], v[36:39], v[76:79]
    s_waitcnt lgkmcnt(4)
    v_mfma_f32_16x16x32_bf16 v[80:83], v[48:51], v[36:39], v[80:83]
    s_lshr_b32 s33, s39, 2
    s_xor_b32 s33, s33, 0x1000
    s_xor_b32 m0, s38, s33
    s_add_u32 s33, s33, s59
    s_add_u32 s33, s33, 0x1640000
    buffer_load_dwordx4 v2, s[16:19], s33 offen offset:0 sc1 lds
    buffer_load_dwordx4 v2, s[16:19], s33 offen offset:1024 sc1 lds
L_chk29:
    s_waitcnt vmcnt(6)
    v_max3_u32 v124, v40, v41, v42
    v_max_u32 v124, v124, v43
    v_cmp_eq_u32 vcc, -1, v124
    s_cbranch_vccnz L_rty29
L_ok29:
    v_mfma_f32_16x16x32_bf16 v[112:115], v[108:111], v[40:43], v[112:115]
    v_mfma_f32_16x16x32_bf16 v[116:119], v[40:43], v[40:43], v[116:119]
    s_waitcnt lgkmcnt(3)
    v_mfma_f32_16x16x32_bf16 v[84:87], v[68:71], v[40:43], v[84:87]
    s_waitcnt lgkmcnt(2)
    v_mfma_f32_16x16x32_bf16 v[88:91], v[72:75], v[40:43], v[88:91]
    s_waitcnt lgkmcnt(1)
    v_mfma_f32_16x16x32_bf16 v[76:79], v[60:63], v[40:43], v[76:79]
    s_waitcnt lgkmcnt(0)
    v_mfma_f32_16x16x32_bf16 v[80:83], v[64:67], v[40:43], v[80:83]
    s_lshr_b32 s33, s39, 2
    s_xor_b32 s33, s33, 0x1800
    s_xor_b32 m0, s38, s33
    s_add_u32 s33, s33, s59
    s_add_u32 s33, s33, 0x1640000
    buffer_load_dwordx4 v2, s[16:19], s33 offen offset:0 sc1 lds
    buffer_load_dwordx4 v2, s[16:19], s33 offen offset:1024 sc1 lds
    v_cndmask_b32 v113, v116, v117, s[52:53]
    v_cndmask_b32 v113, v113, v118, s[54:55]
    v_cndmask_b32 v113, v113, v119, s[56:57]
    ds_write_b64 v125, v[112:113]
    ds_write_b128 v10, v[84:87]
    ds_write_b128 v10, v[88:91] offset:1024
    s_waitcnt lgkmcnt(0)
    s_barrier
    ds_read_b64 v[108:109], v126
    ds_read_b64 v[110:111], v127
    ds_read_b128 v[44:47], v122
    ds_read_b128 v[48:51], v122 offset:16
    ds_read_b128 v[12:15], v11
    ds_read_b128 v[16:19], v11 offset:1024
    s_waitcnt lgkmcnt(4)
    v_add_f32 v108, v108, v110
    v_add_f32 v109, v109, v111
    v_mul_f32 v108, 0x3b000000, v108
    v_mul_f32 v109, 0x3b000000, v109
    v_fma_f32 v109, -v108, v108, v109
    v_max_f32 v109, 0, v109
    v_add_f32 v110, 0x3727c5ac, v109
    v_rsq_f32 v110, v110
    v_fma_f32 v76, -v108, v100, v76
    v_fma_f32 v77, -v108, v101, v77
    v_fma_f32 v78, -v108, v102, v78
    v_fma_f32 v79, -v108, v103, v79
    v_fma_f32 v80, -v108, v104, v80
    v_fma_f32 v81, -v108, v105, v81
    v_fma_f32 v82, -v108, v106, v82
    v_fma_f32 v83, -v108, v107, v83
    v_mul_f32 v111, v110, v110
    v_fmaak_f32 v111, v111, v109, 0x3727c5ac
    v_rsq_f32 v111, v111
    s_waitcnt lgkmcnt(3)
    v_fma_f32 v76, -v108, v44, v76
    v_fma_f32 v77, -v108, v45, v77
    v_fma_f32 v78, -v108, v46, v78
    v_fma_f32 v79, -v108, v47, v79
    s_waitcnt lgkmcnt(2)
    v_fma_f32 v80, -v108, v48, v80
    v_fma_f32 v81, -v108, v49, v81
    v_fma_f32 v82, -v108, v50, v82
    v_fma_f32 v83, -v108, v51, v83
    v_mul_f32 v111, v111, v110
    s_waitcnt lgkmcnt(1)
    v_add_f32 v76, v76, v12
    v_mul_f32 v112, v111, v111
    v_add_f32 v77, v77, v13
    v_mul_f32 v113, 0xc0135761, v111
    v_add_f32 v78, v78, v14
    v_rcp_f32 v111, v111
    v_add_f32 v79, v79, v15
    v_mul_f32 v112, v112, v113
    s_waitcnt lgkmcnt(0)
    v_add_f32 v80, v80, v16
    v_mul_f32 v112, 0x3d372713, v112
    v_add_f32 v81, v81, v17
    v_add_f32 v82, v82, v18
    v_add_f32 v83, v83, v19
    v_mul_f32 v84, v76, v76
    v_mul_f32 v85, v77, v77
    v_mul_f32 v86, v78, v78
    v_mul_f32 v87, v79, v79
    v_mul_f32 v88, v80, v80
    v_mul_f32 v89, v81, v81
    v_mul_f32 v90, v82, v82
    v_mul_f32 v91, v83, v83
    v_fma_f32 v84, v84, v112, v113
    v_fma_f32 v85, v85, v112, v113
    v_fma_f32 v86, v86, v112, v113
    v_fma_f32 v87, v87, v112, v113
    v_fma_f32 v88, v88, v112, v113
    v_fma_f32 v89, v89, v112, v113
    v_fma_f32 v90, v90, v112, v113
    v_fma_f32 v91, v91, v112, v113
    v_mul_f32 v84, v84, v76
    v_mul_f32 v85, v85, v77
    v_mul_f32 v86, v86, v78
    v_mul_f32 v87, v87, v79
    v_mul_f32 v88, v88, v80
    v_mul_f32 v89, v89, v81
    v_mul_f32 v90, v90, v82
    v_mul_f32 v91, v91, v83
    v_exp_f32 v84, v84
    v_exp_f32 v85, v85
    v_exp_f32 v86, v86
    v_exp_f32 v87, v87
    v_exp_f32 v88, v88
    v_exp_f32 v89, v89
    v_exp_f32 v90, v90
    v_exp_f32 v91, v91
    v_fma_f32 v84, v84, v111, v111
    v_fma_f32 v85, v85, v111, v111
    v_fma_f32 v86, v86, v111, v111
    v_fma_f32 v87, v87, v111, v111
    v_fma_f32 v88, v88, v111, v111
    v_fma_f32 v89, v89, v111, v111
    v_fma_f32 v90, v90, v111, v111
    v_fma_f32 v91, v91, v111, v111
    v_rcp_f32 v84, v84
    v_rcp_f32 v85, v85
    v_rcp_f32 v86, v86
    v_rcp_f32 v87, v87
    v_rcp_f32 v88, v88
    v_rcp_f32 v89, v89
    v_rcp_f32 v90, v90
    v_rcp_f32 v91, v91
    v_mul_f32 v76, v76, v84
    v_mul_f32 v77, v77, v85
    v_mul_f32 v78, v78, v86
    v_mul_f32 v79, v79, v87
    v_mul_f32 v80, v80, v88
    v_mul_f32 v81, v81, v89
    v_mul_f32 v82, v82, v90
    v_mul_f32 v83, v83, v91
    v_cvt_pk_bf16_f32 v20, v76, v77
    v_cvt_pk_bf16_f32 v21, v78, v79
    v_cvt_pk_bf16_f32 v22, v80, v81
    v_cvt_pk_bf16_f32 v23, v82, v83
    s_cmp_eq_u32 s35, 0
    s_cbranch_scc1 L_sst30
    buffer_store_dwordx4 v[20:23], v2, s[16:19], s32 offen
L_ssd30:
    v_subrev_u32 v8, 32768, v8
    v_subrev_u32 v9, 32768, v9
    s_waitcnt vmcnt(1)
    s_barrier
    s_add_u32 s32, s40, 0xc00000
    s_add_u32 s42, s4, 0xa00000
    s_add_u32 s43, s5, 0xa00000
    s_add_u32 s44, s6, 0xa00000
    s_add_u32 s45, s7, 0xa00000
    s_mov_b32 s36, 0
    v_sub_f32 v100, v92, v108
    v_mul_f32 v100, v100, v110
    v_sub_f32 v101, v93, v108
    v_mul_f32 v101, v101, v110
    v_sub_f32 v102, v94, v108
    v_mul_f32 v102, v102, v110
    v_sub_f32 v103, v95, v108
    v_mul_f32 v103, v103, v110
    v_sub_f32 v104, v96, v108
    v_mul_f32 v104, v104, v110
    v_sub_f32 v105, v97, v108
    v_mul_f32 v105, v105, v110
    v_sub_f32 v106, v98, v108
    v_mul_f32 v106, v106, v110
    v_sub_f32 v107, v99, v108
    v_mul_f32 v107, v107, v110
    v_dot2c_f32_bf16 v0, s37, v168
    v_dot2c_f32_bf16 v0, s37, v169
    v_dot2c_f32_bf16 v0, s37, v170
    v_dot2c_f32_bf16 v0, s37, v171
    v_dot2c_f32_bf16 v0, s37, v172
    v_dot2c_f32_bf16 v0, s37, v173
    v_dot2c_f32_bf16 v0, s37, v174
    v_dot2c_f32_bf16 v0, s37, v175
    v_dot2c_f32_bf16 v0, s37, v176
    v_dot2c_f32_bf16 v0, s37, v177
    v_dot2c_f32_bf16 v0, s37, v178
    v_dot2c_f32_bf16 v0, s37, v179
    v_dot2c_f32_bf16 v0, s37, v180
    v_dot2c_f32_bf16 v0, s37, v181
    v_dot2c_f32_bf16 v0, s37, v182
    v_dot2c_f32_bf16 v0, s37, v183
    v_dot2c_f32_bf16 v0, s37, v184
    v_dot2c_f32_bf16 v0, s37, v185
    v_dot2c_f32_bf16 v0, s37, v186
    v_dot2c_f32_bf16 v0, s37, v187
    v_dot2c_f32_bf16 v0, s37, v188
    v_dot2c_f32_bf16 v0, s37, v189
    v_dot2c_f32_bf16 v0, s37, v190
    v_dot2c_f32_bf16 v0, s37, v191
    v_dot2c_f32_bf16 v0, s37, v192
    v_dot2c_f32_bf16 v0, s37, v193
    v_dot2c_f32_bf16 v0, s37, v194
    v_dot2c_f32_bf16 v0, s37, v195
    v_dot2c_f32_bf16 v0, s37, v196
    v_dot2c_f32_bf16 v0, s37, v197
    v_dot2c_f32_bf16 v0, s37, v198
    v_dot2c_f32_bf16 v0, s37, v199
    v_dot2c_f32_bf16 v0, s37, v200
    v_dot2c_f32_bf16 v0, s37, v201
    v_dot2c_f32_bf16 v0, s37, v202
    v_dot2c_f32_bf16 v0, s37, v203
    v_dot2c_f32_bf16 v0, s37, v204
    v_dot2c_f32_bf16 v0, s37, v205
    v_dot2c_f32_bf16 v0, s37, v206
    v_dot2c_f32_bf16 v0, s37, v207
    s_mov_b32 s63, 0xa00000
    buffer_load_dwordx4 v[12:15], v6, s[16:19], s42 offen sc1
    buffer_load_dwordx4 v[16:19], v6, s[16:19], s43 offen sc1
    buffer_load_dwordx4 v[20:23], v6, s[16:19], s44 offen sc1
    buffer_load_dwordx4 v[24:27], v6, s[16:19], s45 offen sc1
    ds_read_b128 v[52:55], v9 offset:0
    ds_read_b128 v[56:59], v9 offset:1024
    ds_read_b128 v[44:47], v8 offset:0
    ds_read_b128 v[48:51], v8 offset:1024
    ds_read_b128 v[68:71], v9 offset:4096
    ds_read_b128 v[72:75], v9 offset:5120
L_chk31:
    s_waitcnt vmcnt(3)
    v_max3_u32 v124, v12, v13, v14
    v_max_u32 v124, v124, v15
    v_cmp_eq_u32 vcc, -1, v124
    s_cbranch_vccnz L_rty31
L_ok31:
    buffer_load_dwordx4 v[28:31], v7, s[16:19], s42 offen sc1
    s_waitcnt lgkmcnt(5)
    v_mfma_f32_16x16x32_bf16 v[84:87], v[52:55], v[12:15], 0
    ds_read_b128 v[60:63], v8 offset:4096
    s_waitcnt lgkmcnt(5)
    v_mfma_f32_16x16x32_bf16 v[88:91], v[56:59], v[12:15], 0
    ds_read_b128 v[64:67], v8 offset:5120
    s_waitcnt lgkmcnt(5)
    v_mfma_f32_16x16x32_bf16 v[76:79], v[44:47], v[12:15], 0
    s_waitcnt lgkmcnt(4)
    v_mfma_f32_16x16x32_bf16 v[80:83], v[48:51], v[12:15], 0
    ds_read_b128 v[52:55], v9 offset:8192
    ds_read_b128 v[56:59], v9 offset:9216
L_chk32:
    s_waitcnt vmcnt(3)
    v_max3_u32 v124, v16, v17, v18
    v_max_u32 v124, v124, v19
    v_cmp_eq_u32 vcc, -1, v124
    s_cbranch_vccnz L_rty32
L_ok32:
    buffer_load_dwordx4 v[32:35], v7, s[16:19], s43 offen sc1
    s_waitcnt lgkmcnt(5)
    v_mfma_f32_16x16x32_bf16 v[84:87], v[68:71], v[16:19], v[84:87]
    ds_read_b128 v[44:47], v8 offset:8192
    s_waitcnt lgkmcnt(5)
    v_mfma_f32_16x16x32_bf16 v[88:91], v[72:75], v[16:19], v[88:91]
    ds_read_b128 v[48:51], v8 offset:9216
    s_waitcnt lgkmcnt(5)
    v_mfma_f32_16x16x32_bf16 v[76:79], v[60:63], v[16:19], v[76:79]
    s_waitcnt lgkmcnt(4)
    v_mfma_f32_16x16x32_bf16 v[80:83], v[64:67], v[16:19], v[80:83]
    ds_read_b128 v[68:71], v9 offset:12288
    ds_read_b128 v[72:75], v9 offset:13312
L_chk33:
    s_waitcnt vmcnt(3)
    v_max3_u32 v124, v20, v21, v22
    v_max_u32 v124, v124, v23
    v_cmp_eq_u32 vcc, -1, v124
    s_cbranch_vccnz L_rty33
L_ok33:
    buffer_load_dwordx4 v[36:39], v7, s[16:19], s44 offen sc1
    s_waitcnt lgkmcnt(5)
    v_mfma_f32_16x16x32_bf16 v[84:87], v[52:55], v[20:23], v[84:87]
    ds_read_b128 v[60:63], v8 offset:12288
    s_waitcnt lgkmcnt(5)
    v_mfma_f32_16x16x32_bf16 v[88:91], v[56:59], v[20:23], v[88:91]
    ds_read_b128 v[64:67], v8 offset:13312
    s_waitcnt lgkmcnt(5)
    v_mfma_f32_16x16x32_bf16 v[76:79], v[44:47], v[20:23], v[76:79]
    s_waitcnt lgkmcnt(4)
    v_mfma_f32_16x16x32_bf16 v[80:83], v[48:51], v[20:23], v[80:83]
    ds_read_b128 v[52:55], v9 offset:16384
    ds_read_b128 v[56:59], v9 offset:17408
L_chk34:
    s_waitcnt vmcnt(3)
    v_max3_u32 v124, v24, v25, v26
    v_max_u32 v124, v124, v27
    v_cmp_eq_u32 vcc, -1, v124
    s_cbranch_vccnz L_rty34
L_ok34:
    buffer_load_dwordx4 v[40:43], v7, s[16:19], s45 offen sc1
    s_waitcnt lgkmcnt(5)
    v_mfma_f32_16x16x32_bf16 v[84:87], v[68:71], v[24:27], v[84:87]
    ds_read_b128 v[44:47], v8 offset:16384
    s_waitcnt lgkmcnt(5)
    v_mfma_f32_16x16x32_bf16 v[88:91], v[72:75], v[24:27], v[88:91]
    ds_read_b128 v[48:51], v8 offset:17408
    s_waitcnt lgkmcnt(5)
    v_mfma_f32_16x16x32_bf16 v[76:79], v[60:63], v[24:27], v[76:79]
    s_waitcnt lgkmcnt(4)
    v_mfma_f32_16x16x32_bf16 v[80:83], v[64:67], v[24:27], v[80:83]
    ds_read_b128 v[68:71], v9 offset:20480
    ds_read_b128 v[72:75], v9 offset:21504
L_chk35:
    s_waitcnt vmcnt(3)
    v_max3_u32 v124, v28, v29, v30
    v_max_u32 v124, v124, v31
    v_cmp_eq_u32 vcc, -1, v124
    s_cbranch_vccnz L_rty35
L_ok35:
    s_waitcnt lgkmcnt(5)
    v_mfma_f32_16x16x32_bf16 v[84:87], v[52:55], v[28:31], v[84:87]
    ds_read_b128 v[60:63], v8 offset:20480
    s_waitcnt lgkmcnt(5)
    v_mfma_f32_16x16x32_bf16 v[88:91], v[56:59], v[28:31], v[88:91]
    ds_read_b128 v[64:67], v8 offset:21504
    s_waitcnt lgkmcnt(5)
    v_mfma_f32_16x16x32_bf16 v[76:79], v[44:47], v[28:31], v[76:79]
    s_waitcnt lgkmcnt(4)
    v_mfma_f32_16x16x32_bf16 v[80:83], v[48:51], v[28:31], v[80:83]
    s_xor_b32 s33, s39, 24576
    s_add_u32 s33, s33, s47
    buffer_load_dwordx4 v[224:227], v2, s[16:19], s33 offen offset:0 sc1
    s_xor_b32 s33, s39, 24576
    s_add_u32 s33, s33, s47
    buffer_load_dwordx4 v[228:231], v2, s[16:19], s33 offen offset:1024 sc1
    ds_read_b128 v[52:55], v9 offset:24576
    ds_read_b128 v[56:59], v9 offset:25600
L_chk36:
    s_waitcnt vmcnt(4)
    v_max3_u32 v124, v32, v33, v34
    v_max_u32 v124, v124, v35
    v_cmp_eq_u32 vcc, -1, v124
    s_cbranch_vccnz L_rty36
L_ok36:
    s_waitcnt lgkmcnt(5)
    v_mfma_f32_16x16x32_bf16 v[84:87], v[68:71], v[32:35], v[84:87]
    ds_read_b128 v[44:47], v8 offset:24576
    s_waitcnt lgkmcnt(5)
    v_mfma_f32_16x16x32_bf16 v[88:91], v[72:75], v[32:35], v[88:91]
    ds_read_b128 v[48:51], v8 offset:25600
    s_waitcnt lgkmcnt(5)
    v_mfma_f32_16x16x32_bf16 v[76:79], v[60:63], v[32:35], v[76:79]
    s_waitcnt lgkmcnt(4)
    v_mfma_f32_16x16x32_bf16 v[80:83], v[64:67], v[32:35], v[80:83]
    s_xor_b32 s33, s39, 24576
    s_add_u32 s33, s33, s47
    buffer_load_dwordx4 v[232:235], v2, s[16:19], s33 offen offset:2048 sc1
    s_xor_b32 s33, s39, 24576
    s_add_u32 s33, s33, s47
    buffer_load_dwordx4 v[236:239], v2, s[16:19], s33 offen offset:3072 sc1
    ds_read_b128 v[68:71], v9 offset:28672
    ds_read_b128 v[72:75], v9 offset:29696
L_chk37:
    s_waitcnt vmcnt(5)
    v_max3_u32 v124, v36, v37, v38
    v_max_u32 v124, v124, v39
    v_cmp_eq_u32 vcc, -1, v124
    s_cbranch_vccnz L_rty37
L_ok37:
    s_waitcnt lgkmcnt(5)
    v_mfma_f32_16x16x32_bf16 v[84:87], v[52:55], v[36:39], v[84:87]
    ds_read_b128 v[60:63], v8 offset:28672
    s_waitcnt lgkmcnt(5)
    v_mfma_f32_16x16x32_bf16 v[88:91], v[56:59], v[36:39], v[88:91]
    ds_read_b128 v[64:67], v8 offset:29696
    s_waitcnt lgkmcnt(5)
    v_mfma_f32_16x16x32_bf16 v[76:79], v[44:47], v[36:39], v[76:79]
    s_waitcnt lgkmcnt(4)
    v_mfma_f32_16x16x32_bf16 v[80:83], v[48:51], v[36:39], v[80:83]
    s_xor_b32 s33, s39, 28672
    s_add_u32 s33, s33, s47
    buffer_load_dwordx4 v[240:243], v2, s[16:19], s33 offen offset:0 sc1
    s_xor_b32 s33, s39, 28672
    s_add_u32 s33, s33, s47
    buffer_load_dwordx4 v[244:247], v2, s[16:19], s33 offen offset:1024 sc1
L_chk38:
    s_waitcnt vmcnt(6)
    v_max3_u32 v124, v40, v41, v42
    v_max_u32 v124, v124, v43
    v_cmp_eq_u32 vcc, -1, v124
    s_cbranch_vccnz L_rty38
L_ok38:
    s_waitcnt lgkmcnt(3)
    v_mfma_f32_16x16x32_bf16 v[84:87], v[68:71], v[40:43], v[84:87]
    s_waitcnt lgkmcnt(2)
    v_mfma_f32_16x16x32_bf16 v[88:91], v[72:75], v[40:43], v[88:91]
    s_waitcnt lgkmcnt(1)
    v_mfma_f32_16x16x32_bf16 v[76:79], v[60:63], v[40:43], v[76:79]
    s_waitcnt lgkmcnt(0)
    v_mfma_f32_16x16x32_bf16 v[80:83], v[64:67], v[40:43], v[80:83]
    s_xor_b32 s33, s39, 28672
    s_add_u32 s33, s33, s47
    buffer_load_dwordx4 v[248:251], v2, s[16:19], s33 offen offset:2048 sc1
    s_xor_b32 s33, s39, 28672
    s_add_u32 s33, s33, s47
    buffer_load_dwordx4 v[252:255], v2, s[16:19], s33 offen offset:3072 sc1
    ds_write_b128 v10, v[84:87]
    ds_write_b128 v10, v[88:91] offset:1024
    s_waitcnt lgkmcnt(0)
    s_barrier
    ds_read_b128 v[12:15], v11
    ds_read_b128 v[16:19], v11 offset:1024
    v_add_f32 v100, v100, v76
    v_add_f32 v101, v101, v77
    v_add_f32 v102, v102, v78
    v_add_f32 v103, v103, v79
    v_add_f32 v104, v104, v80
    v_add_f32 v105, v105, v81
    v_add_f32 v106, v106, v82
    v_add_f32 v107, v107, v83
    s_waitcnt lgkmcnt(1)
    v_add_f32 v100, v100, v12
    v_add_f32 v101, v101, v13
    v_add_f32 v102, v102, v14
    v_add_f32 v103, v103, v15
    s_waitcnt lgkmcnt(0)
    v_add_f32 v104, v104, v16
    v_add_f32 v105, v105, v17
    v_add_f32 v106, v106, v18
    v_add_f32 v107, v107, v19
    v_cvt_pk_bf16_f32 v20, v100, v101
    v_cvt_pk_bf16_f32 v21, v102, v103
    v_cvt_pk_bf16_f32 v22, v104, v105
    v_cvt_pk_bf16_f32 v23, v106, v107
    s_cmp_eq_u32 s34, 0
    s_cbranch_scc1 L_sst39
    buffer_store_dwordx4 v[20:23], v2, s[16:19], s32 offen
L_ssd39:
    s_add_u32 s42, s4, 0xc00000
    s_add_u32 s43, s5, 0xc00000
    s_add_u32 s44, s6, 0xc00000
    s_add_u32 s45, s7, 0xc00000
    s_mov_b32 s36, 0
    v_add_f32 v92, v92, v100
    v_add_f32 v93, v93, v101
    v_add_f32 v94, v94, v102
    v_add_f32 v95, v95, v103
    v_add_f32 v96, v96, v104
    v_add_f32 v97, v97, v105
    v_add_f32 v98, v98, v106
    v_add_f32 v99, v99, v107
    ds_write_b128 v11, v[92:95] offset:16384
    ds_write_b128 v11, v[96:99] offset:17408
    v_and_b32 v50, 0xffff, v4
    s_lshr_b32 s30, s39, 1
    v_xor_b32 v50, s30, v50
    v_add_u32 v50, 65536, v50
    v_xor_b32 v51, 0x1000, v50
    v_add_u32 v108, s4, v50
    v_add_u32 v109, s5, v50
    v_add_u32 v110, s6, v50
    v_add_u32 v111, s7, v50
    v_add_u32 v112, s4, v51
    v_add_u32 v113, s5, v51
    v_add_u32 v114, s6, v51
    v_add_u32 v115, s7, v51
    v_mov_b32 v60, s37
    v_mov_b32 v61, s37
    v_mov_b32 v62, s37
    v_mov_b32 v63, s37
    v_dot2c_f32_bf16 v0, s37, v208
    v_dot2c_f32_bf16 v0, s37, v209
    v_dot2c_f32_bf16 v0, s37, v210
    v_dot2c_f32_bf16 v0, s37, v211
    v_dot2c_f32_bf16 v0, s37, v212
    v_dot2c_f32_bf16 v0, s37, v213
    v_dot2c_f32_bf16 v0, s37, v214
    v_dot2c_f32_bf16 v0, s37, v215
    s_mov_b32 s63, 0xc00000
    buffer_load_dwordx4 v[12:15], v4, s[16:19], s42 offen sc1
    buffer_load_dwordx4 v[16:19], v4, s[16:19], s43 offen sc1
    buffer_load_dwordx4 v[20:23], v4, s[16:19], s44 offen sc1
    buffer_load_dwordx4 v[24:27], v4, s[16:19], s45 offen sc1
    v_bfe_u32 v119, v1, 4, 1
    v_lshlrev_b32 v116, 11, v119
    v_and_b32 v6, 15, v1
    v_lshl_add_u32 v116, v6, 4, v116
    v_lshrrev_b32 v117, 5, v1
    v_lshl_add_u32 v116, v117, 8, v116
    v_mul_u32_u24 v117, 14336, v119
    v_add3_u32 v117, v117, v116, s46
    v_lshrrev_b32 v118, 2, v6
    v_lshl_add_u32 v118, v118, 4, v6
    v_lshlrev_b32 v118, 4, v118
    v_lshl_add_u32 v118, v119, 11, v118
    v_add_u32 v118, 131072, v118
    s_lshl_b32 s30, s58, 12
    s_lshl_b32 s31, s28, 13
    s_add_u32 s30, s30, s31
    s_and_b32 s31, s29, 1
    s_lshl_b32 s31, s31, 9
    s_add_u32 s30, s30, s31
    s_add_u32 s30, s30, 147456
    v_add_u32 v116, s30, v116
    s_lshl_b32 s30, s25, 1
    s_add_u32 s30, s30, s28
    s_mul_i32 s30, s30, 113
    s_mul_i32 s31, s29, 28
    s_add_u32 s30, s30, s31
    s_lshl_b32 s60, s30, 10
    s_add_u32 s60, s60, 0x1900000
    s_mov_b32 s32, s62
    s_add_u32 s31, s32, 114688
L_chk40:
    s_waitcnt vmcnt(3)
    v_max3_u32 v48, v12, v13, v14
    v_max_u32 v48, v48, v15
    v_cmp_eq_u32 vcc, -1, v48
    s_cbranch_vccnz L_rty40
L_ok40:
    buffer_load_dwordx4 v[28:31], v5, s[16:19], s42 offen sc1
    ds_write_b128 v108, v[12:15]
    v_mfma_f32_16x16x32_bf16 v[64:67], v[60:63], v[12:15], 0
    v_mfma_f32_16x16x32_bf16 v[68:71], v[12:15], v[12:15], 0
    v_dot2c_f32_bf16 v0, s37, v216
    v_dot2c_f32_bf16 v0, s37, v217
    v_dot2c_f32_bf16 v0, s37, v218
    v_dot2c_f32_bf16 v0, s37, v219
    v_dot2c_f32_bf16 v0, s37, v220
    v_dot2c_f32_bf16 v0, s37, v221
    v_dot2c_f32_bf16 v0, s37, v222
    v_dot2c_f32_bf16 v0, s37, v223
L_chk41:
    s_waitcnt vmcnt(3)
    v_max3_u32 v48, v16, v17, v18
    v_max_u32 v48, v48, v19
    v_cmp_eq_u32 vcc, -1, v48
    s_cbranch_vccnz L_rty41
L_ok41:
    buffer_load_dwordx4 v[32:35], v5, s[16:19], s43 offen sc1
    ds_write_b128 v109, v[16:19]
    v_mfma_f32_16x16x32_bf16 v[64:67], v[60:63], v[16:19], v[64:67]
    v_mfma_f32_16x16x32_bf16 v[68:71], v[16:19], v[16:19], v[68:71]
    v_dot2c_f32_bf16 v0, s37, v224
    v_dot2c_f32_bf16 v0, s37, v225
    v_dot2c_f32_bf16 v0, s37, v226
    v_dot2c_f32_bf16 v0, s37, v227
    v_dot2c_f32_bf16 v0, s37, v228
    v_dot2c_f32_bf16 v0, s37, v229
    v_dot2c_f32_bf16 v0, s37, v230
    v_dot2c_f32_bf16 v0, s37, v231
L_chk42:
    s_waitcnt vmcnt(3)
    v_max3_u32 v48, v20, v21, v22
    v_max_u32 v48, v48, v23
    v_cmp_eq_u32 vcc, -1, v48
    s_cbranch_vccnz L_rty42
L_ok42:
    buffer_load_dwordx4 v[36:39], v5, s[16:19], s44 offen sc1
    ds_write_b128 v110, v[20:23]
    v_mfma_f32_16x16x32_bf16 v[64:67], v[60:63], v[20:23], v[64:67]
    v_mfma_f32_16x16x32_bf16 v[68:71], v[20:23], v[20:23], v[68:71]
    v_dot2c_f32_bf16 v0, s37, v232
    v_dot2c_f32_bf16 v0, s37, v233
    v_dot2c_f32_bf16 v0, s37, v234
    v_dot2c_f32_bf16 v0, s37, v235
    v_dot2c_f32_bf16 v0, s37, v236
    v_dot2c_f32_bf16 v0, s37, v237
    v_dot2c_f32_bf16 v0, s37, v238
    v_dot2c_f32_bf16 v0, s37, v239
L_chk43:
    s_waitcnt vmcnt(3)
    v_max3_u32 v48, v24, v25, v26
    v_max_u32 v48, v48, v27
    v_cmp_eq_u32 vcc, -1, v48
    s_cbranch_vccnz L_rty43
L_ok43:
    buffer_load_dwordx4 v[40:43], v5, s[16:19], s45 offen sc1
    ds_write_b128 v111, v[24:27]
    v_mfma_f32_16x16x32_bf16 v[64:67], v[60:63], v[24:27], v[64:67]
    v_mfma_f32_16x16x32_bf16 v[68:71], v[24:27], v[24:27], v[68:71]
    v_dot2c_f32_bf16 v0, s37, v240
    v_dot2c_f32_bf16 v0, s37, v241
    v_dot2c_f32_bf16 v0, s37, v242
    v_dot2c_f32_bf16 v0, s37, v243
    v_dot2c_f32_bf16 v0, s37, v244
    v_dot2c_f32_bf16 v0, s37, v245
    v_dot2c_f32_bf16 v0, s37, v246
    v_dot2c_f32_bf16 v0, s37, v247
L_chk44:
    s_waitcnt vmcnt(3)
    v_max3_u32 v48, v28, v29, v30
    v_max_u32 v48, v48, v31
    v_cmp_eq_u32 vcc, -1, v48
    s_cbranch_vccnz L_rty44
L_ok44:
    ds_write_b128 v112, v[28:31]
    v_mfma_f32_16x16x32_bf16 v[64:67], v[60:63], v[28:31], v[64:67]
    v_mfma_f32_16x16x32_bf16 v[68:71], v[28:31], v[28:31], v[68:71]
    v_dot2c_f32_bf16 v0, s37, v248
    v_dot2c_f32_bf16 v0, s37, v249
    v_dot2c_f32_bf16 v0, s37, v250
    v_dot2c_f32_bf16 v0, s37, v251
    v_dot2c_f32_bf16 v0, s37, v252
    v_dot2c_f32_bf16 v0, s37, v253
    v_dot2c_f32_bf16 v0, s37, v254
    v_dot2c_f32_bf16 v0, s37, v255
L_chk45:
    s_waitcnt vmcnt(2)
    v_max3_u32 v48, v32, v33, v34
    v_max_u32 v48, v48, v35
    v_cmp_eq_u32 vcc, -1, v48
    s_cbranch_vccnz L_rty45
L_ok45:
    ds_write_b128 v113, v[32:35]
    v_mfma_f32_16x16x32_bf16 v[64:67], v[60:63], v[32:35], v[64:67]
    v_mfma_f32_16x16x32_bf16 v[68:71], v[32:35], v[32:35], v[68:71]
L_chk46:
    s_waitcnt vmcnt(1)
    v_max3_u32 v48, v36, v37, v38
    v_max_u32 v48, v48, v39
    v_cmp_eq_u32 vcc, -1, v48
    s_cbranch_vccnz L_rty46
L_ok46:
    ds_write_b128 v114, v[36:39]
    v_mfma_f32_16x16x32_bf16 v[64:67], v[60:63], v[36:39], v[64:67]
    v_mfma_f32_16x16x32_bf16 v[68:71], v[36:39], v[36:39], v[68:71]
L_chk47:
    s_waitcnt vmcnt(0)
    v_max3_u32 v48, v40, v41, v42
    v_max_u32 v48, v48, v43
    v_cmp_eq_u32 vcc, -1, v48
    s_cbranch_vccnz L_rty47
L_ok47:
    ds_write_b128 v115, v[40:43]
    v_mfma_f32_16x16x32_bf16 v[64:67], v[60:63], v[40:43], v[64:67]
    v_mfma_f32_16x16x32_bf16 v[68:71], v[40:43], v[40:43], v[68:71]
    s_nop 7
    v_cndmask_b32 v65, v68, v69, s[52:53]
    v_cndmask_b32 v65, v65, v70, s[54:55]
    v_cndmask_b32 v65, v65, v71, s[56:57]
    ds_write_b64 v11, v[64:65]
    s_waitcnt lgkmcnt(0)
    s_barrier
    s_setprio 1
    ds_read_b128 v[44:47], v117 offset:0
    ds_read_b128 v[48:51], v117 offset:512
    ds_read_b128 v[52:55], v117 offset:1024
    ds_read_b128 v[120:123], v116
    ds_read_b128 v[124:127], v116 offset:1024
    s_cmp_eq_u32 s3, 7
    s_cbranch_scc1 L_s6_w7
    ds_read_b64 v[36:37], v118 offset:0
    ds_read_b64 v[38:39], v118 offset:8192
    ds_read_b64 v[40:41], v118 offset:4096
    ds_read_b64 v[42:43], v118 offset:12288
    ds_read_b128 v[56:59], v117 offset:1536
    s_waitcnt lgkmcnt(9)
    v_mfma_f32_32x32x16_bf16 v[60:75], v[128:131], v[44:47], 0
    ds_read_b128 v[44:47], v117 offset:2048
    s_waitcnt lgkmcnt(9)
    v_mfma_f32_32x32x16_bf16 v[60:75], v[132:135], v[48:51], v[60:75]
    s_add_u32 s33, s60, 20480
    s_lshl_b32 s30, s3, 13
    s_add_u32 m0, s30, 0
    s_nop 0
    buffer_load_dwordx4 v2, s[16:19], s33 offen offset:0 sc1 lds
    ds_read_b128 v[48:51], v117 offset:2560
    s_waitcnt lgkmcnt(9)
    v_mfma_f32_32x32x16_bf16 v[60:75], v[136:139], v[52:55], v[60:75]
    ds_read_b128 v[52:55], v117 offset:3072
    s_waitcnt lgkmcnt(3)
    v_mfma_f32_32x32x16_bf16 v[60:75], v[140:143], v[56:59], v[60:75]
    ds_read_b128 v[56:59], v117 offset:3584
    s_waitcnt lgkmcnt(3)
    v_mfma_f32_32x32x16_bf16 v[60:75], v[144:147], v[44:47], v[60:75]
    v_add_f32 v36, v36, v38
    buffer_load_dwordx4 v2, s[16:19], s33 offen offset:1024 sc1 lds
    ds_read_b128 v[44:47], v117 offset:4096
    s_waitcnt lgkmcnt(3)
    v_mfma_f32_32x32x16_bf16 v[60:75], v[148:151], v[48:51], v[60:75]
    v_add_f32 v37, v37, v39
    ds_read_b128 v[48:51], v117 offset:4608
    s_waitcnt lgkmcnt(3)
    v_mfma_f32_32x32x16_bf16 v[60:75], v[152:155], v[52:55], v[60:75]
    v_mul_f32 v36, 0x3b000000, v36
    ds_read_b128 v[52:55], v117 offset:5120
    s_waitcnt lgkmcnt(3)
    v_mfma_f32_32x32x16_bf16 v[60:75], v[156:159], v[56:59], v[60:75]
    v_mul_f32 v37, 0x3b000000, v37
    buffer_load_dwordx4 v2, s[16:19], s33 offen offset:2048 sc1 lds
    ds_read_b128 v[56:59], v117 offset:5632
    s_waitcnt lgkmcnt(3)
    v_mfma_f32_32x32x16_bf16 v[60:75], v[160:163], v[44:47], v[60:75]
    v_fma_f32 v37, -v36, v36, v37
    ds_read_b128 v[44:47], v117 offset:6144
    s_waitcnt lgkmcnt(3)
    v_mfma_f32_32x32x16_bf16 v[60:75], v[164:167], v[48:51], v[60:75]
    v_max_f32 v37, 0, v37
    ds_read_b128 v[48:51], v117 offset:6656
    s_waitcnt lgkmcnt(3)
    v_mfma_f32_32x32x16_bf16 v[60:75], v[168:171], v[52:55], v[60:75]
    v_add_f32 v37, 0x3727c5ac, v37
    buffer_load_dwordx4 v2, s[16:19], s33 offen offset:3072 sc1 lds
    ds_read_b128 v[52:55], v117 offset:7168
    s_waitcnt lgkmcnt(3)
    v_mfma_f32_32x32x16_bf16 v[60:75], v[172:175], v[56:59], v[60:75]
    v_rsq_f32 v37, v37
    ds_read_b128 v[56:59], v117 offset:7680
    s_waitcnt lgkmcnt(3)
    v_mfma_f32_32x32x16_bf16 v[60:75], v[176:179], v[44:47], v[60:75]
    v_mul_f32 v38, v37, v37
    ds_read_b128 v[44:47], v117 offset:8192
    s_waitcnt lgkmcnt(3)
    v_mfma_f32_32x32x16_bf16 v[60:75], v[180:183], v[48:51], v[60:75]
    v_mul_f32 v39, 0xc0135761, v37
    s_add_u32 s33, s60, 24576
    s_lshl_b32 s30, s3, 13
    s_add_u32 m0, s30, 4096
    s_nop 0
    buffer_load_dwordx4 v2, s[16:19], s33 offen offset:0 sc1 lds
    ds_read_b128 v[48:51], v117 offset:8704
    s_waitcnt lgkmcnt(3)
    v_mfma_f32_32x32x16_bf16 v[60:75], v[184:187], v[52:55], v[60:75]
    v_rcp_f32 v37, v37
    ds_read_b128 v[52:55], v117 offset:9216
    s_waitcnt lgkmcnt(3)
    v_mfma_f32_32x32x16_bf16 v[60:75], v[188:191], v[56:59], v[60:75]
    v_mul_f32 v38, v38, v39
    ds_read_b128 v[56:59], v117 offset:9728
    s_waitcnt lgkmcnt(3)
    v_mfma_f32_32x32x16_bf16 v[60:75], v[192:195], v[44:47], v[60:75]
    v_mul_f32 v38, 0x3d372713, v38
    buffer_load_dwordx4 v2, s[16:19], s33 offen offset:1024 sc1 lds
    ds_read_b128 v[44:47], v117 offset:10240
    s_waitcnt lgkmcnt(3)
    v_mfma_f32_32x32x16_bf16 v[60:75], v[196:199], v[48:51], v[60:75]
    v_add_f32 v40, v40, v42
    ds_read_b128 v[48:51], v117 offset:10752
    s_waitcnt lgkmcnt(3)
    v_mfma_f32_32x32x16_bf16 v[60:75], v[200:203], v[52:55], v[60:75]
    v_add_f32 v41, v41, v43
    ds_read_b128 v[52:55], v117 offset:11264
    s_waitcnt lgkmcnt(3)
    v_mfma_f32_32x32x16_bf16 v[60:75], v[204:207], v[56:59], v[60:75]
    v_mul_f32 v40, 0x3b000000, v40
    buffer_load_dwordx4 v2, s[16:19], s33 offen offset:2048 sc1 lds
    ds_read_b128 v[56:59], v117 offset:11776
    s_waitcnt lgkmcnt(3)
    v_mfma_f32_32x32x16_bf16 v[60:75], v[208:211], v[44:47], v[60:75]
    v_mul_f32 v41, 0x3b000000, v41
    ds_read_b128 v[44:47], v117 offset:12288
    s_waitcnt lgkmcnt(3)
    v_mfma_f32_32x32x16_bf16 v[60:75], v[212:215], v[48:51], v[60:75]
    v_fma_f32 v41, -v40, v40, v41
    ds_read_b128 v[48:51], v117 offset:12800
    s_waitcnt lgkmcnt(3)
    v_mfma_f32_32x32x16_bf16 v[60:75], v[216:219], v[52:55], v[60:75]
    v_max_f32 v41, 0, v41
    v_mov_b32 v12, v0
    s_nop 1
    v_permlane32_swap_b32 v12, v0
    v_add_f32 v12, v12, v0
    s_lshl_b32 s30, s3, 11
    s_add_u32 s30, s30, 132096
    v_lshl_add_u32 v13, v1, 2, s30
    ds_write_b32 v13, v12
    v_lshrrev_b32 v14, 5, v1
    v_lshl_add_u32 v14, v14, 4, s30
    ds_read_b128 v[92:95], v14 offset:0
    ds_read_b128 v[96:99], v14 offset:32
    ds_read_b128 v[100:103], v14 offset:64
    ds_read_b128 v[104:107], v14 offset:96
    buffer_load_dwordx4 v2, s[16:19], s33 offen offset:3072 sc1 lds
    ds_read_b128 v[52:55], v117 offset:13312
    s_waitcnt lgkmcnt(8)
    v_mfma_f32_32x32x16_bf16 v[60:75], v[220:223], v[56:59], v[60:75]
    v_add_f32 v41, 0x3727c5ac, v41
    ds_read_b128 v[56:59], v117 offset:13824
    s_waitcnt lgkmcnt(8)
    v_mfma_f32_32x32x16_bf16 v[60:75], v[224:227], v[44:47], v[60:75]
    v_rsq_f32 v41, v41
    ds_read_b128 v[44:47], v117 offset:14336
    s_waitcnt lgkmcnt(8)
    v_mfma_f32_32x32x16_bf16 v[60:75], v[228:231], v[48:51], v[60:75]
    v_mul_f32 v42, v41, v41
    ds_read_b128 v[48:51], v117 offset:14848
    s_waitcnt lgkmcnt(3)
    v_mfma_f32_32x32x16_bf16 v[60:75], v[232:235], v[52:55], v[60:75]
    v_mul_f32 v43, 0xc0135761, v41
    ds_read_b128 v[52:55], v117 offset:15360
    s_waitcnt lgkmcnt(3)
    v_mfma_f32_32x32x16_bf16 v[60:75], v[236:239], v[56:59], v[60:75]
    v_rcp_f32 v41, v41
    ds_read_b128 v[56:59], v117 offset:15872
    s_waitcnt lgkmcnt(3)
    v_mfma_f32_32x32x16_bf16 v[60:75], v[240:243], v[44:47], v[60:75]
    v_mul_f32 v42, v42, v43
    ds_read_b128 v[44:47], v117 offset:32768
    s_waitcnt lgkmcnt(3)
    v_mfma_f32_32x32x16_bf16 v[60:75], v[244:247], v[48:51], v[60:75]
    v_mul_f32 v42, 0x3d372713, v42
    ds_read_b128 v[48:51], v117 offset:33280
    s_waitcnt lgkmcnt(3)
    v_mfma_f32_32x32x16_bf16 v[60:75], v[248:251], v[52:55], v[60:75]
    ds_read_b128 v[52:55], v117 offset:33792
    s_waitcnt lgkmcnt(3)
    v_mfma_f32_32x32x16_bf16 v[60:75], v[252:255], v[56:59], v[60:75]
    s_setprio 0
    s_nop 10
    v_fma_f32 v60, -v36, v92, v60
    v_fma_f32 v61, -v36, v93, v61
    v_fma_f32 v62, -v36, v94, v62
    v_fma_f32 v63, -v36, v95, v63
    v_fma_f32 v64, -v36, v96, v64
    v_fma_f32 v65, -v36, v97, v65
    v_fma_f32 v66, -v36, v98, v66
    v_fma_f32 v67, -v36, v99, v67
    v_mul_f32 v12, v60, v60
    v_mul_f32 v13, v61, v61
    v_mul_f32 v14, v62, v62
    v_mul_f32 v15, v63, v63
    v_mul_f32 v16, v64, v64
    v_mul_f32 v17, v65, v65
    v_mul_f32 v18, v66, v66
    v_mul_f32 v19, v67, v67
    v_fma_f32 v12, v12, v38, v39
    v_fma_f32 v13, v13, v38, v39
    v_fma_f32 v14, v14, v38, v39
    v_fma_f32 v15, v15, v38, v39
    v_fma_f32 v16, v16, v38, v39
    v_fma_f32 v17, v17, v38, v39
    v_fma_f32 v18, v18, v38, v39
    v_fma_f32 v19, v19, v38, v39
    v_mul_f32 v12, v12, v60
    v_mul_f32 v13, v13, v61
    v_mul_f32 v14, v14, v62
    v_mul_f32 v15, v15, v63
    v_mul_f32 v16, v16, v64
    v_mul_f32 v17, v17, v65
    v_mul_f32 v18, v18, v66
    v_mul_f32 v19, v19, v67
    v_exp_f32 v12, v12
    v_exp_f32 v13, v13
    v_exp_f32 v14, v14
    v_exp_f32 v15, v15
    v_exp_f32 v16, v16
    v_exp_f32 v17, v17
    v_exp_f32 v18, v18
    v_exp_f32 v19, v19
    v_fma_f32 v12, v12, v37, v37
    v_fma_f32 v13, v13, v37, v37
    v_fma_f32 v14, v14, v37, v37
    v_fma_f32 v15, v15, v37, v37
    v_fma_f32 v16, v16, v37, v37
    v_fma_f32 v17, v17, v37, v37
    v_fma_f32 v18, v18, v37, v37
    v_fma_f32 v19, v19, v37, v37
    v_rcp_f32 v12, v12
    v_rcp_f32 v13, v13
    v_rcp_f32 v14, v14
    v_rcp_f32 v15, v15
    v_rcp_f32 v16, v16
    v_rcp_f32 v17, v17
    v_rcp_f32 v18, v18
    v_rcp_f32 v19, v19
    v_mul_f32 v60, v60, v12
    v_mul_f32 v61, v61, v13
    v_mul_f32 v62, v62, v14
    v_mul_f32 v63, v63, v15
    v_mul_f32 v64, v64, v16
    v_mul_f32 v65, v65, v17
    v_mul_f32 v66, v66, v18
    v_mul_f32 v67, v67, v19
    v_cvt_pk_bf16_f32 v20, v60, v61
    v_cvt_pk_bf16_f32 v21, v62, v63
    v_cvt_pk_bf16_f32 v22, v64, v65
    v_cvt_pk_bf16_f32 v23, v66, v67
    v_fma_f32 v68, -v36, v100, v68
    v_fma_f32 v69, -v36, v101, v69
    v_fma_f32 v70, -v36, v102, v70
    v_fma_f32 v71, -v36, v103, v71
    v_fma_f32 v72, -v36, v104, v72
    v_fma_f32 v73, -v36, v105, v73
    v_fma_f32 v74, -v36, v106, v74
    v_fma_f32 v75, -v36, v107, v75
    v_mul_f32 v12, v68, v68
    v_mul_f32 v13, v69, v69
    v_mul_f32 v14, v70, v70
    v_mul_f32 v15, v71, v71
    v_mul_f32 v16, v72, v72
    v_mul_f32 v17, v73, v73
    v_mul_f32 v18, v74, v74
    v_mul_f32 v19, v75, v75
    v_fma_f32 v12, v12, v38, v39
    v_fma_f32 v13, v13, v38, v39
    v_fma_f32 v14, v14, v38, v39
    v_fma_f32 v15, v15, v38, v39
    v_fma_f32 v16, v16, v38, v39
    v_fma_f32 v17, v17, v38, v39
    v_fma_f32 v18, v18, v38, v39
    v_fma_f32 v19, v19, v38, v39
    v_mul_f32 v12, v12, v68
    v_mul_f32 v13, v13, v69
    v_mul_f32 v14, v14, v70
    v_mul_f32 v15, v15, v71
    v_mul_f32 v16, v16, v72
    v_mul_f32 v17, v17, v73
    v_mul_f32 v18, v18, v74
    v_mul_f32 v19, v19, v75
    v_exp_f32 v12, v12
    v_exp_f32 v13, v13
    v_exp_f32 v14, v14
    v_exp_f32 v15, v15
    v_exp_f32 v16, v16
    v_exp_f32 v17, v17
    v_exp_f32 v18, v18
    v_exp_f32 v19, v19
    v_fma_f32 v12, v12, v37, v37
    v_fma_f32 v13, v13, v37, v37
    v_fma_f32 v14, v14, v37, v37
    v_fma_f32 v15, v15, v37, v37
    v_fma_f32 v16, v16, v37, v37
    v_fma_f32 v17, v17, v37, v37
    v_fma_f32 v18, v18, v37, v37
    v_fma_f32 v19, v19, v37, v37
    v_rcp_f32 v12, v12
    v_rcp_f32 v13, v13
    v_rcp_f32 v14, v14
    v_rcp_f32 v15, v15
    v_rcp_f32 v16, v16
    v_rcp_f32 v17, v17
    v_rcp_f32 v18, v18
    v_rcp_f32 v19, v19
    v_mul_f32 v68, v68, v12
    v_mul_f32 v69, v69, v13
    v_mul_f32 v70, v70, v14
    v_mul_f32 v71, v71, v15
    v_mul_f32 v72, v72, v16
    v_mul_f32 v73, v73, v17
    v_mul_f32 v74, v74, v18
    v_mul_f32 v75, v75, v19
    v_cvt_pk_bf16_f32 v24, v68, v69
    v_cvt_pk_bf16_f32 v25, v70, v71
    v_cvt_pk_bf16_f32 v26, v72, v73
    v_cvt_pk_bf16_f32 v27, v74, v75
    s_setprio 3
    s_cmp_eq_u32 s34, 0
    s_cbranch_scc1 L_sst48
    buffer_store_dwordx4 v[20:23], v2, s[16:19], s32 offen
L_ssd48:
    s_cmp_eq_u32 s34, 0
    s_cbranch_scc1 L_sst49
    buffer_store_dwordx4 v[24:27], v2, s[16:19], s32 offen offset:1024
L_ssd49:
    s_setprio 1
    ds_read_b128 v[56:59], v117 offset:34304
    s_waitcnt lgkmcnt(3)
    v_mfma_f32_32x32x16_bf16 v[76:91], v[128:131], v[44:47], 0
    ds_read_b128 v[44:47], v117 offset:34816
    s_waitcnt lgkmcnt(3)
    v_mfma_f32_32x32x16_bf16 v[76:91], v[132:135], v[48:51], v[76:91]
    ds_read_b128 v[48:51], v117 offset:35328
    s_waitcnt lgkmcnt(3)
    v_mfma_f32_32x32x16_bf16 v[76:91], v[136:139], v[52:55], v[76:91]
    ds_read_b128 v[52:55], v117 offset:35840
    s_waitcnt lgkmcnt(3)
    v_mfma_f32_32x32x16_bf16 v[76:91], v[140:143], v[56:59], v[76:91]
    ds_read_b128 v[56:59], v117 offset:36352
    s_waitcnt lgkmcnt(3)
    v_mfma_f32_32x32x16_bf16 v[76:91], v[144:147], v[44:47], v[76:91]
    s_add_u32 s33, s60, 0
    buffer_load_dwordx4 v[144:147], v2, s[16:19], s33 offen offset:0 sc1
    ds_read_b128 v[44:47], v117 offset:36864
    s_waitcnt lgkmcnt(3)
    v_mfma_f32_32x32x16_bf16 v[76:91], v[148:151], v[48:51], v[76:91]
    s_add_u32 s33, s60, 0
    buffer_load_dwordx4 v[148:151], v2, s[16:19], s33 offen offset:1024 sc1
    ds_read_b128 v[48:51], v117 offset:37376
    s_waitcnt lgkmcnt(3)
    v_mfma_f32_32x32x16_bf16 v[76:91], v[152:155], v[52:55], v[76:91]
    s_add_u32 s33, s60, 0
    buffer_load_dwordx4 v[152:155], v2, s[16:19], s33 offen offset:2048 sc1
    ds_read_b128 v[52:55], v117 offset:37888
    s_waitcnt lgkmcnt(3)
    v_mfma_f32_32x32x16_bf16 v[76:91], v[156:159], v[56:59], v[76:91]
    s_add_u32 s33, s60, 0
    buffer_load_dwordx4 v[156:159], v2, s[16:19], s33 offen offset:3072 sc1
    ds_read_b128 v[56:59], v117 offset:38400
    s_waitcnt lgkmcnt(3)
    v_mfma_f32_32x32x16_bf16 v[76:91], v[160:163], v[44:47], v[76:91]
    s_add_u32 s33, s60, 4096
    buffer_load_dwordx4 v[160:163], v2, s[16:19], s33 offen offset:0 sc1
    ds_read_b128 v[44:47], v117 offset:38912
    s_waitcnt lgkmcnt(3)
    v_mfma_f32_32x32x16_bf16 v[76:91], v[164:167], v[48:51], v[76:91]
    s_add_u32 s33, s60, 4096
    buffer_load_dwordx4 v[164:167], v2, s[16:19], s33 offen offset:1024 sc1
    ds_read_b128 v[48:51], v117 offset:39424
    s_waitcnt lgkmcnt(3)
    v_mfma_f32_32x32x16_bf16 v[76:91], v[168:171], v[52:55], v[76:91]
    s_add_u32 s33, s60, 4096
    buffer_load_dwordx4 v[168:171], v2, s[16:19], s33 offen offset:2048 sc1
    ds_read_b128 v[52:55], v117 offset:39936
    s_waitcnt lgkmcnt(3)
    v_mfma_f32_32x32x16_bf16 v[76:91], v[172:175], v[56:59], v[76:91]
    s_add_u32 s33, s60, 4096
    buffer_load_dwordx4 v[172:175], v2, s[16:19], s33 offen offset:3072 sc1
    ds_read_b128 v[56:59], v117 offset:40448
    s_waitcnt lgkmcnt(3)
    v_mfma_f32_32x32x16_bf16 v[76:91], v[176:179], v[44:47], v[76:91]
    s_add_u32 s33, s60, 8192
    buffer_load_dwordx4 v[176:179], v2, s[16:19], s33 offen offset:0 sc1
    ds_read_b128 v[44:47], v117 offset:40960
    s_waitcnt lgkmcnt(3)
    v_mfma_f32_32x32x16_bf16 v[76:91], v[180:183], v[48:51], v[76:91]
    s_add_u32 s33, s60, 8192
    buffer_load_dwordx4 v[180:183], v2, s[16:19], s33 offen offset:1024 sc1
    ds_read_b128 v[48:51], v117 offset:41472
    s_waitcnt lgkmcnt(3)
    v_mfma_f32_32x32x16_bf16 v[76:91], v[184:187], v[52:55], v[76:91]
    s_add_u32 s33, s60, 8192
    buffer_load_dwordx4 v[184:187], v2, s[16:19], s33 offen offset:2048 sc1
    ds_read_b128 v[52:55], v117 offset:41984
    s_waitcnt lgkmcnt(3)
    v_mfma_f32_32x32x16_bf16 v[76:91], v[188:191], v[56:59], v[76:91]
    s_add_u32 s33, s60, 8192
    buffer_load_dwordx4 v[188:191], v2, s[16:19], s33 offen offset:3072 sc1
    ds_read_b128 v[56:59], v117 offset:42496
    s_waitcnt lgkmcnt(3)
    v_mfma_f32_32x32x16_bf16 v[76:91], v[192:195], v[44:47], v[76:91]
    s_add_u32 s33, s60, 12288
    buffer_load_dwordx4 v[192:195], v2, s[16:19], s33 offen offset:0 sc1
    ds_read_b128 v[44:47], v117 offset:43008
    s_waitcnt lgkmcnt(3)
    v_mfma_f32_32x32x16_bf16 v[76:91], v[196:199], v[48:51], v[76:91]
    s_add_u32 s33, s60, 12288
    buffer_load_dwordx4 v[196:199], v2, s[16:19], s33 offen offset:1024 sc1
    ds_read_b128 v[48:51], v117 offset:43520
    s_waitcnt lgkmcnt(3)
    v_mfma_f32_32x32x16_bf16 v[76:91], v[200:203], v[52:55], v[76:91]
    s_add_u32 s33, s60, 12288
    buffer_load_dwordx4 v[200:203], v2, s[16:19], s33 offen offset:2048 sc1
    ds_read_b128 v[52:55], v117 offset:44032
    s_waitcnt lgkmcnt(3)
    v_mfma_f32_32x32x16_bf16 v[76:91], v[204:207], v[56:59], v[76:91]
    s_add_u32 s33, s60, 12288
    buffer_load_dwordx4 v[204:207], v2, s[16:19], s33 offen offset:3072 sc1
    ds_read_b128 v[56:59], v117 offset:44544
    s_waitcnt lgkmcnt(3)
    v_mfma_f32_32x32x16_bf16 v[76:91], v[208:211], v[44:47], v[76:91]
    s_add_u32 s33, s60, 16384
    buffer_load_dwordx4 v[208:211], v2, s[16:19], s33 offen offset:0 sc1
    ds_read_b128 v[44:47], v117 offset:45056
    s_waitcnt lgkmcnt(3)
    v_mfma_f32_32x32x16_bf16 v[76:91], v[212:215], v[48:51], v[76:91]
    s_add_u32 s33, s60, 16384
    buffer_load_dwordx4 v[212:215], v2, s[16:19], s33 offen offset:1024 sc1
    ds_read_b128 v[48:51], v117 offset:45568
    s_waitcnt lgkmcnt(3)
    v_mfma_f32_32x32x16_bf16 v[76:91], v[216:219], v[52:55], v[76:91]
    s_add_u32 s33, s60, 16384
    buffer_load_dwordx4 v[216:219], v2, s[16:19], s33 offen offset:2048 sc1
    ds_read_b128 v[52:55], v117 offset:46080
    s_waitcnt lgkmcnt(3)
    v_mfma_f32_32x32x16_bf16 v[76:91], v[220:223], v[56:59], v[76:91]
    s_add_u32 s33, s60, 16384
    buffer_load_dwordx4 v[220:223], v2, s[16:19], s33 offen offset:3072 sc1
    ds_read_b128 v[56:59], v117 offset:46592
    s_waitcnt lgkmcnt(3)
    v_mfma_f32_32x32x16_bf16 v[76:91], v[224:227], v[44:47], v[76:91]
    ds_read_b128 v[44:47], v117 offset:47104
    s_waitcnt lgkmcnt(3)
    v_mfma_f32_32x32x16_bf16 v[76:91], v[228:231], v[48:51], v[76:91]
    ds_read_b128 v[48:51], v117 offset:47616
    s_waitcnt lgkmcnt(3)
    v_mfma_f32_32x32x16_bf16 v[76:91], v[232:235], v[52:55], v[76:91]
    ds_read_b128 v[52:55], v117 offset:48128
    s_waitcnt lgkmcnt(3)
    v_mfma_f32_32x32x16_bf16 v[76:91], v[236:239], v[56:59], v[76:91]
    ds_read_b128 v[56:59], v117 offset:48640
    s_waitcnt lgkmcnt(3)
    v_mfma_f32_32x32x16_bf16 v[76:91], v[240:243], v[44:47], v[76:91]
    s_waitcnt lgkmcnt(2)
    v_mfma_f32_32x32x16_bf16 v[76:91], v[244:247], v[48:51], v[76:91]
    s_waitcnt lgkmcnt(1)
    v_mfma_f32_32x32x16_bf16 v[76:91], v[248:251], v[52:55], v[76:91]
    s_waitcnt lgkmcnt(0)
    v_mfma_f32_32x32x16_bf16 v[76:91], v[252:255], v[56:59], v[76:91]
    s_waitcnt vmcnt(22)
    s_lshl_b32 s30, s3, 13
    v_add_u32 v44, s30, v2
    ds_read_b128 v[224:227], v44 offset:0
    ds_read_b128 v[228:231], v44 offset:1024
    ds_read_b128 v[232:235], v44 offset:2048
    ds_read_b128 v[236:239], v44 offset:3072
    ds_read_b128 v[240:243], v44 offset:4096
    ds_read_b128 v[244:247], v44 offset:5120
    ds_read_b128 v[248:251], v44 offset:6144
    ds_read_b128 v[252:255], v44 offset:7168
    s_setprio 0
    v_fma_f32 v76, -v40, v92, v76
    v_fma_f32 v77, -v40, v93, v77
    v_fma_f32 v78, -v40, v94, v78
    v_fma_f32 v79, -v40, v95, v79
    v_fma_f32 v80, -v40, v96, v80
    v_fma_f32 v81, -v40, v97, v81
    v_fma_f32 v82, -v40, v98, v82
    v_fma_f32 v83, -v40, v99, v83
    v_mul_f32 v12, v76, v76
    v_mul_f32 v13, v77, v77
    v_mul_f32 v14, v78, v78
    v_mul_f32 v15, v79, v79
    v_mul_f32 v16, v80, v80
    v_mul_f32 v17, v81, v81
    v_mul_f32 v18, v82, v82
    v_mul_f32 v19, v83, v83
    v_fma_f32 v12, v12, v42, v43
    v_fma_f32 v13, v13, v42, v43
    v_fma_f32 v14, v14, v42, v43
    v_fma_f32 v15, v15, v42, v43
    v_fma_f32 v16, v16, v42, v43
    v_fma_f32 v17, v17, v42, v43
    v_fma_f32 v18, v18, v42, v43
    v_fma_f32 v19, v19, v42, v43
    v_mul_f32 v12, v12, v76
    v_mul_f32 v13, v13, v77
    v_mul_f32 v14, v14, v78
    v_mul_f32 v15, v15, v79
    v_mul_f32 v16, v16, v80
    v_mul_f32 v17, v17, v81
    v_mul_f32 v18, v18, v82
    v_mul_f32 v19, v19, v83
    v_exp_f32 v12, v12
    v_exp_f32 v13, v13
    v_exp_f32 v14, v14
    v_exp_f32 v15, v15
    v_exp_f32 v16, v16
    v_exp_f32 v17, v17
    v_exp_f32 v18, v18
    v_exp_f32 v19, v19
    v_fma_f32 v12, v12, v41, v41
    v_fma_f32 v13, v13, v41, v41
    v_fma_f32 v14, v14, v41, v41
    v_fma_f32 v15, v15, v41, v41
    v_fma_f32 v16, v16, v41, v41
    v_fma_f32 v17, v17, v41, v41
    v_fma_f32 v18, v18, v41, v41
    v_fma_f32 v19, v19, v41, v41
    v_rcp_f32 v12, v12
    v_rcp_f32 v13, v13
    v_rcp_f32 v14, v14
    v_rcp_f32 v15, v15
    v_rcp_f32 v16, v16
    v_rcp_f32 v17, v17
    v_rcp_f32 v18, v18
    v_rcp_f32 v19, v19
    v_mul_f32 v76, v76, v12
    v_mul_f32 v77, v77, v13
    v_mul_f32 v78, v78, v14
    v_mul_f32 v79, v79, v15
    v_mul_f32 v80, v80, v16
    v_mul_f32 v81, v81, v17
    v_mul_f32 v82, v82, v18
    v_mul_f32 v83, v83, v19
    v_cvt_pk_bf16_f32 v28, v76, v77
    v_cvt_pk_bf16_f32 v29, v78, v79
    v_cvt_pk_bf16_f32 v30, v80, v81
    v_cvt_pk_bf16_f32 v31, v82, v83
    v_fma_f32 v84, -v40, v100, v84
    v_fma_f32 v85, -v40, v101, v85
    v_fma_f32 v86, -v40, v102, v86
    v_fma_f32 v87, -v40, v103, v87
    v_fma_f32 v88, -v40, v104, v88
    v_fma_f32 v89, -v40, v105, v89
    v_fma_f32 v90, -v40, v106, v90
    v_fma_f32 v91, -v40, v107, v91
    v_mul_f32 v12, v84, v84
    v_mul_f32 v13, v85, v85
    v_mul_f32 v14, v86, v86
    v_mul_f32 v15, v87, v87
    v_mul_f32 v16, v88, v88
    v_mul_f32 v17, v89, v89
    v_mul_f32 v18, v90, v90
    v_mul_f32 v19, v91, v91
    v_fma_f32 v12, v12, v42, v43
    v_fma_f32 v13, v13, v42, v43
    v_fma_f32 v14, v14, v42, v43
    v_fma_f32 v15, v15, v42, v43
    v_fma_f32 v16, v16, v42, v43
    v_fma_f32 v17, v17, v42, v43
    v_fma_f32 v18, v18, v42, v43
    v_fma_f32 v19, v19, v42, v43
    v_mul_f32 v12, v12, v84
    v_mul_f32 v13, v13, v85
    v_mul_f32 v14, v14, v86
    v_mul_f32 v15, v15, v87
    v_mul_f32 v16, v16, v88
    v_mul_f32 v17, v17, v89
    v_mul_f32 v18, v18, v90
    v_mul_f32 v19, v19, v91
    v_exp_f32 v12, v12
    v_exp_f32 v13, v13
    v_exp_f32 v14, v14
    v_exp_f32 v15, v15
    v_exp_f32 v16, v16
    v_exp_f32 v17, v17
    v_exp_f32 v18, v18
    v_exp_f32 v19, v19
    v_fma_f32 v12, v12, v41, v41
    v_fma_f32 v13, v13, v41, v41
    v_fma_f32 v14, v14, v41, v41
    v_fma_f32 v15, v15, v41, v41
    v_fma_f32 v16, v16, v41, v41
    v_fma_f32 v17, v17, v41, v41
    v_fma_f32 v18, v18, v41, v41
    v_fma_f32 v19, v19, v41, v41
    v_rcp_f32 v12, v12
    v_rcp_f32 v13, v13
    v_rcp_f32 v14, v14
    v_rcp_f32 v15, v15
    v_rcp_f32 v16, v16
    v_rcp_f32 v17, v17
    v_rcp_f32 v18, v18
    v_rcp_f32 v19, v19
    v_mul_f32 v84, v84, v12
    v_mul_f32 v85, v85, v13
    v_mul_f32 v86, v86, v14
    v_mul_f32 v87, v87, v15
    v_mul_f32 v88, v88, v16
    v_mul_f32 v89, v89, v17
    v_mul_f32 v90, v90, v18
    v_mul_f32 v91, v91, v19
    v_cvt_pk_bf16_f32 v32, v84, v85
    v_cvt_pk_bf16_f32 v33, v86, v87
    v_cvt_pk_bf16_f32 v34, v88, v89
    v_cvt_pk_bf16_f32 v35, v90, v91
    s_setprio 3
    s_cmp_eq_u32 s34, 0
    s_cbranch_scc1 L_sst50
    buffer_store_dwordx4 v[28:31], v2, s[16:19], s31 offen
L_ssd50:
    s_cmp_eq_u32 s34, 0
    s_cbranch_scc1 L_sst51
    buffer_store_dwordx4 v[32:35], v2, s[16:19], s31 offen offset:1024
L_ssd51:
    s_setprio 0
L_s6_done:
    s_waitcnt lgkmcnt(0)
    s_barrier
    s_lshl_b32 s30, s24, 1
    s_mul_i32 s30, s30, 112
    s_mul_i32 s31, s29, 28
    s_add_u32 s30, s30, s31
    s_lshl_b32 s30, s30, 10
    s_add_u32 s30, s30, 0xe00000
    s_mul_i32 s31, s58, 114688
    s_add_u32 s42, s30, s31
    s_sub_u32 s43, s30, s31
    s_add_u32 s43, s43, 114688
    s_lshl_b32 s44, s3, 12
    s_mov_b32 s36, 0
    v_min_u32 v76, 27, v1
    v_lshlrev_b32 v76, 10, v76
    s_waitcnt vmcnt(0)
    buffer_load_dword v77, v76, s[16:19], s42 offen offset:1020 sc1
    s_add_u32 s33, s42, 0
    s_add_u32 m0, s44, 0
    s_nop 0
    buffer_load_dwordx4 v2, s[16:19], s33 offen offset:0 sc1 lds
    buffer_load_dwordx4 v2, s[16:19], s33 offen offset:1024 sc1 lds
    buffer_load_dwordx4 v2, s[16:19], s33 offen offset:2048 sc1 lds
    buffer_load_dwordx4 v2, s[16:19], s33 offen offset:3072 sc1 lds
    v_add_u32 v128, s44, v2
    v_xor_b32 v129, 0x1000, v128
    v_add_u32 v130, 0x10000, v128
    v_add_u32 v131, 0x10000, v129
    s_xor_b32 s30, s3, 2
    s_mul_i32 s30, s30, 6144
    s_add_u32 s30, s30, 114688
    v_add_u32 v132, s30, v2
    s_xor_b32 s30, s3, 4
    s_mul_i32 s30, s30, 6144
    s_add_u32 s30, s30, 116736
    v_add_u32 v133, s30, v2
    s_xor_b32 s30, s3, 6
    s_mul_i32 s30, s30, 6144
    s_add_u32 s30, s30, 118784
    v_add_u32 v134, s30, v2
    s_mul_i32 s30, s3, 6144
    s_add_u32 s30, s30, 114688
    v_add_u32 v135, s30, v2
    s_lshl_b32 s30, s58, 15
    s_add_u32 s30, s30, s41
    s_lshl_b32 s31, s25, 7
    s_add_u32 s30, s30, s31
    s_lshl_b32 s31, s28, 6
    s_add_u32 s30, s30, s31
    s_and_b32 s31, s29, 1
    s_lshl_b32 s31, s31, 5
    s_add_u32 s30, s30, s31
    v_and_b32 v137, 31, v1
    v_lshlrev_b32 v137, 10, v137
    v_lshrrev_b32 v136, 5, v1
    v_lshl_add_u32 v137, v136, 4, v137
    v_add_u32 v137, s30, v137
    s_waitcnt vmcnt(4)
    v_cmp_eq_u32 vcc, -1, v77
    s_cbranch_vccz L_go7
L_spin7:
    buffer_load_dword v77, v76, s[16:19], s42 offen offset:1020 sc1
    s_add_u32 s36, s36, 1
    s_waitcnt vmcnt(0)
    v_cmp_eq_u32 vcc, -1, v77
    s_cmp_gt_u32 s36, 20000
    s_cselect_b64 vcc, 0, vcc
    s_cbranch_vccnz L_spin7
    s_add_u32 s33, s42, 0
    s_add_u32 m0, s44, 0
    s_nop 0
    buffer_load_dwordx4 v2, s[16:19], s33 offen offset:0 sc1 lds
    buffer_load_dwordx4 v2, s[16:19], s33 offen offset:1024 sc1 lds
    buffer_load_dwordx4 v2, s[16:19], s33 offen offset:2048 sc1 lds
    buffer_load_dwordx4 v2, s[16:19], s33 offen offset:3072 sc1 lds
L_go7:
    s_add_u32 s33, s42, 4096
    s_add_u32 m0, s44, 32768
    s_nop 0
    buffer_load_dwordx4 v2, s[16:19], s33 offen offset:0 sc1 lds
    buffer_load_dwordx4 v2, s[16:19], s33 offen offset:1024 sc1 lds
    buffer_load_dwordx4 v2, s[16:19], s33 offen offset:2048 sc1 lds
    buffer_load_dwordx4 v2, s[16:19], s33 offen offset:3072 sc1 lds
    s_waitcnt vmcnt(4)
    s_barrier
    ds_read_b128 v[12:15], v128 offset:0
    ds_read_b128 v[16:19], v129 offset:0
    s_add_u32 s33, s42, 8192
    s_add_u32 m0, s44, 65536
    s_nop 0
    buffer_load_dwordx4 v2, s[16:19], s33 offen offset:0 sc1 lds
    ds_read_b128 v[20:23], v128 offset:1024
    ds_read_b128 v[24:27], v129 offset:1024
    buffer_load_dwordx4 v2, s[16:19], s33 offen offset:1024 sc1 lds
    ds_read_b128 v[28:31], v128 offset:2048
    ds_read_b128 v[32:35], v129 offset:2048
    s_waitcnt lgkmcnt(5)
    v_mfma_f32_32x32x16_bf16 v[84:99], v[144:147], v[12:15], 0
    v_max3_u32 v136, v12, v13, v14
    v_max_u32 v136, v136, v15
    s_waitcnt lgkmcnt(4)
    v_mfma_f32_32x32x16_bf16 v[100:115], v[144:147], v[16:19], 0
    v_max3_u32 v138, v16, v17, v18
    v_max_u32 v138, v138, v19
    buffer_load_dwordx4 v2, s[16:19], s33 offen offset:2048 sc1 lds
    ds_read_b128 v[36:39], v128 offset:3072
    ds_read_b128 v[40:43], v129 offset:3072
    s_waitcnt lgkmcnt(5)
    v_mfma_f32_32x32x16_bf16 v[84:99], v[148:151], v[20:23], v[84:99]
    v_max3_u32 v136, v136, v20, v21
    v_max3_u32 v136, v136, v22, v23
    s_waitcnt lgkmcnt(4)
    v_mfma_f32_32x32x16_bf16 v[100:115], v[148:151], v[24:27], v[100:115]
    v_max3_u32 v138, v138, v24, v25
    v_max3_u32 v138, v138, v26, v27
    buffer_load_dwordx4 v2, s[16:19], s33 offen offset:3072 sc1 lds
    s_waitcnt vmcnt(4)
    s_waitcnt lgkmcnt(0)
    s_barrier
    ds_read_b128 v[44:47], v128 offset:32768
    ds_read_b128 v[48:51], v129 offset:32768
    v_mfma_f32_32x32x16_bf16 v[84:99], v[152:155], v[28:31], v[84:99]
    v_max3_u32 v136, v136, v28, v29
    v_max3_u32 v136, v136, v30, v31
    v_mfma_f32_32x32x16_bf16 v[100:115], v[152:155], v[32:35], v[100:115]
    v_max3_u32 v138, v138, v32, v33
    v_max3_u32 v138, v138, v34, v35
    s_add_u32 s33, s42, 12288
    s_add_u32 m0, s44, 98304
    s_nop 0
    buffer_load_dwordx4 v2, s[16:19], s33 offen offset:0 sc1 lds
    ds_read_b128 v[52:55], v128 offset:33792
    ds_read_b128 v[56:59], v129 offset:33792
    v_mfma_f32_32x32x16_bf16 v[84:99], v[156:159], v[36:39], v[84:99]
    v_max3_u32 v136, v136, v36, v37
    v_max3_u32 v136, v136, v38, v39
    v_mfma_f32_32x32x16_bf16 v[100:115], v[156:159], v[40:43], v[100:115]
    v_max3_u32 v138, v138, v40, v41
    v_max3_u32 v138, v138, v42, v43
    buffer_load_dwordx4 v2, s[16:19], s33 offen offset:1024 sc1 lds
    ds_read_b128 v[60:63], v128 offset:34816
    ds_read_b128 v[64:67], v129 offset:34816
    s_waitcnt lgkmcnt(5)
    v_mfma_f32_32x32x16_bf16 v[84:99], v[160:163], v[44:47], v[84:99]
    v_max3_u32 v136, v136, v44, v45
    v_max3_u32 v136, v136, v46, v47
    s_waitcnt lgkmcnt(4)
    v_mfma_f32_32x32x16_bf16 v[100:115], v[160:163], v[48:51], v[100:115]
    v_max3_u32 v138, v138, v48, v49
    v_max3_u32 v138, v138, v50, v51
    buffer_load_dwordx4 v2, s[16:19], s33 offen offset:2048 sc1 lds
    ds_read_b128 v[68:71], v128 offset:35840
    ds_read_b128 v[72:75], v129 offset:35840
    s_waitcnt lgkmcnt(5)
    v_mfma_f32_32x32x16_bf16 v[84:99], v[164:167], v[52:55], v[84:99]
    v_max3_u32 v136, v136, v52, v53
    v_max3_u32 v136, v136, v54, v55
    s_waitcnt lgkmcnt(4)
    v_mfma_f32_32x32x16_bf16 v[100:115], v[164:167], v[56:59], v[100:115]
    v_max3_u32 v138, v138, v56, v57
    v_max3_u32 v138, v138, v58, v59
    buffer_load_dwordx4 v2, s[16:19], s33 offen offset:3072 sc1 lds
    s_waitcnt vmcnt(4)
    s_waitcnt lgkmcnt(0)
    s_barrier
    ds_read_b128 v[12:15], v130 offset:0
    ds_read_b128 v[16:19], v131 offset:0
    v_mfma_f32_32x32x16_bf16 v[84:99], v[168:171], v[60:63], v[84:99]
    v_max3_u32 v136, v136, v60, v61
    v_max3_u32 v136, v136, v62, v63
    v_mfma_f32_32x32x16_bf16 v[100:115], v[168:171], v[64:67], v[100:115]
    v_max3_u32 v138, v138, v64, v65
    v_max3_u32 v138, v138, v66, v67
    s_add_u32 s33, s42, 16384
    s_add_u32 m0, s44, 0
    s_nop 0
    buffer_load_dwordx4 v2, s[16:19], s33 offen offset:0 sc1 lds
    ds_read_b128 v[20:23], v130 offset:1024
    ds_read_b128 v[24:27], v131 offset:1024
    v_mfma_f32_32x32x16_bf16 v[84:99], v[172:175], v[68:71], v[84:99]
    v_max3_u32 v136, v136, v68, v69
    v_max3_u32 v136, v136, v70, v71
    v_mfma_f32_32x32x16_bf16 v[100:115], v[172:175], v[72:75], v[100:115]
    v_max3_u32 v138, v138, v72, v73
    v_max3_u32 v138, v138, v74, v75
    buffer_load_dwordx4 v2, s[16:19], s33 offen offset:1024 sc1 lds
    ds_read_b128 v[28:31], v130 offset:2048
    ds_read_b128 v[32:35], v131 offset:2048
    s_waitcnt lgkmcnt(5)
    v_mfma_f32_32x32x16_bf16 v[84:99], v[176:179], v[12:15], v[84:99]
    v_max3_u32 v136, v136, v12, v13
    v_max3_u32 v136, v136, v14, v15
    s_waitcnt lgkmcnt(4)
    v_mfma_f32_32x32x16_bf16 v[100:115], v[176:179], v[16:19], v[100:115]
    v_max3_u32 v138, v138, v16, v17
    v_max3_u32 v138, v138, v18, v19
    buffer_load_dwordx4 v2, s[16:19], s33 offen offset:2048 sc1 lds
    ds_read_b128 v[36:39], v130 offset:3072
    ds_read_b128 v[40:43], v131 offset:3072
    s_waitcnt lgkmcnt(5)
    v_mfma_f32_32x32x16_bf16 v[84:99], v[180:183], v[20:23], v[84:99]
    v_max3_u32 v136, v136, v20, v21
    v_max3_u32 v136, v136, v22, v23
    s_waitcnt lgkmcnt(4)
    v_mfma_f32_32x32x16_bf16 v[100:115], v[180:183], v[24:27], v[100:115]
    v_max3_u32 v138, v138, v24, v25
    v_max3_u32 v138, v138, v26, v27
    buffer_load_dwordx4 v2, s[16:19], s33 offen offset:3072 sc1 lds
    s_waitcnt vmcnt(4)
    s_waitcnt lgkmcnt(0)
    s_barrier
    ds_read_b128 v[44:47], v130 offset:32768
    ds_read_b128 v[48:51], v131 offset:32768
    v_mfma_f32_32x32x16_bf16 v[84:99], v[184:187], v[28:31], v[84:99]
    v_max3_u32 v136, v136, v28, v29
    v_max3_u32 v136, v136, v30, v31
    v_mfma_f32_32x32x16_bf16 v[100:115], v[184:187], v[32:35], v[100:115]
    v_max3_u32 v138, v138, v32, v33
    v_max3_u32 v138, v138, v34, v35
    s_add_u32 s33, s42, 20480
    s_add_u32 m0, s44, 32768
    s_nop 0
    buffer_load_dwordx4 v2, s[16:19], s33 offen offset:0 sc1 lds
    ds_read_b128 v[52:55], v130 offset:33792
    ds_read_b128 v[56:59], v131 offset:33792
    v_mfma_f32_32x32x16_bf16 v[84:99], v[188:191], v[36:39], v[84:99]
    v_max3_u32 v136, v136, v36, v37
    v_max3_u32 v136, v136, v38, v39
    v_mfma_f32_32x32x16_bf16 v[100:115], v[188:191], v[40:43], v[100:115]
    v_max3_u32 v138, v138, v40, v41
    v_max3_u32 v138, v138, v42, v43
    buffer_load_dwordx4 v2, s[16:19], s33 offen offset:1024 sc1 lds
    ds_read_b128 v[60:63], v130 offset:34816
    ds_read_b128 v[64:67], v131 offset:34816
    s_waitcnt lgkmcnt(5)
    v_mfma_f32_32x32x16_bf16 v[84:99], v[192:195], v[44:47], v[84:99]
    v_max3_u32 v136, v136, v44, v45
    v_max3_u32 v136, v136, v46, v47
    s_waitcnt lgkmcnt(4)
    v_mfma_f32_32x32x16_bf16 v[100:115], v[192:195], v[48:51], v[100:115]
    v_max3_u32 v138, v138, v48, v49
    v_max3_u32 v138, v138, v50, v51
    buffer_load_dwordx4 v2, s[16:19], s33 offen offset:2048 sc1 lds
    ds_read_b128 v[68:71], v130 offset:35840
    ds_read_b128 v[72:75], v131 offset:35840
    s_waitcnt lgkmcnt(5)
    v_mfma_f32_32x32x16_bf16 v[84:99], v[196:199], v[52:55], v[84:99]
    v_max3_u32 v136, v136, v52, v53
    v_max3_u32 v136, v136, v54, v55
    s_waitcnt lgkmcnt(4)
    v_mfma_f32_32x32x16_bf16 v[100:115], v[196:199], v[56:59], v[100:115]
    v_max3_u32 v138, v138, v56, v57
    v_max3_u32 v138, v138, v58, v59
    buffer_load_dwordx4 v2, s[16:19], s33 offen offset:3072 sc1 lds
    s_waitcnt vmcnt(4)
    s_waitcnt lgkmcnt(0)
    s_barrier
    ds_read_b128 v[12:15], v128 offset:0
    ds_read_b128 v[16:19], v129 offset:0
    v_mfma_f32_32x32x16_bf16 v[84:99], v[200:203], v[60:63], v[84:99]
    v_max3_u32 v136, v136, v60, v61
    v_max3_u32 v136, v136, v62, v63
    v_mfma_f32_32x32x16_bf16 v[100:115], v[200:203], v[64:67], v[100:115]
    v_max3_u32 v138, v138, v64, v65
    v_max3_u32 v138, v138, v66, v67
    s_add_u32 s33, s42, 24576
    s_add_u32 m0, s44, 65536
    s_nop 0
    buffer_load_dwordx4 v2, s[16:19], s33 offen offset:0 sc1 lds
    ds_read_b128 v[20:23], v128 offset:1024
    ds_read_b128 v[24:27], v129 offset:1024
    v_mfma_f32_32x32x16_bf16 v[84:99], v[204:207], v[68:71], v[84:99]
    v_max3_u32 v136, v136, v68, v69
    v_max3_u32 v136, v136, v70, v71
    v_mfma_f32_32x32x16_bf16 v[100:115], v[204:207], v[72:75], v[100:115]
    v_max3_u32 v138, v138, v72, v73
    v_max3_u32 v138, v138, v74, v75
    buffer_load_dwordx4 v2, s[16:19], s33 offen offset:1024 sc1 lds
    ds_read_b128 v[28:31], v128 offset:2048
    ds_read_b128 v[32:35], v129 offset:2048
    s_waitcnt lgkmcnt(5)
    v_mfma_f32_32x32x16_bf16 v[84:99], v[208:211], v[12:15], v[84:99]
    v_max3_u32 v136, v136, v12, v13
    v_max3_u32 v136, v136, v14, v15
    s_waitcnt lgkmcnt(4)
    v_mfma_f32_32x32x16_bf16 v[100:115], v[208:211], v[16:19], v[100:115]
    v_max3_u32 v138, v138, v16, v17
    v_max3_u32 v138, v138, v18, v19
    buffer_load_dwordx4 v2, s[16:19], s33 offen offset:2048 sc1 lds
    ds_read_b128 v[36:39], v128 offset:3072
    ds_read_b128 v[40:43], v129 offset:3072
    s_waitcnt lgkmcnt(5)
    v_mfma_f32_32x32x16_bf16 v[84:99], v[212:215], v[20:23], v[84:99]
    v_max3_u32 v136, v136, v20, v21
    v_max3_u32 v136, v136, v22, v23
    s_waitcnt lgkmcnt(4)
    v_mfma_f32_32x32x16_bf16 v[100:115], v[212:215], v[24:27], v[100:115]
    v_max3_u32 v138, v138, v24, v25
    v_max3_u32 v138, v138, v26, v27
    buffer_load_dwordx4 v2, s[16:19], s33 offen offset:3072 sc1 lds
    s_waitcnt vmcnt(4)
    s_waitcnt lgkmcnt(0)
    s_barrier
    ds_read_b128 v[44:47], v128 offset:32768
    ds_read_b128 v[48:51], v129 offset:32768
    v_mfma_f32_32x32x16_bf16 v[84:99], v[216:219], v[28:31], v[84:99]
    v_max3_u32 v136, v136, v28, v29
    v_max3_u32 v136, v136, v30, v31
    v_mfma_f32_32x32x16_bf16 v[100:115], v[216:219], v[32:35], v[100:115]
    v_max3_u32 v138, v138, v32, v33
    v_max3_u32 v138, v138, v34, v35
    ds_read_b128 v[52:55], v128 offset:33792
    ds_read_b128 v[56:59], v129 offset:33792
    v_mfma_f32_32x32x16_bf16 v[84:99], v[220:223], v[36:39], v[84:99]
    v_max3_u32 v136, v136, v36, v37
    v_max3_u32 v136, v136, v38, v39
    v_mfma_f32_32x32x16_bf16 v[100:115], v[220:223], v[40:43], v[100:115]
    v_max3_u32 v138, v138, v40, v41
    v_max3_u32 v138, v138, v42, v43
    ds_read_b128 v[60:63], v128 offset:34816
    ds_read_b128 v[64:67], v129 offset:34816
    s_waitcnt lgkmcnt(5)
    v_mfma_f32_32x32x16_bf16 v[84:99], v[224:227], v[44:47], v[84:99]
    v_max3_u32 v136, v136, v44, v45
    v_max3_u32 v136, v136, v46, v47
    s_waitcnt lgkmcnt(4)
    v_mfma_f32_32x32x16_bf16 v[100:115], v[224:227], v[48:51], v[100:115]
    v_max3_u32 v138, v138, v48, v49
    v_max3_u32 v138, v138, v50, v51
    ds_read_b128 v[68:71], v128 offset:35840
    ds_read_b128 v[72:75], v129 offset:35840
    s_waitcnt lgkmcnt(5)
    v_mfma_f32_32x32x16_bf16 v[84:99], v[228:231], v[52:55], v[84:99]
    v_max3_u32 v136, v136, v52, v53
    v_max3_u32 v136, v136, v54, v55
    s_waitcnt lgkmcnt(4)
    v_mfma_f32_32x32x16_bf16 v[100:115], v[228:231], v[56:59], v[100:115]
    v_max3_u32 v138, v138, v56, v57
    v_max3_u32 v138, v138, v58, v59
    s_waitcnt vmcnt(0)
    s_waitcnt lgkmcnt(0)
    s_barrier
    ds_read_b128 v[12:15], v130 offset:0
    ds_read_b128 v[16:19], v131 offset:0
    v_mfma_f32_32x32x16_bf16 v[84:99], v[232:235], v[60:63], v[84:99]
    v_max3_u32 v136, v136, v60, v61
    v_max3_u32 v136, v136, v62, v63
    v_mfma_f32_32x32x16_bf16 v[100:115], v[232:235], v[64:67], v[100:115]
    v_max3_u32 v138, v138, v64, v65
    v_max3_u32 v138, v138, v66, v67
    ds_read_b128 v[20:23], v130 offset:1024
    ds_read_b128 v[24:27], v131 offset:1024
    v_mfma_f32_32x32x16_bf16 v[84:99], v[236:239], v[68:71], v[84:99]
    v_max3_u32 v136, v136, v68, v69
    v_max3_u32 v136, v136, v70, v71
    v_mfma_f32_32x32x16_bf16 v[100:115], v[236:239], v[72:75], v[100:115]
    v_max3_u32 v138, v138, v72, v73
    v_max3_u32 v138, v138, v74, v75
    ds_read_b128 v[28:31], v130 offset:2048
    ds_read_b128 v[32:35], v131 offset:2048
    s_waitcnt lgkmcnt(5)
    v_mfma_f32_32x32x16_bf16 v[84:99], v[240:243], v[12:15], v[84:99]
    v_max3_u32 v136, v136, v12, v13
    v_max3_u32 v136, v136, v14, v15
    s_waitcnt lgkmcnt(4)
    v_mfma_f32_32x32x16_bf16 v[100:115], v[240:243], v[16:19], v[100:115]
    v_max3_u32 v138, v138, v16, v17
    v_max3_u32 v138, v138, v18, v19
    ds_read_b128 v[36:39], v130 offset:3072
    ds_read_b128 v[40:43], v131 offset:3072
    s_waitcnt lgkmcnt(5)
    v_mfma_f32_32x32x16_bf16 v[84:99], v[244:247], v[20:23], v[84:99]
    v_max3_u32 v136, v136, v20, v21
    v_max3_u32 v136, v136, v22, v23
    s_waitcnt lgkmcnt(4)
    v_mfma_f32_32x32x16_bf16 v[100:115], v[244:247], v[24:27], v[100:115]
    v_max3_u32 v138, v138, v24, v25
    v_max3_u32 v138, v138, v26, v27
    s_waitcnt lgkmcnt(3)
    v_mfma_f32_32x32x16_bf16 v[84:99], v[248:251], v[28:31], v[84:99]
    v_max3_u32 v136, v136, v28, v29
    v_max3_u32 v136, v136, v30, v31
    s_waitcnt lgkmcnt(2)
    v_mfma_f32_32x32x16_bf16 v[100:115], v[248:251], v[32:35], v[100:115]
    v_max3_u32 v138, v138, v32, v33
    v_max3_u32 v138, v138, v34, v35
    s_waitcnt lgkmcnt(1)
    v_mfma_f32_32x32x16_bf16 v[84:99], v[252:255], v[36:39], v[84:99]
    v_max3_u32 v136, v136, v36, v37
    v_max3_u32 v136, v136, v38, v39
    s_waitcnt lgkmcnt(0)
    v_mfma_f32_32x32x16_bf16 v[100:115], v[252:255], v[40:43], v[100:115]
    v_max3_u32 v138, v138, v40, v41
    v_max3_u32 v138, v138, v42, v43
    v_max_u32 v136, v136, v138
    v_cmp_eq_u32 vcc, -1, v136
    s_cbranch_vccnz L_s7_slow
L_s7_red:
    s_nop 2
    ds_write_b128 v132, v[92:95]
    ds_write_b128 v132, v[96:99] offset:1024
    s_nop 1
    ds_write_b128 v133, v[100:103]
    ds_write_b128 v133, v[104:107] offset:1024
    ds_write_b128 v134, v[108:111]
    ds_write_b128 v134, v[112:115] offset:1024
    v_add_f32 v120, v120, v84
    v_add_f32 v121, v121, v85
    v_add_f32 v122, v122, v86
    v_add_f32 v123, v123, v87
    v_add_f32 v124, v124, v88
    v_add_f32 v125, v125, v89
    v_add_f32 v126, v126, v90
    v_add_f32 v127, v127, v91
    s_waitcnt lgkmcnt(0)
    s_barrier
    ds_read_b128 v[12:15], v135 offset:0
    ds_read_b128 v[16:19], v135 offset:1024
    ds_read_b128 v[20:23], v135 offset:2048
    ds_read_b128 v[24:27], v135 offset:3072
    ds_read_b128 v[28:31], v135 offset:4096
    ds_read_b128 v[32:35], v135 offset:5120
    s_waitcnt lgkmcnt(5)
    v_add_f32 v120, v120, v12
    v_add_f32 v121, v121, v13
    v_add_f32 v122, v122, v14
    v_add_f32 v123, v123, v15
    s_waitcnt lgkmcnt(4)
    v_add_f32 v124, v124, v16
    v_add_f32 v125, v125, v17
    v_add_f32 v126, v126, v18
    v_add_f32 v127, v127, v19
    s_waitcnt lgkmcnt(3)
    v_add_f32 v120, v120, v20
    v_add_f32 v121, v121, v21
    v_add_f32 v122, v122, v22
    v_add_f32 v123, v123, v23
    s_waitcnt lgkmcnt(2)
    v_add_f32 v124, v124, v24
    v_add_f32 v125, v125, v25
    v_add_f32 v126, v126, v26
    v_add_f32 v127, v127, v27
    s_waitcnt lgkmcnt(1)
    v_add_f32 v120, v120, v28
    v_add_f32 v121, v121, v29
    v_add_f32 v122, v122, v30
    v_add_f32 v123, v123, v31
    s_waitcnt lgkmcnt(0)
    v_add_f32 v124, v124, v32
    v_add_f32 v125, v125, v33
    v_add_f32 v126, v126, v34
    v_add_f32 v127, v127, v35
    v_cvt_pk_bf16_f32 v140, v120, v121
    v_cvt_pk_bf16_f32 v141, v122, v123
    v_cvt_pk_bf16_f32 v142, v124, v125
    v_cvt_pk_bf16_f32 v143, v126, v127
    buffer_store_dwordx4 v[140:143], v137, s[20:23], 0 offen
L_k2_end:
    s_endpgm
L_sst0:
    buffer_store_dwordx4 v[88:91], v2, s[16:19], s43 offen sc1
    s_nop 0
    s_branch L_ssd0
L_sst1:
    buffer_store_dwordx4 v[92:95], v26, s[16:19], s43 offen sc1
    s_nop 0
    s_branch L_ssd1
L_sst2:
    buffer_store_dwordx4 v[96:99], v27, s[16:19], s44 offen sc1
    s_nop 0
    s_branch L_ssd2
L_sst3:
    buffer_store_dwordx4 v[100:103], v27, s[16:19], s44 offen offset:512 sc1
    s_nop 0
    s_branch L_ssd3
L_sst4:
    buffer_store_dwordx4 v[80:83], v2, s[16:19], s42 offen sc1
    s_nop 0
    s_branch L_ssd4
L_sst5:
    buffer_store_dwordx4 v[84:87], v26, s[16:19], s42 offen sc1
    s_nop 0
    s_branch L_ssd5
L_sst6:
    buffer_store_dwordx4 v[116:119], v2, s[16:19], s30 offen sc1
    s_nop 0
    s_branch L_ssd6
L_sst7:
    buffer_store_dwordx4 v[116:119], v2, s[16:19], s30 offen sc1
    s_nop 0
    s_branch L_ssd7
L_sst8:
    buffer_store_dwordx4 v[116:119], v2, s[16:19], s30 offen sc1
    s_nop 0
    s_branch L_ssd8
L_sst9:
    buffer_store_dwordx4 v[116:119], v2, s[16:19], s30 offen sc1
    s_nop 0
    s_branch L_ssd9
L_sst10:
    buffer_store_dwordx4 v[116:119], v2, s[16:19], s30 offen offset:1024 sc1
    s_nop 0
    s_branch L_ssd10
L_sst11:
    buffer_store_dwordx4 v[116:119], v2, s[16:19], s30 offen sc1
    s_nop 0
    s_branch L_ssd11
L_sst12:
    buffer_store_dwordx4 v[116:119], v2, s[16:19], s30 offen offset:1024 sc1
    s_nop 0
    s_branch L_ssd12
L_pkretry:
    s_add_u32 s36, s36, 1
    s_cmp_gt_u32 s36, 20000
    s_cbranch_scc1 L_pkok
    s_sleep 16
    buffer_load_dwordx4 v[244:247], v2, s[16:19], s55 offen sc1
    s_waitcnt vmcnt(0)
    s_branch L_pkchk
L_rdwait:
    s_sleep 4
    ds_read_b32 v124, v125
    s_waitcnt lgkmcnt(0)
    s_branch L_rdchk
L_att_fallback:
    s_nop 15
    s_waitcnt vmcnt(0) lgkmcnt(0)
    v_mov_b32 v80, 0xff800000
    s_mov_b32 s32, 0
    s_lshl_b32 s33, s11, 16
    s_add_u32 s33, s33, 0x200000
L_fb_max:
    buffer_load_dwordx4 v[16:19], v2, s[16:19], s33 offen sc1
    s_add_u32 s33, s33, 0x400
    s_waitcnt vmcnt(0)
    v_mfma_f32_32x32x16_bf16 v[64:79], v[16:19], v[12:15], 0
    s_nop 11
    v_max3_f32 v80, v80, v64, v65
    v_max3_f32 v80, v80, v66, v67
    v_max3_f32 v80, v80, v68, v69
    v_max3_f32 v80, v80, v70, v71
    v_max3_f32 v80, v80, v72, v73
    v_max3_f32 v80, v80, v74, v75
    v_max3_f32 v80, v80, v76, v77
    v_max3_f32 v80, v80, v78, v79
    s_add_u32 s32, s32, 1
    s_cmp_lt_u32 s32, 64
    s_cbranch_scc1 L_fb_max
    v_mov_b32 v81, v80
    s_nop 1
    v_permlane32_swap_b32 v80, v81
    v_max_f32 v80, v80, v81
    v_sub_f32 v48, 0, v80
    v_sub_f32 v49, 0, v80
    v_sub_f32 v50, 0, v80
    v_sub_f32 v51, 0, v80
    v_sub_f32 v52, 0, v80
    v_sub_f32 v53, 0, v80
    v_sub_f32 v54, 0, v80
    v_sub_f32 v55, 0, v80
    v_sub_f32 v56, 0, v80
    v_sub_f32 v57, 0, v80
    v_sub_f32 v58, 0, v80
    v_sub_f32 v59, 0, v80
    v_sub_f32 v60, 0, v80
    v_sub_f32 v61, 0, v80
    v_sub_f32 v62, 0, v80
    v_sub_f32 v63, 0, v80
    v_mov_b32 v96, 0
    v_mov_b32 v97, 0
    v_mov_b32 v98, 0
    v_mov_b32 v99, 0
    v_mov_b32 v100, 0
    v_mov_b32 v101, 0
    v_mov_b32 v102, 0
    v_mov_b32 v103, 0
    v_mov_b32 v104, 0
    v_mov_b32 v105, 0
    v_mov_b32 v106, 0
    v_mov_b32 v107, 0
    v_mov_b32 v108, 0
    v_mov_b32 v109, 0
    v_mov_b32 v110, 0
    v_mov_b32 v111, 0
    v_and_b32 v82, 0x1ff, v113
    v_add_u32 v82, 0x200000, v82
    s_sub_u32 s33, s33, 0x10000
    s_mov_b32 s32, 0
    s_nop 7
L_fb_main:
    buffer_load_dwordx4 v[16:19], v2, s[16:19], s33 offen sc1
    s_mov_b32 exec_lo, 0xffff
    s_mov_b32 exec_hi, 0xffff
    buffer_load_dwordx4 v[24:27], v82, s[16:19], s33 offen sc1
    buffer_load_dwordx4 v[28:31], v82, s[16:19], s33 offen offset:512 sc1
    s_mov_b64 exec, -1
    s_add_u32 s33, s33, 0x400
    s_waitcnt vmcnt(2)
    v_mfma_f32_32x32x16_bf16 v[64:79], v[16:19], v[12:15], v[48:63]
    s_nop 11
    v_exp_f32 v64, v64
    v_exp_f32 v65, v65
    v_exp_f32 v66, v66
    v_exp_f32 v67, v67
    v_exp_f32 v68, v68
    v_exp_f32 v69, v69
    v_exp_f32 v70, v70
    v_exp_f32 v71, v71
    v_exp_f32 v72, v72
    v_exp_f32 v73, v73
    v_exp_f32 v74, v74
    v_exp_f32 v75, v75
    v_exp_f32 v76, v76
    v_exp_f32 v77, v77
    v_exp_f32 v78, v78
    v_exp_f32 v79, v79
    v_cvt_pk_bf16_f32 v40, v64, v65
    v_cvt_pk_bf16_f32 v41, v66, v67
    v_cvt_pk_bf16_f32 v42, v68, v69
    v_cvt_pk_bf16_f32 v43, v70, v71
    v_cvt_pk_bf16_f32 v44, v72, v73
    v_cvt_pk_bf16_f32 v45, v74, v75
    v_cvt_pk_bf16_f32 v46, v76, v77
    v_cvt_pk_bf16_f32 v47, v78, v79
    s_waitcnt vmcnt(1)
    v_mfma_f32_32x32x16_bf16 v[96:111], v[24:27], v[40:43], v[96:111]
    s_waitcnt vmcnt(0)
    v_mfma_f32_32x32x16_bf16 v[96:111], v[28:31], v[44:47], v[96:111]
    s_add_u32 s32, s32, 1
    s_cmp_lt_u32 s32, 64
    s_nop 15
    s_cbranch_scc1 L_fb_main
    s_branch L_att_done
L_rty13:
    s_add_u32 s36, s36, 1
    s_cmp_gt_u32 s36, 20000
    s_cbranch_scc1 L_ok13
    s_waitcnt vmcnt(0)
    buffer_load_dwordx4 v[12:15], v4, s[16:19], s42 offen sc1
    buffer_load_dwordx4 v[16:19], v4, s[16:19], s43 offen sc1
    buffer_load_dwordx4 v[20:23], v4, s[16:19], s44 offen sc1
    buffer_load_dwordx4 v[24:27], v4, s[16:19], s45 offen sc1
    s_waitcnt vmcnt(0)
    s_branch L_chk13
L_rty14:
    s_add_u32 s36, s36, 1
    s_cmp_gt_u32 s36, 20000
    s_cbranch_scc1 L_ok14
    s_waitcnt vmcnt(0)
    buffer_load_dwordx4 v[16:19], v4, s[16:19], s43 offen sc1
    buffer_load_dwordx4 v[20:23], v4, s[16:19], s44 offen sc1
    buffer_load_dwordx4 v[24:27], v4, s[16:19], s45 offen sc1
    buffer_load_dwordx4 v[28:31], v5, s[16:19], s42 offen sc1
    s_waitcnt vmcnt(0)
    s_branch L_chk14
L_rty15:
    s_add_u32 s36, s36, 1
    s_cmp_gt_u32 s36, 20000
    s_cbranch_scc1 L_ok15
    s_waitcnt vmcnt(0)
    buffer_load_dwordx4 v[20:23], v4, s[16:19], s44 offen sc1
    buffer_load_dwordx4 v[24:27], v4, s[16:19], s45 offen sc1
    buffer_load_dwordx4 v[28:31], v5, s[16:19], s42 offen sc1
    buffer_load_dwordx4 v[32:35], v5, s[16:19], s43 offen sc1
    s_waitcnt vmcnt(0)
    s_branch L_chk15
L_rty16:
    s_add_u32 s36, s36, 1
    s_cmp_gt_u32 s36, 20000
    s_cbranch_scc1 L_ok16
    s_waitcnt vmcnt(0)
    buffer_load_dwordx4 v[24:27], v4, s[16:19], s45 offen sc1
    buffer_load_dwordx4 v[28:31], v5, s[16:19], s42 offen sc1
    buffer_load_dwordx4 v[32:35], v5, s[16:19], s43 offen sc1
    buffer_load_dwordx4 v[36:39], v5, s[16:19], s44 offen sc1
    s_waitcnt vmcnt(0)
    s_branch L_chk16
L_rty17:
    s_add_u32 s36, s36, 1
    s_cmp_gt_u32 s36, 20000
    s_cbranch_scc1 L_ok17
    s_waitcnt vmcnt(0)
    buffer_load_dwordx4 v[28:31], v5, s[16:19], s42 offen sc1
    buffer_load_dwordx4 v[32:35], v5, s[16:19], s43 offen sc1
    buffer_load_dwordx4 v[36:39], v5, s[16:19], s44 offen sc1
    buffer_load_dwordx4 v[40:43], v5, s[16:19], s45 offen sc1
    s_waitcnt vmcnt(0)
    s_branch L_chk17
L_rty18:
    s_add_u32 s36, s36, 1
    s_cmp_gt_u32 s36, 20000
    s_cbranch_scc1 L_ok18
    s_waitcnt vmcnt(0)
    buffer_load_dwordx4 v[32:35], v5, s[16:19], s43 offen sc1
    buffer_load_dwordx4 v[36:39], v5, s[16:19], s44 offen sc1
    buffer_load_dwordx4 v[40:43], v5, s[16:19], s45 offen sc1
    s_waitcnt vmcnt(0)
    s_branch L_chk18
L_rty19:
    s_add_u32 s36, s36, 1
    s_cmp_gt_u32 s36, 20000
    s_cbranch_scc1 L_ok19
    s_waitcnt vmcnt(0)
    buffer_load_dwordx4 v[36:39], v5, s[16:19], s44 offen sc1
    buffer_load_dwordx4 v[40:43], v5, s[16:19], s45 offen sc1
    s_waitcnt vmcnt(0)
    s_branch L_chk19
L_rty20:
    s_add_u32 s36, s36, 1
    s_cmp_gt_u32 s36, 20000
    s_cbranch_scc1 L_ok20
    s_waitcnt vmcnt(0)
    buffer_load_dwordx4 v[40:43], v5, s[16:19], s45 offen sc1
    s_waitcnt vmcnt(0)
    s_branch L_chk20
L_sst21:
    buffer_store_dwordx4 v[20:23], v2, s[16:19], s32 offen sc1
    s_nop 0
    s_branch L_ssd21
L_rty22:
    s_add_u32 s36, s36, 1
    s_cmp_gt_u32 s36, 20000
    s_cbranch_scc1 L_ok22
    s_waitcnt vmcnt(0)
    buffer_load_dwordx4 v[12:15], v4, s[16:19], s42 offen sc1
    buffer_load_dwordx4 v[16:19], v4, s[16:19], s43 offen sc1
    buffer_load_dwordx4 v[20:23], v4, s[16:19], s44 offen sc1
    buffer_load_dwordx4 v[24:27], v4, s[16:19], s45 offen sc1
    s_waitcnt vmcnt(0)
    s_branch L_chk22
L_rty23:
    s_add_u32 s36, s36, 1
    s_cmp_gt_u32 s36, 20000
    s_cbranch_scc1 L_ok23
    s_waitcnt vmcnt(0)
    buffer_load_dwordx4 v[16:19], v4, s[16:19], s43 offen sc1
    buffer_load_dwordx4 v[20:23], v4, s[16:19], s44 offen sc1
    buffer_load_dwordx4 v[24:27], v4, s[16:19], s45 offen sc1
    buffer_load_dwordx4 v[28:31], v5, s[16:19], s42 offen sc1
    s_waitcnt vmcnt(0)
    s_branch L_chk23
L_rty24:
    s_add_u32 s36, s36, 1
    s_cmp_gt_u32 s36, 20000
    s_cbranch_scc1 L_ok24
    s_waitcnt vmcnt(0)
    buffer_load_dwordx4 v[20:23], v4, s[16:19], s44 offen sc1
    buffer_load_dwordx4 v[24:27], v4, s[16:19], s45 offen sc1
    buffer_load_dwordx4 v[28:31], v5, s[16:19], s42 offen sc1
    buffer_load_dwordx4 v[32:35], v5, s[16:19], s43 offen sc1
    s_waitcnt vmcnt(0)
    s_branch L_chk24
L_rty25:
    s_add_u32 s36, s36, 1
    s_cmp_gt_u32 s36, 20000
    s_cbranch_scc1 L_ok25
    s_waitcnt vmcnt(0)
    buffer_load_dwordx4 v[24:27], v4, s[16:19], s45 offen sc1
    buffer_load_dwordx4 v[28:31], v5, s[16:19], s42 offen sc1
    buffer_load_dwordx4 v[32:35], v5, s[16:19], s43 offen sc1
    buffer_load_dwordx4 v[36:39], v5, s[16:19], s44 offen sc1
    s_waitcnt vmcnt(0)
    s_branch L_chk25
L_rty26:
    s_add_u32 s36, s36, 1
    s_cmp_gt_u32 s36, 20000
    s_cbranch_scc1 L_ok26
    s_waitcnt vmcnt(0)
    buffer_load_dwordx4 v[28:31], v5, s[16:19], s42 offen sc1
    buffer_load_dwordx4 v[32:35], v5, s[16:19], s43 offen sc1
    buffer_load_dwordx4 v[36:39], v5, s[16:19], s44 offen sc1
    buffer_load_dwordx4 v[40:43], v5, s[16:19], s45 offen sc1
    s_waitcnt vmcnt(0)
    s_branch L_chk26
L_rty27:
    s_add_u32 s36, s36, 1
    s_cmp_gt_u32 s36, 20000
    s_cbranch_scc1 L_ok27
    s_waitcnt vmcnt(0)
    buffer_load_dwordx4 v[32:35], v5, s[16:19], s43 offen sc1
    buffer_load_dwordx4 v[36:39], v5, s[16:19], s44 offen sc1
    buffer_load_dwordx4 v[40:43], v5, s[16:19], s45 offen sc1
    s_waitcnt vmcnt(0)
    s_branch L_chk27
L_rty28:
    s_add_u32 s36, s36, 1
    s_cmp_gt_u32 s36, 20000
    s_cbranch_scc1 L_ok28
    s_waitcnt vmcnt(0)
    buffer_load_dwordx4 v[36:39], v5, s[16:19], s44 offen sc1
    buffer_load_dwordx4 v[40:43], v5, s[16:19], s45 offen sc1
    s_waitcnt vmcnt(0)
    s_branch L_chk28
L_rty29:
    s_add_u32 s36, s36, 1
    s_cmp_gt_u32 s36, 20000
    s_cbranch_scc1 L_ok29
    s_waitcnt vmcnt(0)
    buffer_load_dwordx4 v[40:43], v5, s[16:19], s45 offen sc1
    s_waitcnt vmcnt(0)
    s_branch L_chk29
L_sst30:
    buffer_store_dwordx4 v[20:23], v2, s[16:19], s32 offen sc1
    s_nop 0
    s_branch L_ssd30
L_rty31:
    s_add_u32 s36, s36, 1
    s_cmp_gt_u32 s36, 20000
    s_cbranch_scc1 L_ok31
    s_waitcnt vmcnt(0)
    buffer_load_dwordx4 v[12:15], v6, s[16:19], s42 offen sc1
    buffer_load_dwordx4 v[16:19], v6, s[16:19], s43 offen sc1
    buffer_load_dwordx4 v[20:23], v6, s[16:19], s44 offen sc1
    buffer_load_dwordx4 v[24:27], v6, s[16:19], s45 offen sc1
    s_waitcnt vmcnt(0)
    s_branch L_chk31
L_rty32:
    s_add_u32 s36, s36, 1
    s_cmp_gt_u32 s36, 20000
    s_cbranch_scc1 L_ok32
    s_waitcnt vmcnt(0)
    buffer_load_dwordx4 v[16:19], v6, s[16:19], s43 offen sc1
    buffer_load_dwordx4 v[20:23], v6, s[16:19], s44 offen sc1
    buffer_load_dwordx4 v[24:27], v6, s[16:19], s45 offen sc1
    buffer_load_dwordx4 v[28:31], v7, s[16:19], s42 offen sc1
    s_waitcnt vmcnt(0)
    s_branch L_chk32
L_rty33:
    s_add_u32 s36, s36, 1
    s_cmp_gt_u32 s36, 20000
    s_cbranch_scc1 L_ok33
    s_waitcnt vmcnt(0)
    buffer_load_dwordx4 v[20:23], v6, s[16:19], s44 offen sc1
    buffer_load_dwordx4 v[24:27], v6, s[16:19], s45 offen sc1
    buffer_load_dwordx4 v[28:31], v7, s[16:19], s42 offen sc1
    buffer_load_dwordx4 v[32:35], v7, s[16:19], s43 offen sc1
    s_waitcnt vmcnt(0)
    s_branch L_chk33
L_rty34:
    s_add_u32 s36, s36, 1
    s_cmp_gt_u32 s36, 20000
    s_cbranch_scc1 L_ok34
    s_waitcnt vmcnt(0)
    buffer_load_dwordx4 v[24:27], v6, s[16:19], s45 offen sc1
    buffer_load_dwordx4 v[28:31], v7, s[16:19], s42 offen sc1
    buffer_load_dwordx4 v[32:35], v7, s[16:19], s43 offen sc1
    buffer_load_dwordx4 v[36:39], v7, s[16:19], s44 offen sc1
    s_waitcnt vmcnt(0)
    s_branch L_chk34
L_rty35:
    s_add_u32 s36, s36, 1
    s_cmp_gt_u32 s36, 20000
    s_cbranch_scc1 L_ok35
    s_waitcnt vmcnt(0)
    buffer_load_dwordx4 v[28:31], v7, s[16:19], s42 offen sc1
    buffer_load_dwordx4 v[32:35], v7, s[16:19], s43 offen sc1
    buffer_load_dwordx4 v[36:39], v7, s[16:19], s44 offen sc1
    buffer_load_dwordx4 v[40:43], v7, s[16:19], s45 offen sc1
    s_waitcnt vmcnt(0)
    s_branch L_chk35
L_rty36:
    s_add_u32 s36, s36, 1
    s_cmp_gt_u32 s36, 20000
    s_cbranch_scc1 L_ok36
    s_waitcnt vmcnt(0)
    buffer_load_dwordx4 v[32:35], v7, s[16:19], s43 offen sc1
    buffer_load_dwordx4 v[36:39], v7, s[16:19], s44 offen sc1
    buffer_load_dwordx4 v[40:43], v7, s[16:19], s45 offen sc1
    s_waitcnt vmcnt(0)
    s_branch L_chk36
L_rty37:
    s_add_u32 s36, s36, 1
    s_cmp_gt_u32 s36, 20000
    s_cbranch_scc1 L_ok37
    s_waitcnt vmcnt(0)
    buffer_load_dwordx4 v[36:39], v7, s[16:19], s44 offen sc1
    buffer_load_dwordx4 v[40:43], v7, s[16:19], s45 offen sc1
    s_waitcnt vmcnt(0)
    s_branch L_chk37
L_rty38:
    s_add_u32 s36, s36, 1
    s_cmp_gt_u32 s36, 20000
    s_cbranch_scc1 L_ok38
    s_waitcnt vmcnt(0)
    buffer_load_dwordx4 v[40:43], v7, s[16:19], s45 offen sc1
    s_waitcnt vmcnt(0)
    s_branch L_chk38
L_sst39:
    buffer_store_dwordx4 v[20:23], v2, s[16:19], s32 offen sc1
    s_nop 0
    s_branch L_ssd39
L_rty40:
    s_add_u32 s36, s36, 1
    s_cmp_gt_u32 s36, 20000
    s_cbranch_scc1 L_ok40
    s_waitcnt vmcnt(0)
    buffer_load_dwordx4 v[12:15], v4, s[16:19], s42 offen sc1
    buffer_load_dwordx4 v[16:19], v4, s[16:19], s43 offen sc1
    buffer_load_dwordx4 v[20:23], v4, s[16:19], s44 offen sc1
    buffer_load_dwordx4 v[24:27], v4, s[16:19], s45 offen sc1
    s_waitcnt vmcnt(3)
    s_branch L_chk40
L_rty41:
    s_add_u32 s36, s36, 1
    s_cmp_gt_u32 s36, 20000
    s_cbranch_scc1 L_ok41
    s_waitcnt vmcnt(0)
    buffer_load_dwordx4 v[16:19], v4, s[16:19], s43 offen sc1
    buffer_load_dwordx4 v[20:23], v4, s[16:19], s44 offen sc1
    buffer_load_dwordx4 v[24:27], v4, s[16:19], s45 offen sc1
    buffer_load_dwordx4 v[28:31], v5, s[16:19], s42 offen sc1
    s_waitcnt vmcnt(3)
    s_branch L_chk41
L_rty42:
    s_add_u32 s36, s36, 1
    s_cmp_gt_u32 s36, 20000
    s_cbranch_scc1 L_ok42
    s_waitcnt vmcnt(0)
    buffer_load_dwordx4 v[20:23], v4, s[16:19], s44 offen sc1
    buffer_load_dwordx4 v[24:27], v4, s[16:19], s45 offen sc1
    buffer_load_dwordx4 v[28:31], v5, s[16:19], s42 offen sc1
    buffer_load_dwordx4 v[32:35], v5, s[16:19], s43 offen sc1
    s_waitcnt vmcnt(3)
    s_branch L_chk42
L_rty43:
    s_add_u32 s36, s36, 1
    s_cmp_gt_u32 s36, 20000
    s_cbranch_scc1 L_ok43
    s_waitcnt vmcnt(0)
    buffer_load_dwordx4 v[24:27], v4, s[16:19], s45 offen sc1
    buffer_load_dwordx4 v[28:31], v5, s[16:19], s42 offen sc1
    buffer_load_dwordx4 v[32:35], v5, s[16:19], s43 offen sc1
    buffer_load_dwordx4 v[36:39], v5, s[16:19], s44 offen sc1
    s_waitcnt vmcnt(3)
    s_branch L_chk43
L_rty44:
    s_add_u32 s36, s36, 1
    s_cmp_gt_u32 s36, 20000
    s_cbranch_scc1 L_ok44
    s_waitcnt vmcnt(0)
    buffer_load_dwordx4 v[28:31], v5, s[16:19], s42 offen sc1
    buffer_load_dwordx4 v[32:35], v5, s[16:19], s43 offen sc1
    buffer_load_dwordx4 v[36:39], v5, s[16:19], s44 offen sc1
    buffer_load_dwordx4 v[40:43], v5, s[16:19], s45 offen sc1
    s_waitcnt vmcnt(3)
    s_branch L_chk44
L_rty45:
    s_add_u32 s36, s36, 1
    s_cmp_gt_u32 s36, 20000
    s_cbranch_scc1 L_ok45
    s_waitcnt vmcnt(0)
    buffer_load_dwordx4 v[32:35], v5, s[16:19], s43 offen sc1
    buffer_load_dwordx4 v[36:39], v5, s[16:19], s44 offen sc1
    buffer_load_dwordx4 v[40:43], v5, s[16:19], s45 offen sc1
    s_waitcnt vmcnt(2)
    s_branch L_chk45
L_rty46:
    s_add_u32 s36, s36, 1
    s_cmp_gt_u32 s36, 20000
    s_cbranch_scc1 L_ok46
    s_waitcnt vmcnt(0)
    buffer_load_dwordx4 v[36:39], v5, s[16:19], s44 offen sc1
    buffer_load_dwordx4 v[40:43], v5, s[16:19], s45 offen sc1
    s_waitcnt vmcnt(1)
    s_branch L_chk46
L_rty47:
    s_add_u32 s36, s36, 1
    s_cmp_gt_u32 s36, 20000
    s_cbranch_scc1 L_ok47
    s_waitcnt vmcnt(0)
    buffer_load_dwordx4 v[40:43], v5, s[16:19], s45 offen sc1
    s_waitcnt vmcnt(0)
    s_branch L_chk47
L_sst48:
    buffer_store_dwordx4 v[20:23], v2, s[16:19], s32 offen sc1
    s_nop 0
    s_branch L_ssd48
L_sst49:
    buffer_store_dwordx4 v[24:27], v2, s[16:19], s32 offen offset:1024 sc1
    s_nop 0
    s_branch L_ssd49
L_sst50:
    buffer_store_dwordx4 v[28:31], v2, s[16:19], s31 offen sc1
    s_nop 0
    s_branch L_ssd50
L_sst51:
    buffer_store_dwordx4 v[32:35], v2, s[16:19], s31 offen offset:1024 sc1
    s_nop 0
    s_branch L_ssd51
L_s6_w7:
    s_setprio 0
    s_add_u32 s33, s60, 0
    buffer_load_dwordx4 v[144:147], v2, s[16:19], s33 offen offset:0 sc1
    s_add_u32 s33, s60, 0
    buffer_load_dwordx4 v[148:151], v2, s[16:19], s33 offen offset:1024 sc1
    s_add_u32 s33, s60, 0
    buffer_load_dwordx4 v[152:155], v2, s[16:19], s33 offen offset:2048 sc1
    s_add_u32 s33, s60, 0
    buffer_load_dwordx4 v[156:159], v2, s[16:19], s33 offen offset:3072 sc1
    s_add_u32 s33, s60, 4096
    buffer_load_dwordx4 v[160:163], v2, s[16:19], s33 offen offset:0 sc1
    s_add_u32 s33, s60, 4096
    buffer_load_dwordx4 v[164:167], v2, s[16:19], s33 offen offset:1024 sc1
    s_add_u32 s33, s60, 4096
    buffer_load_dwordx4 v[168:171], v2, s[16:19], s33 offen offset:2048 sc1
    s_add_u32 s33, s60, 4096
    buffer_load_dwordx4 v[172:175], v2, s[16:19], s33 offen offset:3072 sc1
    s_add_u32 s33, s60, 8192
    buffer_load_dwordx4 v[176:179], v2, s[16:19], s33 offen offset:0 sc1
    s_add_u32 s33, s60, 8192
    buffer_load_dwordx4 v[180:183], v2, s[16:19], s33 offen offset:1024 sc1
    s_add_u32 s33, s60, 8192
    buffer_load_dwordx4 v[184:187], v2, s[16:19], s33 offen offset:2048 sc1
    s_add_u32 s33, s60, 8192
    buffer_load_dwordx4 v[188:191], v2, s[16:19], s33 offen offset:3072 sc1
    s_add_u32 s33, s60, 12288
    buffer_load_dwordx4 v[192:195], v2, s[16:19], s33 offen offset:0 sc1
    s_add_u32 s33, s60, 12288
    buffer_load_dwordx4 v[196:199], v2, s[16:19], s33 offen offset:1024 sc1
    s_add_u32 s33, s60, 12288
    buffer_load_dwordx4 v[200:203], v2, s[16:19], s33 offen offset:2048 sc1
    s_add_u32 s33, s60, 12288
    buffer_load_dwordx4 v[204:207], v2, s[16:19], s33 offen offset:3072 sc1
    s_add_u32 s33, s60, 16384
    buffer_load_dwordx4 v[208:211], v2, s[16:19], s33 offen offset:0 sc1
    s_add_u32 s33, s60, 16384
    buffer_load_dwordx4 v[212:215], v2, s[16:19], s33 offen offset:1024 sc1
    s_add_u32 s33, s60, 16384
    buffer_load_dwordx4 v[216:219], v2, s[16:19], s33 offen offset:2048 sc1
    s_add_u32 s33, s60, 16384
    buffer_load_dwordx4 v[220:223], v2, s[16:19], s33 offen offset:3072 sc1
    s_add_u32 s33, s60, 20480
    buffer_load_dwordx4 v[224:227], v2, s[16:19], s33 offen offset:0 sc1
    s_add_u32 s33, s60, 20480
    buffer_load_dwordx4 v[228:231], v2, s[16:19], s33 offen offset:1024 sc1
    s_add_u32 s33, s60, 20480
    buffer_load_dwordx4 v[232:235], v2, s[16:19], s33 offen offset:2048 sc1
    s_add_u32 s33, s60, 20480
    buffer_load_dwordx4 v[236:239], v2, s[16:19], s33 offen offset:3072 sc1
    s_add_u32 s33, s60, 24576
    buffer_load_dwordx4 v[240:243], v2, s[16:19], s33 offen offset:0 sc1
    s_add_u32 s33, s60, 24576
    buffer_load_dwordx4 v[244:247], v2, s[16:19], s33 offen offset:1024 sc1
    s_add_u32 s33, s60, 24576
    buffer_load_dwordx4 v[248:251], v2, s[16:19], s33 offen offset:2048 sc1
    s_add_u32 s33, s60, 24576
    buffer_load_dwordx4 v[252:255], v2, s[16:19], s33 offen offset:3072 sc1
    s_branch L_s6_done
L_s7_slow:
    s_nop 15
    s_mov_b32 s30, s42
    s_mov_b32 s31, s43
L_s7s0:
    buffer_load_dwordx4 v[12:15], v2, s[16:19], s30 offen sc1
    buffer_load_dwordx4 v[16:19], v2, s[16:19], s31 offen sc1
    s_add_u32 s36, s36, 1
    s_waitcnt vmcnt(1)
    v_max3_u32 v136, v12, v13, v14
    s_waitcnt vmcnt(0)
    v_max3_u32 v136, v136, v15, v16
    v_max3_u32 v136, v136, v17, v18
    v_max_u32 v136, v136, v19
    v_cmp_eq_u32 vcc, -1, v136
    s_cmp_gt_u32 s36, 20000
    s_cselect_b64 vcc, 0, vcc
    s_cbranch_vccnz L_s7s0
    v_mfma_f32_32x32x16_bf16 v[84:99], v[144:147], v[12:15], 0
    v_mfma_f32_32x32x16_bf16 v[100:115], v[144:147], v[16:19], 0
    s_add_u32 s30, s30, 1024
    s_add_u32 s31, s31, 1024
L_s7s1:
    buffer_load_dwordx4 v[12:15], v2, s[16:19], s30 offen sc1
    buffer_load_dwordx4 v[16:19], v2, s[16:19], s31 offen sc1
    s_add_u32 s36, s36, 1
    s_waitcnt vmcnt(1)
    v_max3_u32 v136, v12, v13, v14
    s_waitcnt vmcnt(0)
    v_max3_u32 v136, v136, v15, v16
    v_max3_u32 v136, v136, v17, v18
    v_max_u32 v136, v136, v19
    v_cmp_eq_u32 vcc, -1, v136
    s_cmp_gt_u32 s36, 20000
    s_cselect_b64 vcc, 0, vcc
    s_cbranch_vccnz L_s7s1
    v_mfma_f32_32x32x16_bf16 v[84:99], v[148:151], v[12:15], v[84:99]
    v_mfma_f32_32x32x16_bf16 v[100:115], v[148:151], v[16:19], v[100:115]
    s_add_u32 s30, s30, 1024
    s_add_u32 s31, s31, 1024
L_s7s2:
    buffer_load_dwordx4 v[12:15], v2, s[16:19], s30 offen sc1
    buffer_load_dwordx4 v[16:19], v2, s[16:19], s31 offen sc1
    s_add_u32 s36, s36, 1
    s_waitcnt vmcnt(1)
    v_max3_u32 v136, v12, v13, v14
    s_waitcnt vmcnt(0)
    v_max3_u32 v136, v136, v15, v16
    v_max3_u32 v136, v136, v17, v18
    v_max_u32 v136, v136, v19
    v_cmp_eq_u32 vcc, -1, v136
    s_cmp_gt_u32 s36, 20000
    s_cselect_b64 vcc, 0, vcc
    s_cbranch_vccnz L_s7s2
    v_mfma_f32_32x32x16_bf16 v[84:99], v[152:155], v[12:15], v[84:99]
    v_mfma_f32_32x32x16_bf16 v[100:115], v[152:155], v[16:19], v[100:115]
    s_add_u32 s30, s30, 1024
    s_add_u32 s31, s31, 1024
L_s7s3:
    buffer_load_dwordx4 v[12:15], v2, s[16:19], s30 offen sc1
    buffer_load_dwordx4 v[16:19], v2, s[16:19], s31 offen sc1
    s_add_u32 s36, s36, 1
    s_waitcnt vmcnt(1)
    v_max3_u32 v136, v12, v13, v14
    s_waitcnt vmcnt(0)
    v_max3_u32 v136, v136, v15, v16
    v_max3_u32 v136, v136, v17, v18
    v_max_u32 v136, v136, v19
    v_cmp_eq_u32 vcc, -1, v136
    s_cmp_gt_u32 s36, 20000
    s_cselect_b64 vcc, 0, vcc
    s_cbranch_vccnz L_s7s3
    v_mfma_f32_32x32x16_bf16 v[84:99], v[156:159], v[12:15], v[84:99]
    v_mfma_f32_32x32x16_bf16 v[100:115], v[156:159], v[16:19], v[100:115]
    s_add_u32 s30, s30, 1024
    s_add_u32 s31, s31, 1024
L_s7s4:
    buffer_load_dwordx4 v[12:15], v2, s[16:19], s30 offen sc1
    buffer_load_dwordx4 v[16:19], v2, s[16:19], s31 offen sc1
    s_add_u32 s36, s36, 1
    s_waitcnt vmcnt(1)
    v_max3_u32 v136, v12, v13, v14
    s_waitcnt vmcnt(0)
    v_max3_u32 v136, v136, v15, v16
    v_max3_u32 v136, v136, v17, v18
    v_max_u32 v136, v136, v19
    v_cmp_eq_u32 vcc, -1, v136
    s_cmp_gt_u32 s36, 20000
    s_cselect_b64 vcc, 0, vcc
    s_cbranch_vccnz L_s7s4
    v_mfma_f32_32x32x16_bf16 v[84:99], v[160:163], v[12:15], v[84:99]
    v_mfma_f32_32x32x16_bf16 v[100:115], v[160:163], v[16:19], v[100:115]
    s_add_u32 s30, s30, 1024
    s_add_u32 s31, s31, 1024
L_s7s5:
    buffer_load_dwordx4 v[12:15], v2, s[16:19], s30 offen sc1
    buffer_load_dwordx4 v[16:19], v2, s[16:19], s31 offen sc1
    s_add_u32 s36, s36, 1
    s_waitcnt vmcnt(1)
    v_max3_u32 v136, v12, v13, v14
    s_waitcnt vmcnt(0)
    v_max3_u32 v136, v136, v15, v16
    v_max3_u32 v136, v136, v17, v18
    v_max_u32 v136, v136, v19
    v_cmp_eq_u32 vcc, -1, v136
    s_cmp_gt_u32 s36, 20000
    s_cselect_b64 vcc, 0, vcc
    s_cbranch_vccnz L_s7s5
    v_mfma_f32_32x32x16_bf16 v[84:99], v[164:167], v[12:15], v[84:99]
    v_mfma_f32_32x32x16_bf16 v[100:115], v[164:167], v[16:19], v[100:115]
    s_add_u32 s30, s30, 1024
    s_add_u32 s31, s31, 1024
L_s7s6:
    buffer_load_dwordx4 v[12:15], v2, s[16:19], s30 offen sc1
    buffer_load_dwordx4 v[16:19], v2, s[16:19], s31 offen sc1
    s_add_u32 s36, s36, 1
    s_waitcnt vmcnt(1)
    v_max3_u32 v136, v12, v13, v14
    s_waitcnt vmcnt(0)
    v_max3_u32 v136, v136, v15, v16
    v_max3_u32 v136, v136, v17, v18
    v_max_u32 v136, v136, v19
    v_cmp_eq_u32 vcc, -1, v136
    s_cmp_gt_u32 s36, 20000
    s_cselect_b64 vcc, 0, vcc
    s_cbranch_vccnz L_s7s6
    v_mfma_f32_32x32x16_bf16 v[84:99], v[168:171], v[12:15], v[84:99]
    v_mfma_f32_32x32x16_bf16 v[100:115], v[168:171], v[16:19], v[100:115]
    s_add_u32 s30, s30, 1024
    s_add_u32 s31, s31, 1024
L_s7s7:
    buffer_load_dwordx4 v[12:15], v2, s[16:19], s30 offen sc1
    buffer_load_dwordx4 v[16:19], v2, s[16:19], s31 offen sc1
    s_add_u32 s36, s36, 1
    s_waitcnt vmcnt(1)
    v_max3_u32 v136, v12, v13, v14
    s_waitcnt vmcnt(0)
    v_max3_u32 v136, v136, v15, v16
    v_max3_u32 v136, v136, v17, v18
    v_max_u32 v136, v136, v19
    v_cmp_eq_u32 vcc, -1, v136
    s_cmp_gt_u32 s36, 20000
    s_cselect_b64 vcc, 0, vcc
    s_cbranch_vccnz L_s7s7
    v_mfma_f32_32x32x16_bf16 v[84:99], v[172:175], v[12:15], v[84:99]
    v_mfma_f32_32x32x16_bf16 v[100:115], v[172:175], v[16:19], v[100:115]
    s_add_u32 s30, s30, 1024
    s_add_u32 s31, s31, 1024
L_s7s8:
    buffer_load_dwordx4 v[12:15], v2, s[16:19], s30 offen sc1
    buffer_load_dwordx4 v[16:19], v2, s[16:19], s31 offen sc1
    s_add_u32 s36, s36, 1
    s_waitcnt vmcnt(1)
    v_max3_u32 v136, v12, v13, v14
    s_waitcnt vmcnt(0)
    v_max3_u32 v136, v136, v15, v16
    v_max3_u32 v136, v136, v17, v18
    v_max_u32 v136, v136, v19
    v_cmp_eq_u32 vcc, -1, v136
    s_cmp_gt_u32 s36, 20000
    s_cselect_b64 vcc, 0, vcc
    s_cbranch_vccnz L_s7s8
    v_mfma_f32_32x32x16_bf16 v[84:99], v[176:179], v[12:15], v[84:99]
    v_mfma_f32_32x32x16_bf16 v[100:115], v[176:179], v[16:19], v[100:115]
    s_add_u32 s30, s30, 1024
    s_add_u32 s31, s31, 1024
L_s7s9:
    buffer_load_dwordx4 v[12:15], v2, s[16:19], s30 offen sc1
    buffer_load_dwordx4 v[16:19], v2, s[16:19], s31 offen sc1
    s_add_u32 s36, s36, 1
    s_waitcnt vmcnt(1)
    v_max3_u32 v136, v12, v13, v14
    s_waitcnt vmcnt(0)
    v_max3_u32 v136, v136, v15, v16
    v_max3_u32 v136, v136, v17, v18
    v_max_u32 v136, v136, v19
    v_cmp_eq_u32 vcc, -1, v136
    s_cmp_gt_u32 s36, 20000
    s_cselect_b64 vcc, 0, vcc
    s_cbranch_vccnz L_s7s9
    v_mfma_f32_32x32x16_bf16 v[84:99], v[180:183], v[12:15], v[84:99]
    v_mfma_f32_32x32x16_bf16 v[100:115], v[180:183], v[16:19], v[100:115]
    s_add_u32 s30, s30, 1024
    s_add_u32 s31, s31, 1024
L_s7s10:
    buffer_load_dwordx4 v[12:15], v2, s[16:19], s30 offen sc1
    buffer_load_dwordx4 v[16:19], v2, s[16:19], s31 offen sc1
    s_add_u32 s36, s36, 1
    s_waitcnt vmcnt(1)
    v_max3_u32 v136, v12, v13, v14
    s_waitcnt vmcnt(0)
    v_max3_u32 v136, v136, v15, v16
    v_max3_u32 v136, v136, v17, v18
    v_max_u32 v136, v136, v19
    v_cmp_eq_u32 vcc, -1, v136
    s_cmp_gt_u32 s36, 20000
    s_cselect_b64 vcc, 0, vcc
    s_cbranch_vccnz L_s7s10
    v_mfma_f32_32x32x16_bf16 v[84:99], v[184:187], v[12:15], v[84:99]
    v_mfma_f32_32x32x16_bf16 v[100:115], v[184:187], v[16:19], v[100:115]
    s_add_u32 s30, s30, 1024
    s_add_u32 s31, s31, 1024
L_s7s11:
    buffer_load_dwordx4 v[12:15], v2, s[16:19], s30 offen sc1
    buffer_load_dwordx4 v[16:19], v2, s[16:19], s31 offen sc1
    s_add_u32 s36, s36, 1
    s_waitcnt vmcnt(1)
    v_max3_u32 v136, v12, v13, v14
    s_waitcnt vmcnt(0)
    v_max3_u32 v136, v136, v15, v16
    v_max3_u32 v136, v136, v17, v18
    v_max_u32 v136, v136, v19
    v_cmp_eq_u32 vcc, -1, v136
    s_cmp_gt_u32 s36, 20000
    s_cselect_b64 vcc, 0, vcc
    s_cbranch_vccnz L_s7s11
    v_mfma_f32_32x32x16_bf16 v[84:99], v[188:191], v[12:15], v[84:99]
    v_mfma_f32_32x32x16_bf16 v[100:115], v[188:191], v[16:19], v[100:115]
    s_add_u32 s30, s30, 1024
    s_add_u32 s31, s31, 1024
L_s7s12:
    buffer_load_dwordx4 v[12:15], v2, s[16:19], s30 offen sc1
    buffer_load_dwordx4 v[16:19], v2, s[16:19], s31 offen sc1
    s_add_u32 s36, s36, 1
    s_waitcnt vmcnt(1)
    v_max3_u32 v136, v12, v13, v14
    s_waitcnt vmcnt(0)
    v_max3_u32 v136, v136, v15, v16
    v_max3_u32 v136, v136, v17, v18
    v_max_u32 v136, v136, v19
    v_cmp_eq_u32 vcc, -1, v136
    s_cmp_gt_u32 s36, 20000
    s_cselect_b64 vcc, 0, vcc
    s_cbranch_vccnz L_s7s12
    v_mfma_f32_32x32x16_bf16 v[84:99], v[192:195], v[12:15], v[84:99]
    v_mfma_f32_32x32x16_bf16 v[100:115], v[192:195], v[16:19], v[100:115]
    s_add_u32 s30, s30, 1024
    s_add_u32 s31, s31, 1024
L_s7s13:
    buffer_load_dwordx4 v[12:15], v2, s[16:19], s30 offen sc1
    buffer_load_dwordx4 v[16:19], v2, s[16:19], s31 offen sc1
    s_add_u32 s36, s36, 1
    s_waitcnt vmcnt(1)
    v_max3_u32 v136, v12, v13, v14
    s_waitcnt vmcnt(0)
    v_max3_u32 v136, v136, v15, v16
    v_max3_u32 v136, v136, v17, v18
    v_max_u32 v136, v136, v19
    v_cmp_eq_u32 vcc, -1, v136
    s_cmp_gt_u32 s36, 20000
    s_cselect_b64 vcc, 0, vcc
    s_cbranch_vccnz L_s7s13
    v_mfma_f32_32x32x16_bf16 v[84:99], v[196:199], v[12:15], v[84:99]
    v_mfma_f32_32x32x16_bf16 v[100:115], v[196:199], v[16:19], v[100:115]
    s_add_u32 s30, s30, 1024
    s_add_u32 s31, s31, 1024
L_s7s14:
    buffer_load_dwordx4 v[12:15], v2, s[16:19], s30 offen sc1
    buffer_load_dwordx4 v[16:19], v2, s[16:19], s31 offen sc1
    s_add_u32 s36, s36, 1
    s_waitcnt vmcnt(1)
    v_max3_u32 v136, v12, v13, v14
    s_waitcnt vmcnt(0)
    v_max3_u32 v136, v136, v15, v16
    v_max3_u32 v136, v136, v17, v18
    v_max_u32 v136, v136, v19
    v_cmp_eq_u32 vcc, -1, v136
    s_cmp_gt_u32 s36, 20000
    s_cselect_b64 vcc, 0, vcc
    s_cbranch_vccnz L_s7s14
    v_mfma_f32_32x32x16_bf16 v[84:99], v[200:203], v[12:15], v[84:99]
    v_mfma_f32_32x32x16_bf16 v[100:115], v[200:203], v[16:19], v[100:115]
    s_add_u32 s30, s30, 1024
    s_add_u32 s31, s31, 1024
L_s7s15:
    buffer_load_dwordx4 v[12:15], v2, s[16:19], s30 offen sc1
    buffer_load_dwordx4 v[16:19], v2, s[16:19], s31 offen sc1
    s_add_u32 s36, s36, 1
    s_waitcnt vmcnt(1)
    v_max3_u32 v136, v12, v13, v14
    s_waitcnt vmcnt(0)
    v_max3_u32 v136, v136, v15, v16
    v_max3_u32 v136, v136, v17, v18
    v_max_u32 v136, v136, v19
    v_cmp_eq_u32 vcc, -1, v136
    s_cmp_gt_u32 s36, 20000
    s_cselect_b64 vcc, 0, vcc
    s_cbranch_vccnz L_s7s15
    v_mfma_f32_32x32x16_bf16 v[84:99], v[204:207], v[12:15], v[84:99]
    v_mfma_f32_32x32x16_bf16 v[100:115], v[204:207], v[16:19], v[100:115]
    s_add_u32 s30, s30, 1024
    s_add_u32 s31, s31, 1024
L_s7s16:
    buffer_load_dwordx4 v[12:15], v2, s[16:19], s30 offen sc1
    buffer_load_dwordx4 v[16:19], v2, s[16:19], s31 offen sc1
    s_add_u32 s36, s36, 1
    s_waitcnt vmcnt(1)
    v_max3_u32 v136, v12, v13, v14
    s_waitcnt vmcnt(0)
    v_max3_u32 v136, v136, v15, v16
    v_max3_u32 v136, v136, v17, v18
    v_max_u32 v136, v136, v19
    v_cmp_eq_u32 vcc, -1, v136
    s_cmp_gt_u32 s36, 20000
    s_cselect_b64 vcc, 0, vcc
    s_cbranch_vccnz L_s7s16
    v_mfma_f32_32x32x16_bf16 v[84:99], v[208:211], v[12:15], v[84:99]
    v_mfma_f32_32x32x16_bf16 v[100:115], v[208:211], v[16:19], v[100:115]
    s_add_u32 s30, s30, 1024
    s_add_u32 s31, s31, 1024
L_s7s17:
    buffer_load_dwordx4 v[12:15], v2, s[16:19], s30 offen sc1
    buffer_load_dwordx4 v[16:19], v2, s[16:19], s31 offen sc1
    s_add_u32 s36, s36, 1
    s_waitcnt vmcnt(1)
    v_max3_u32 v136, v12, v13, v14
    s_waitcnt vmcnt(0)
    v_max3_u32 v136, v136, v15, v16
    v_max3_u32 v136, v136, v17, v18
    v_max_u32 v136, v136, v19
    v_cmp_eq_u32 vcc, -1, v136
    s_cmp_gt_u32 s36, 20000
    s_cselect_b64 vcc, 0, vcc
    s_cbranch_vccnz L_s7s17
    v_mfma_f32_32x32x16_bf16 v[84:99], v[212:215], v[12:15], v[84:99]
    v_mfma_f32_32x32x16_bf16 v[100:115], v[212:215], v[16:19], v[100:115]
    s_add_u32 s30, s30, 1024
    s_add_u32 s31, s31, 1024
L_s7s18:
    buffer_load_dwordx4 v[12:15], v2, s[16:19], s30 offen sc1
    buffer_load_dwordx4 v[16:19], v2, s[16:19], s31 offen sc1
    s_add_u32 s36, s36, 1
    s_waitcnt vmcnt(1)
    v_max3_u32 v136, v12, v13, v14
    s_waitcnt vmcnt(0)
    v_max3_u32 v136, v136, v15, v16
    v_max3_u32 v136, v136, v17, v18
    v_max_u32 v136, v136, v19
    v_cmp_eq_u32 vcc, -1, v136
    s_cmp_gt_u32 s36, 20000
    s_cselect_b64 vcc, 0, vcc
    s_cbranch_vccnz L_s7s18
    v_mfma_f32_32x32x16_bf16 v[84:99], v[216:219], v[12:15], v[84:99]
    v_mfma_f32_32x32x16_bf16 v[100:115], v[216:219], v[16:19], v[100:115]
    s_add_u32 s30, s30, 1024
    s_add_u32 s31, s31, 1024
L_s7s19:
    buffer_load_dwordx4 v[12:15], v2, s[16:19], s30 offen sc1
    buffer_load_dwordx4 v[16:19], v2, s[16:19], s31 offen sc1
    s_add_u32 s36, s36, 1
    s_waitcnt vmcnt(1)
    v_max3_u32 v136, v12, v13, v14
    s_waitcnt vmcnt(0)
    v_max3_u32 v136, v136, v15, v16
    v_max3_u32 v136, v136, v17, v18
    v_max_u32 v136, v136, v19
    v_cmp_eq_u32 vcc, -1, v136
    s_cmp_gt_u32 s36, 20000
    s_cselect_b64 vcc, 0, vcc
    s_cbranch_vccnz L_s7s19
    v_mfma_f32_32x32x16_bf16 v[84:99], v[220:223], v[12:15], v[84:99]
    v_mfma_f32_32x32x16_bf16 v[100:115], v[220:223], v[16:19], v[100:115]
    s_add_u32 s30, s30, 1024
    s_add_u32 s31, s31, 1024
L_s7s20:
    buffer_load_dwordx4 v[12:15], v2, s[16:19], s30 offen sc1
    buffer_load_dwordx4 v[16:19], v2, s[16:19], s31 offen sc1
    s_add_u32 s36, s36, 1
    s_waitcnt vmcnt(1)
    v_max3_u32 v136, v12, v13, v14
    s_waitcnt vmcnt(0)
    v_max3_u32 v136, v136, v15, v16
    v_max3_u32 v136, v136, v17, v18
    v_max_u32 v136, v136, v19
    v_cmp_eq_u32 vcc, -1, v136
    s_cmp_gt_u32 s36, 20000
    s_cselect_b64 vcc, 0, vcc
    s_cbranch_vccnz L_s7s20
    v_mfma_f32_32x32x16_bf16 v[84:99], v[224:227], v[12:15], v[84:99]
    v_mfma_f32_32x32x16_bf16 v[100:115], v[224:227], v[16:19], v[100:115]
    s_add_u32 s30, s30, 1024
    s_add_u32 s31, s31, 1024
L_s7s21:
    buffer_load_dwordx4 v[12:15], v2, s[16:19], s30 offen sc1
    buffer_load_dwordx4 v[16:19], v2, s[16:19], s31 offen sc1
    s_add_u32 s36, s36, 1
    s_waitcnt vmcnt(1)
    v_max3_u32 v136, v12, v13, v14
    s_waitcnt vmcnt(0)
    v_max3_u32 v136, v136, v15, v16
    v_max3_u32 v136, v136, v17, v18
    v_max_u32 v136, v136, v19
    v_cmp_eq_u32 vcc, -1, v136
    s_cmp_gt_u32 s36, 20000
    s_cselect_b64 vcc, 0, vcc
    s_cbranch_vccnz L_s7s21
    v_mfma_f32_32x32x16_bf16 v[84:99], v[228:231], v[12:15], v[84:99]
    v_mfma_f32_32x32x16_bf16 v[100:115], v[228:231], v[16:19], v[100:115]
    s_add_u32 s30, s30, 1024
    s_add_u32 s31, s31, 1024
L_s7s22:
    buffer_load_dwordx4 v[12:15], v2, s[16:19], s30 offen sc1
    buffer_load_dwordx4 v[16:19], v2, s[16:19], s31 offen sc1
    s_add_u32 s36, s36, 1
    s_waitcnt vmcnt(1)
    v_max3_u32 v136, v12, v13, v14
    s_waitcnt vmcnt(0)
    v_max3_u32 v136, v136, v15, v16
    v_max3_u32 v136, v136, v17, v18
    v_max_u32 v136, v136, v19
    v_cmp_eq_u32 vcc, -1, v136
    s_cmp_gt_u32 s36, 20000
    s_cselect_b64 vcc, 0, vcc
    s_cbranch_vccnz L_s7s22
    v_mfma_f32_32x32x16_bf16 v[84:99], v[232:235], v[12:15], v[84:99]
    v_mfma_f32_32x32x16_bf16 v[100:115], v[232:235], v[16:19], v[100:115]
    s_add_u32 s30, s30, 1024
    s_add_u32 s31, s31, 1024
L_s7s23:
    buffer_load_dwordx4 v[12:15], v2, s[16:19], s30 offen sc1
    buffer_load_dwordx4 v[16:19], v2, s[16:19], s31 offen sc1
    s_add_u32 s36, s36, 1
    s_waitcnt vmcnt(1)
    v_max3_u32 v136, v12, v13, v14
    s_waitcnt vmcnt(0)
    v_max3_u32 v136, v136, v15, v16
    v_max3_u32 v136, v136, v17, v18
    v_max_u32 v136, v136, v19
    v_cmp_eq_u32 vcc, -1, v136
    s_cmp_gt_u32 s36, 20000
    s_cselect_b64 vcc, 0, vcc
    s_cbranch_vccnz L_s7s23
    v_mfma_f32_32x32x16_bf16 v[84:99], v[236:239], v[12:15], v[84:99]
    v_mfma_f32_32x32x16_bf16 v[100:115], v[236:239], v[16:19], v[100:115]
    s_add_u32 s30, s30, 1024
    s_add_u32 s31, s31, 1024
L_s7s24:
    buffer_load_dwordx4 v[12:15], v2, s[16:19], s30 offen sc1
    buffer_load_dwordx4 v[16:19], v2, s[16:19], s31 offen sc1
    s_add_u32 s36, s36, 1
    s_waitcnt vmcnt(1)
    v_max3_u32 v136, v12, v13, v14
    s_waitcnt vmcnt(0)
    v_max3_u32 v136, v136, v15, v16
    v_max3_u32 v136, v136, v17, v18
    v_max_u32 v136, v136, v19
    v_cmp_eq_u32 vcc, -1, v136
    s_cmp_gt_u32 s36, 20000
    s_cselect_b64 vcc, 0, vcc
    s_cbranch_vccnz L_s7s24
    v_mfma_f32_32x32x16_bf16 v[84:99], v[240:243], v[12:15], v[84:99]
    v_mfma_f32_32x32x16_bf16 v[100:115], v[240:243], v[16:19], v[100:115]
    s_add_u32 s30, s30, 1024
    s_add_u32 s31, s31, 1024
L_s7s25:
    buffer_load_dwordx4 v[12:15], v2, s[16:19], s30 offen sc1
    buffer_load_dwordx4 v[16:19], v2, s[16:19], s31 offen sc1
    s_add_u32 s36, s36, 1
    s_waitcnt vmcnt(1)
    v_max3_u32 v136, v12, v13, v14
    s_waitcnt vmcnt(0)
    v_max3_u32 v136, v136, v15, v16
    v_max3_u32 v136, v136, v17, v18
    v_max_u32 v136, v136, v19
    v_cmp_eq_u32 vcc, -1, v136
    s_cmp_gt_u32 s36, 20000
    s_cselect_b64 vcc, 0, vcc
    s_cbranch_vccnz L_s7s25
    v_mfma_f32_32x32x16_bf16 v[84:99], v[244:247], v[12:15], v[84:99]
    v_mfma_f32_32x32x16_bf16 v[100:115], v[244:247], v[16:19], v[100:115]
    s_add_u32 s30, s30, 1024
    s_add_u32 s31, s31, 1024
L_s7s26:
    buffer_load_dwordx4 v[12:15], v2, s[16:19], s30 offen sc1
    buffer_load_dwordx4 v[16:19], v2, s[16:19], s31 offen sc1
    s_add_u32 s36, s36, 1
    s_waitcnt vmcnt(1)
    v_max3_u32 v136, v12, v13, v14
    s_waitcnt vmcnt(0)
    v_max3_u32 v136, v136, v15, v16
    v_max3_u32 v136, v136, v17, v18
    v_max_u32 v136, v136, v19
    v_cmp_eq_u32 vcc, -1, v136
    s_cmp_gt_u32 s36, 20000
    s_cselect_b64 vcc, 0, vcc
    s_cbranch_vccnz L_s7s26
    v_mfma_f32_32x32x16_bf16 v[84:99], v[248:251], v[12:15], v[84:99]
    v_mfma_f32_32x32x16_bf16 v[100:115], v[248:251], v[16:19], v[100:115]
    s_add_u32 s30, s30, 1024
    s_add_u32 s31, s31, 1024
L_s7s27:
    buffer_load_dwordx4 v[12:15], v2, s[16:19], s30 offen sc1
    buffer_load_dwordx4 v[16:19], v2, s[16:19], s31 offen sc1
    s_add_u32 s36, s36, 1
    s_waitcnt vmcnt(1)
    v_max3_u32 v136, v12, v13, v14
    s_waitcnt vmcnt(0)
    v_max3_u32 v136, v136, v15, v16
    v_max3_u32 v136, v136, v17, v18
    v_max_u32 v136, v136, v19
    v_cmp_eq_u32 vcc, -1, v136
    s_cmp_gt_u32 s36, 20000
    s_cselect_b64 vcc, 0, vcc
    s_cbranch_vccnz L_s7s27
    v_mfma_f32_32x32x16_bf16 v[84:99], v[252:255], v[12:15], v[84:99]
    v_mfma_f32_32x32x16_bf16 v[100:115], v[252:255], v[16:19], v[100:115]
    s_add_u32 s30, s30, 1024
    s_add_u32 s31, s31, 1024
    s_nop 15
    s_branch L_s7_red
L_code_end:
.section .rodata,"a"
.p2align 6
.amdhsa_kernel sequential_preLN__mha_block__mixer_s_mlp__prompt_kernel
  .amdhsa_next_free_vgpr 256
  .amdhsa_next_free_sgpr 70
  .amdhsa_accum_offset 256
  .amdhsa_group_segment_fixed_size 0
  .amdhsa_kernarg_size 88
  .amdhsa_user_sgpr_count 2
  .amdhsa_user_sgpr_kernarg_segment_ptr 1
  .amdhsa_system_sgpr_workgroup_id_x 1
.end_amdhsa_kernel
```
